```python
import torch

def _softmax(x, axis=-1):
    return torch.softmax(x, dim=axis)

def _gelu(x):
    return torch.nn.functional.gelu(x, approximate='tanh')

def _silu(x):
    return torch.nn.functional.silu(x)

def _sigmoid(x):
    return torch.sigmoid(x)

def _layernorm(x, axis=-1, eps=1e-05):
    m = x.mean(dim=axis, keepdim=True)
    v = x.var(dim=axis, keepdim=True, unbiased=False)
    return (x - m) / torch.sqrt(v + eps)

def _scatter_add(tgt, idx, src, axis=0):
    return tgt.clone().index_add_(axis, idx, src)

def _segment_sum(src, seg, n):
    out = torch.zeros((n,) + src.shape[1:], dtype=src.dtype)
    return out.index_add_(0, seg, src)

def _pad(x, pw):
    flat = tuple((v for pair in reversed(pw) for v in pair))
    return torch.nn.functional.pad(x, flat)
kernel_name = 'adaLN_cond__memory_aug_recurrent_mem_tr__dense_activation_gelu__prompt'

def setup_inputs():

    _w = lambda a: (lambda t: t.to(torch.bfloat16) if t.is_floating_point() else t)(torch.as_tensor(a))

    def _A_setup():
        B, S, Dm = (1, 2048, 448)
        H, Dh = (16, 256)
        M, seg = (8, 32)
        seg = min(seg, S)
        S = S // seg * seg
        return {'x': _w((lambda *s: torch.randn(*s, dtype=torch.bfloat16) * 0.05)(B, S, Dm)), 'mem0': _w((lambda *s: torch.randn(*s, dtype=torch.bfloat16) * 0.8)(B, M, Dm)), 'Wq': _w((lambda *s: torch.randn(*s, dtype=torch.bfloat16) * 0.8)(Dm, H, Dh) * Dm ** (-0.5)), 'Wk': _w((lambda *s: torch.randn(*s, dtype=torch.bfloat16) * 0.8)(Dm, H, Dh) * Dm ** (-0.5)), 'Wv': _w((lambda *s: torch.randn(*s, dtype=torch.bfloat16) * 0.8)(Dm, H, Dh) * Dm ** (-0.5)), 'Wo': _w((lambda *s: torch.randn(*s, dtype=torch.bfloat16) * 0.8)(H, Dh, Dm) * (H * Dh) ** (-0.5)), 'seg_len': seg}
    _A_in = _A_setup()

    def _B_setup():
        B, S, D, F = (1, 2048, 448, 1792)
        return {'x': _w((lambda *s: torch.randn(*s, dtype=torch.bfloat16) * 0.05)(B, S, D)), 'w1': _w((lambda *s: torch.randn(*s, dtype=torch.bfloat16) * 0.8)(D, F) * D ** (-0.5)), 'b1': _w((lambda *s: torch.randn(*s, dtype=torch.bfloat16) * 12.8)(F) * 0.01), 'w2': _w((lambda *s: torch.randn(*s, dtype=torch.bfloat16) * 0.8)(F, D) * F ** (-0.5)), 'b2': _w((lambda *s: torch.randn(*s, dtype=torch.bfloat16) * 12.8)(D) * 0.01)}
    _B_in = _B_setup()
    return {'A_x': _A_in['x'], 'A_mem0': _A_in['mem0'], 'A_Wq': _A_in['Wq'], 'A_Wk': _A_in['Wk'], 'A_Wv': _A_in['Wv'], 'A_Wo': _A_in['Wo'], 'A_seg_len': _A_in['seg_len'], 'B_x': _B_in['x'], 'B_w1': _B_in['w1'], 'B_b1': _B_in['b1'], 'B_w2': _B_in['w2'], 'B_b2': _B_in['b2'], 'c': _w((lambda *s: torch.randn(*s, dtype=torch.bfloat16) * 0.1)(1, 448) * 8.0), 'w_mod': _w((lambda *s: torch.randn(*s, dtype=torch.bfloat16) * 0.1)(448, 6 * 448) * 448 ** (-0.5) * 8.0)}

def reference(A_x, A_mem0, A_Wq, A_Wk, A_Wv, A_Wo, A_seg_len, B_x, B_w1, B_b1, B_w2, B_b2, c, w_mod):

    def _A_ref(x, mem0, Wq, Wk, Wv, Wo, seg_len):
        B, S, Dm = x.shape
        H, Dh = (Wq.shape[1], Wq.shape[2])
        M = mem0.shape[1]
        scale = Dh ** (-0.5)
        n_seg = S // seg_len
        L = M + seg_len
        idx = torch.arange(L)
        mask = (idx[:, None] < M) | (idx[:, None] >= idx[None, :])
        mem = mem0
        outs = []
        for s in range(n_seg):
            xs = x[:, s * seg_len:(s + 1) * seg_len, :].clone()
            h = torch.concatenate([mem, xs], axis=1)
            q = torch.einsum('btd,dhe->bhte', h, Wq)
            k = torch.einsum('btd,dhe->bhte', h, Wk)
            v = torch.einsum('btd,dhe->bhte', h, Wv)
            scores = torch.einsum('bhqe,bhke->bhqk', q, k) * scale
            scores = torch.where(mask[None, None], scores, -1000000000.0)
            p = _softmax(scores, axis=-1)
            o = torch.einsum('bhqk,bhke->bhqe', p, v)
            o = torch.einsum('bhte,hed->btd', o, Wo)
            mem = o[:, :M, :].clone()
            outs.append(o[:, M:, :])
        return torch.concatenate(outs, axis=1)

    def _B_ref(x, w1, b1, w2, b2):
        h = torch.einsum('bsd,df->bsf', x, w1) + b1
        h = _gelu(h)
        return torch.einsum('bsf,fd->bsd', h, w2) + b2
    x = A_x
    mod = (_silu(c) @ w_mod).reshape(c.shape[0], 6, 1, -1)
    sa, ca, ga, sb, cb, gb = (mod[:, 0].clone(), mod[:, 1].clone(), mod[:, 2].clone(), mod[:, 3].clone(), mod[:, 4].clone(), mod[:, 5].clone())
    h = _layernorm(x, axis=-1) * (1 + ca) + sa
    x = x + ga * _A_ref(h, A_mem0, A_Wq, A_Wk, A_Wv, A_Wo, A_seg_len)
    h = _layernorm(x, axis=-1) * (1 + cb) + sb
    x = x + gb * _B_ref(h, B_w1, B_b1, B_w2, B_b2)
    return x
```

```asm
; @launch kernel=prep_kernel grid=(672,1,1) block=(256,1,1) lds=4096
; @launch kernel=pre2_kernel grid=(708,1,1) block=(256,1,1) lds=0
; @launch kernel=mega_kernel grid=(256,1,1) block=(256,1,1) lds=135168
.amdgcn_target "amdgcn-amd-amdhsa--gfx950"
.text
.globl prep_kernel
.p2align 8
.type prep_kernel,@function
prep_kernel:
    s_load_dwordx2 s[4:5], s[0:1], 16
    s_load_dwordx2 s[6:7], s[0:1], 24
    s_load_dwordx2 s[10:11], s[0:1], 40
    s_load_dwordx2 s[12:13], s[0:1], 64
    s_load_dwordx2 s[14:15], s[0:1], 80
    s_load_dwordx2 s[16:17], s[0:1], 96
    s_load_dwordx2 s[18:19], s[0:1], 104
    s_load_dwordx2 s[20:21], s[0:1], 128
    s_load_dwordx2 s[22:23], s[0:1], 8
    s_waitcnt lgkmcnt(0)
    v_lshrrev_b32 v2, 6, v0
    s_nop 0
    v_readfirstlane_b32 s24, v2
    v_and_b32 v1, 63, v0
    v_and_b32 v2, 15, v1
    v_lshrrev_b32 v3, 4, v1
    s_cmp_ge_u32 s2, 672
    s_cbranch_scc1 .prep_end_1
    s_cmp_ge_u32 s2, 671
    s_cbranch_scc1 .prep_8
    s_cmp_ge_u32 s2, 637
    s_cbranch_scc1 .prep_7
    s_cmp_ge_u32 s2, 539
    s_cbranch_scc1 .prep_6
    s_cmp_ge_u32 s2, 441
    s_cbranch_scc1 .prep_5
    s_cmp_ge_u32 s2, 217
    s_cbranch_scc1 .prep_4
    s_cmp_ge_u32 s2, 21
    s_cbranch_scc1 .prep_3
    v_lshlrev_b32 v4, 1, v0
    global_load_ushort v5, v4, s[16:17]
    v_add_u32 v6, 256, v0
    v_min_u32 v6, 447, v6
    v_lshlrev_b32 v7, 1, v6
    global_load_ushort v8, v7, s[16:17]
    s_sub_u32 s25, s2, 0
    s_lshl_b32 s25, s25, 8
    s_mul_i32 s26, s24, 602112
    s_add_u32 s26, s26, s25
    v_lshlrev_b32 v4, 2, v1
    v_add_u32 v4, s26, v4
    global_load_dword v16, v4, s[18:19]
    v_add_u32 v4, 5376, v4
    global_load_dword v17, v4, s[18:19]
    v_add_u32 v4, 5376, v4
    global_load_dword v18, v4, s[18:19]
    v_add_u32 v4, 5376, v4
    global_load_dword v19, v4, s[18:19]
    v_add_u32 v4, 5376, v4
    global_load_dword v20, v4, s[18:19]
    v_add_u32 v4, 5376, v4
    global_load_dword v21, v4, s[18:19]
    v_add_u32 v4, 5376, v4
    global_load_dword v22, v4, s[18:19]
    v_add_u32 v4, 5376, v4
    global_load_dword v23, v4, s[18:19]
    v_add_u32 v4, 5376, v4
    global_load_dword v24, v4, s[18:19]
    v_add_u32 v4, 5376, v4
    global_load_dword v25, v4, s[18:19]
    v_add_u32 v4, 5376, v4
    global_load_dword v26, v4, s[18:19]
    v_add_u32 v4, 5376, v4
    global_load_dword v27, v4, s[18:19]
    v_add_u32 v4, 5376, v4
    global_load_dword v28, v4, s[18:19]
    v_add_u32 v4, 5376, v4
    global_load_dword v29, v4, s[18:19]
    v_add_u32 v4, 5376, v4
    global_load_dword v30, v4, s[18:19]
    v_add_u32 v4, 5376, v4
    global_load_dword v31, v4, s[18:19]
    v_add_u32 v4, 5376, v4
    global_load_dword v32, v4, s[18:19]
    v_add_u32 v4, 5376, v4
    global_load_dword v33, v4, s[18:19]
    v_add_u32 v4, 5376, v4
    global_load_dword v34, v4, s[18:19]
    v_add_u32 v4, 5376, v4
    global_load_dword v35, v4, s[18:19]
    v_add_u32 v4, 5376, v4
    global_load_dword v36, v4, s[18:19]
    v_add_u32 v4, 5376, v4
    global_load_dword v37, v4, s[18:19]
    v_add_u32 v4, 5376, v4
    global_load_dword v38, v4, s[18:19]
    v_add_u32 v4, 5376, v4
    global_load_dword v39, v4, s[18:19]
    v_add_u32 v4, 5376, v4
    global_load_dword v40, v4, s[18:19]
    v_add_u32 v4, 5376, v4
    global_load_dword v41, v4, s[18:19]
    v_add_u32 v4, 5376, v4
    global_load_dword v42, v4, s[18:19]
    v_add_u32 v4, 5376, v4
    global_load_dword v43, v4, s[18:19]
    v_add_u32 v4, 5376, v4
    global_load_dword v44, v4, s[18:19]
    v_add_u32 v4, 5376, v4
    global_load_dword v45, v4, s[18:19]
    v_add_u32 v4, 5376, v4
    global_load_dword v46, v4, s[18:19]
    v_add_u32 v4, 5376, v4
    global_load_dword v47, v4, s[18:19]
    v_add_u32 v4, 5376, v4
    global_load_dword v48, v4, s[18:19]
    v_add_u32 v4, 5376, v4
    global_load_dword v49, v4, s[18:19]
    v_add_u32 v4, 5376, v4
    global_load_dword v50, v4, s[18:19]
    v_add_u32 v4, 5376, v4
    global_load_dword v51, v4, s[18:19]
    v_add_u32 v4, 5376, v4
    global_load_dword v52, v4, s[18:19]
    v_add_u32 v4, 5376, v4
    global_load_dword v53, v4, s[18:19]
    v_add_u32 v4, 5376, v4
    global_load_dword v54, v4, s[18:19]
    v_add_u32 v4, 5376, v4
    global_load_dword v55, v4, s[18:19]
    v_add_u32 v4, 5376, v4
    global_load_dword v56, v4, s[18:19]
    v_add_u32 v4, 5376, v4
    global_load_dword v57, v4, s[18:19]
    v_add_u32 v4, 5376, v4
    global_load_dword v58, v4, s[18:19]
    v_add_u32 v4, 5376, v4
    global_load_dword v59, v4, s[18:19]
    v_add_u32 v4, 5376, v4
    global_load_dword v60, v4, s[18:19]
    v_add_u32 v4, 5376, v4
    global_load_dword v61, v4, s[18:19]
    v_add_u32 v4, 5376, v4
    global_load_dword v62, v4, s[18:19]
    v_add_u32 v4, 5376, v4
    global_load_dword v63, v4, s[18:19]
    v_add_u32 v4, 5376, v4
    global_load_dword v64, v4, s[18:19]
    v_add_u32 v4, 5376, v4
    global_load_dword v65, v4, s[18:19]
    v_add_u32 v4, 5376, v4
    global_load_dword v66, v4, s[18:19]
    v_add_u32 v4, 5376, v4
    global_load_dword v67, v4, s[18:19]
    v_add_u32 v4, 5376, v4
    global_load_dword v68, v4, s[18:19]
    v_add_u32 v4, 5376, v4
    global_load_dword v69, v4, s[18:19]
    v_add_u32 v4, 5376, v4
    global_load_dword v70, v4, s[18:19]
    v_add_u32 v4, 5376, v4
    global_load_dword v71, v4, s[18:19]
    v_add_u32 v4, 5376, v4
    s_waitcnt vmcnt(56)
    v_lshlrev_b32 v5, 16, v5
    v_mul_f32 v9, 0xbfb8aa3b, v5
    v_exp_f32 v9, v9
    s_nop 0
    v_add_f32 v9, 1.0, v9
    v_rcp_f32 v9, v9
    s_nop 0
    v_mul_f32 v9, v9, v5
    v_cvt_pk_bf16_f32 v9, v9, v9
    v_lshlrev_b32 v9, 16, v9
    v_lshlrev_b32 v10, 2, v0
    ds_write_b32 v10, v9
    v_lshlrev_b32 v8, 16, v8
    v_mul_f32 v9, 0xbfb8aa3b, v8
    v_exp_f32 v9, v9
    s_nop 0
    v_add_f32 v9, 1.0, v9
    v_rcp_f32 v9, v9
    s_nop 0
    v_mul_f32 v9, v9, v8
    v_cvt_pk_bf16_f32 v9, v9, v9
    v_lshlrev_b32 v9, 16, v9
    v_lshlrev_b32 v10, 2, v6
    ds_write_b32 v10, v9
    s_waitcnt lgkmcnt(0)
    s_barrier
    s_mul_i32 s27, s24, 448
    v_mov_b32 v5, s27
    v_mov_b32 v6, 0
    v_mov_b32 v7, 0
    ds_read_b128 v[128:131], v5 offset:0
    ds_read_b128 v[132:135], v5 offset:16
    ds_read_b128 v[136:139], v5 offset:32
    ds_read_b128 v[140:143], v5 offset:48
    ds_read_b128 v[144:147], v5 offset:64
    ds_read_b128 v[148:151], v5 offset:80
    ds_read_b128 v[152:155], v5 offset:96
    ds_read_b128 v[156:159], v5 offset:112
    ds_read_b128 v[160:163], v5 offset:128
    ds_read_b128 v[164:167], v5 offset:144
    ds_read_b128 v[168:171], v5 offset:160
    ds_read_b128 v[172:175], v5 offset:176
    ds_read_b128 v[176:179], v5 offset:192
    ds_read_b128 v[180:183], v5 offset:208
    ds_read_b128 v[184:187], v5 offset:224
    ds_read_b128 v[188:191], v5 offset:240
    ds_read_b128 v[192:195], v5 offset:256
    ds_read_b128 v[196:199], v5 offset:272
    ds_read_b128 v[200:203], v5 offset:288
    ds_read_b128 v[204:207], v5 offset:304
    ds_read_b128 v[208:211], v5 offset:320
    ds_read_b128 v[212:215], v5 offset:336
    ds_read_b128 v[216:219], v5 offset:352
    ds_read_b128 v[220:223], v5 offset:368
    ds_read_b128 v[224:227], v5 offset:384
    ds_read_b128 v[228:231], v5 offset:400
    ds_read_b128 v[232:235], v5 offset:416
    ds_read_b128 v[236:239], v5 offset:432
    s_waitcnt vmcnt(0) lgkmcnt(0)
    global_load_dword v72, v4, s[18:19]
    v_add_u32 v4, 5376, v4
    global_load_dword v73, v4, s[18:19]
    v_add_u32 v4, 5376, v4
    global_load_dword v74, v4, s[18:19]
    v_add_u32 v4, 5376, v4
    global_load_dword v75, v4, s[18:19]
    v_add_u32 v4, 5376, v4
    global_load_dword v76, v4, s[18:19]
    v_add_u32 v4, 5376, v4
    global_load_dword v77, v4, s[18:19]
    v_add_u32 v4, 5376, v4
    global_load_dword v78, v4, s[18:19]
    v_add_u32 v4, 5376, v4
    global_load_dword v79, v4, s[18:19]
    v_add_u32 v4, 5376, v4
    global_load_dword v80, v4, s[18:19]
    v_add_u32 v4, 5376, v4
    global_load_dword v81, v4, s[18:19]
    v_add_u32 v4, 5376, v4
    global_load_dword v82, v4, s[18:19]
    v_add_u32 v4, 5376, v4
    global_load_dword v83, v4, s[18:19]
    v_add_u32 v4, 5376, v4
    global_load_dword v84, v4, s[18:19]
    v_add_u32 v4, 5376, v4
    global_load_dword v85, v4, s[18:19]
    v_add_u32 v4, 5376, v4
    global_load_dword v86, v4, s[18:19]
    v_add_u32 v4, 5376, v4
    global_load_dword v87, v4, s[18:19]
    v_add_u32 v4, 5376, v4
    global_load_dword v88, v4, s[18:19]
    v_add_u32 v4, 5376, v4
    global_load_dword v89, v4, s[18:19]
    v_add_u32 v4, 5376, v4
    global_load_dword v90, v4, s[18:19]
    v_add_u32 v4, 5376, v4
    global_load_dword v91, v4, s[18:19]
    v_add_u32 v4, 5376, v4
    global_load_dword v92, v4, s[18:19]
    v_add_u32 v4, 5376, v4
    global_load_dword v93, v4, s[18:19]
    v_add_u32 v4, 5376, v4
    global_load_dword v94, v4, s[18:19]
    v_add_u32 v4, 5376, v4
    global_load_dword v95, v4, s[18:19]
    v_add_u32 v4, 5376, v4
    global_load_dword v96, v4, s[18:19]
    v_add_u32 v4, 5376, v4
    global_load_dword v97, v4, s[18:19]
    v_add_u32 v4, 5376, v4
    global_load_dword v98, v4, s[18:19]
    v_add_u32 v4, 5376, v4
    global_load_dword v99, v4, s[18:19]
    v_add_u32 v4, 5376, v4
    global_load_dword v100, v4, s[18:19]
    v_add_u32 v4, 5376, v4
    global_load_dword v101, v4, s[18:19]
    v_add_u32 v4, 5376, v4
    global_load_dword v102, v4, s[18:19]
    v_add_u32 v4, 5376, v4
    global_load_dword v103, v4, s[18:19]
    v_add_u32 v4, 5376, v4
    global_load_dword v104, v4, s[18:19]
    v_add_u32 v4, 5376, v4
    global_load_dword v105, v4, s[18:19]
    v_add_u32 v4, 5376, v4
    global_load_dword v106, v4, s[18:19]
    v_add_u32 v4, 5376, v4
    global_load_dword v107, v4, s[18:19]
    v_add_u32 v4, 5376, v4
    global_load_dword v108, v4, s[18:19]
    v_add_u32 v4, 5376, v4
    global_load_dword v109, v4, s[18:19]
    v_add_u32 v4, 5376, v4
    global_load_dword v110, v4, s[18:19]
    v_add_u32 v4, 5376, v4
    global_load_dword v111, v4, s[18:19]
    v_add_u32 v4, 5376, v4
    global_load_dword v112, v4, s[18:19]
    v_add_u32 v4, 5376, v4
    global_load_dword v113, v4, s[18:19]
    v_add_u32 v4, 5376, v4
    global_load_dword v114, v4, s[18:19]
    v_add_u32 v4, 5376, v4
    global_load_dword v115, v4, s[18:19]
    v_add_u32 v4, 5376, v4
    global_load_dword v116, v4, s[18:19]
    v_add_u32 v4, 5376, v4
    global_load_dword v117, v4, s[18:19]
    v_add_u32 v4, 5376, v4
    global_load_dword v118, v4, s[18:19]
    v_add_u32 v4, 5376, v4
    global_load_dword v119, v4, s[18:19]
    v_add_u32 v4, 5376, v4
    global_load_dword v120, v4, s[18:19]
    v_add_u32 v4, 5376, v4
    global_load_dword v121, v4, s[18:19]
    v_add_u32 v4, 5376, v4
    global_load_dword v122, v4, s[18:19]
    v_add_u32 v4, 5376, v4
    global_load_dword v123, v4, s[18:19]
    v_add_u32 v4, 5376, v4
    global_load_dword v124, v4, s[18:19]
    v_add_u32 v4, 5376, v4
    global_load_dword v125, v4, s[18:19]
    v_add_u32 v4, 5376, v4
    global_load_dword v126, v4, s[18:19]
    v_add_u32 v4, 5376, v4
    global_load_dword v127, v4, s[18:19]
    v_add_u32 v4, 5376, v4
    v_lshlrev_b32 v8, 16, v16
    v_and_b32 v9, 0xffff0000, v16
    v_fmac_f32 v6, v8, v128
    v_fmac_f32 v7, v9, v128
    v_lshlrev_b32 v8, 16, v17
    v_and_b32 v9, 0xffff0000, v17
    v_fmac_f32 v6, v8, v129
    v_fmac_f32 v7, v9, v129
    v_lshlrev_b32 v8, 16, v18
    v_and_b32 v9, 0xffff0000, v18
    v_fmac_f32 v6, v8, v130
    v_fmac_f32 v7, v9, v130
    v_lshlrev_b32 v8, 16, v19
    v_and_b32 v9, 0xffff0000, v19
    v_fmac_f32 v6, v8, v131
    v_fmac_f32 v7, v9, v131
    v_lshlrev_b32 v8, 16, v20
    v_and_b32 v9, 0xffff0000, v20
    v_fmac_f32 v6, v8, v132
    v_fmac_f32 v7, v9, v132
    v_lshlrev_b32 v8, 16, v21
    v_and_b32 v9, 0xffff0000, v21
    v_fmac_f32 v6, v8, v133
    v_fmac_f32 v7, v9, v133
    v_lshlrev_b32 v8, 16, v22
    v_and_b32 v9, 0xffff0000, v22
    v_fmac_f32 v6, v8, v134
    v_fmac_f32 v7, v9, v134
    v_lshlrev_b32 v8, 16, v23
    v_and_b32 v9, 0xffff0000, v23
    v_fmac_f32 v6, v8, v135
    v_fmac_f32 v7, v9, v135
    v_lshlrev_b32 v8, 16, v24
    v_and_b32 v9, 0xffff0000, v24
    v_fmac_f32 v6, v8, v136
    v_fmac_f32 v7, v9, v136
    v_lshlrev_b32 v8, 16, v25
    v_and_b32 v9, 0xffff0000, v25
    v_fmac_f32 v6, v8, v137
    v_fmac_f32 v7, v9, v137
    v_lshlrev_b32 v8, 16, v26
    v_and_b32 v9, 0xffff0000, v26
    v_fmac_f32 v6, v8, v138
    v_fmac_f32 v7, v9, v138
    v_lshlrev_b32 v8, 16, v27
    v_and_b32 v9, 0xffff0000, v27
    v_fmac_f32 v6, v8, v139
    v_fmac_f32 v7, v9, v139
    v_lshlrev_b32 v8, 16, v28
    v_and_b32 v9, 0xffff0000, v28
    v_fmac_f32 v6, v8, v140
    v_fmac_f32 v7, v9, v140
    v_lshlrev_b32 v8, 16, v29
    v_and_b32 v9, 0xffff0000, v29
    v_fmac_f32 v6, v8, v141
    v_fmac_f32 v7, v9, v141
    v_lshlrev_b32 v8, 16, v30
    v_and_b32 v9, 0xffff0000, v30
    v_fmac_f32 v6, v8, v142
    v_fmac_f32 v7, v9, v142
    v_lshlrev_b32 v8, 16, v31
    v_and_b32 v9, 0xffff0000, v31
    v_fmac_f32 v6, v8, v143
    v_fmac_f32 v7, v9, v143
    v_lshlrev_b32 v8, 16, v32
    v_and_b32 v9, 0xffff0000, v32
    v_fmac_f32 v6, v8, v144
    v_fmac_f32 v7, v9, v144
    v_lshlrev_b32 v8, 16, v33
    v_and_b32 v9, 0xffff0000, v33
    v_fmac_f32 v6, v8, v145
    v_fmac_f32 v7, v9, v145
    v_lshlrev_b32 v8, 16, v34
    v_and_b32 v9, 0xffff0000, v34
    v_fmac_f32 v6, v8, v146
    v_fmac_f32 v7, v9, v146
    v_lshlrev_b32 v8, 16, v35
    v_and_b32 v9, 0xffff0000, v35
    v_fmac_f32 v6, v8, v147
    v_fmac_f32 v7, v9, v147
    v_lshlrev_b32 v8, 16, v36
    v_and_b32 v9, 0xffff0000, v36
    v_fmac_f32 v6, v8, v148
    v_fmac_f32 v7, v9, v148
    v_lshlrev_b32 v8, 16, v37
    v_and_b32 v9, 0xffff0000, v37
    v_fmac_f32 v6, v8, v149
    v_fmac_f32 v7, v9, v149
    v_lshlrev_b32 v8, 16, v38
    v_and_b32 v9, 0xffff0000, v38
    v_fmac_f32 v6, v8, v150
    v_fmac_f32 v7, v9, v150
    v_lshlrev_b32 v8, 16, v39
    v_and_b32 v9, 0xffff0000, v39
    v_fmac_f32 v6, v8, v151
    v_fmac_f32 v7, v9, v151
    v_lshlrev_b32 v8, 16, v40
    v_and_b32 v9, 0xffff0000, v40
    v_fmac_f32 v6, v8, v152
    v_fmac_f32 v7, v9, v152
    v_lshlrev_b32 v8, 16, v41
    v_and_b32 v9, 0xffff0000, v41
    v_fmac_f32 v6, v8, v153
    v_fmac_f32 v7, v9, v153
    v_lshlrev_b32 v8, 16, v42
    v_and_b32 v9, 0xffff0000, v42
    v_fmac_f32 v6, v8, v154
    v_fmac_f32 v7, v9, v154
    v_lshlrev_b32 v8, 16, v43
    v_and_b32 v9, 0xffff0000, v43
    v_fmac_f32 v6, v8, v155
    v_fmac_f32 v7, v9, v155
    v_lshlrev_b32 v8, 16, v44
    v_and_b32 v9, 0xffff0000, v44
    v_fmac_f32 v6, v8, v156
    v_fmac_f32 v7, v9, v156
    v_lshlrev_b32 v8, 16, v45
    v_and_b32 v9, 0xffff0000, v45
    v_fmac_f32 v6, v8, v157
    v_fmac_f32 v7, v9, v157
    v_lshlrev_b32 v8, 16, v46
    v_and_b32 v9, 0xffff0000, v46
    v_fmac_f32 v6, v8, v158
    v_fmac_f32 v7, v9, v158
    v_lshlrev_b32 v8, 16, v47
    v_and_b32 v9, 0xffff0000, v47
    v_fmac_f32 v6, v8, v159
    v_fmac_f32 v7, v9, v159
    v_lshlrev_b32 v8, 16, v48
    v_and_b32 v9, 0xffff0000, v48
    v_fmac_f32 v6, v8, v160
    v_fmac_f32 v7, v9, v160
    v_lshlrev_b32 v8, 16, v49
    v_and_b32 v9, 0xffff0000, v49
    v_fmac_f32 v6, v8, v161
    v_fmac_f32 v7, v9, v161
    v_lshlrev_b32 v8, 16, v50
    v_and_b32 v9, 0xffff0000, v50
    v_fmac_f32 v6, v8, v162
    v_fmac_f32 v7, v9, v162
    v_lshlrev_b32 v8, 16, v51
    v_and_b32 v9, 0xffff0000, v51
    v_fmac_f32 v6, v8, v163
    v_fmac_f32 v7, v9, v163
    v_lshlrev_b32 v8, 16, v52
    v_and_b32 v9, 0xffff0000, v52
    v_fmac_f32 v6, v8, v164
    v_fmac_f32 v7, v9, v164
    v_lshlrev_b32 v8, 16, v53
    v_and_b32 v9, 0xffff0000, v53
    v_fmac_f32 v6, v8, v165
    v_fmac_f32 v7, v9, v165
    v_lshlrev_b32 v8, 16, v54
    v_and_b32 v9, 0xffff0000, v54
    v_fmac_f32 v6, v8, v166
    v_fmac_f32 v7, v9, v166
    v_lshlrev_b32 v8, 16, v55
    v_and_b32 v9, 0xffff0000, v55
    v_fmac_f32 v6, v8, v167
    v_fmac_f32 v7, v9, v167
    v_lshlrev_b32 v8, 16, v56
    v_and_b32 v9, 0xffff0000, v56
    v_fmac_f32 v6, v8, v168
    v_fmac_f32 v7, v9, v168
    v_lshlrev_b32 v8, 16, v57
    v_and_b32 v9, 0xffff0000, v57
    v_fmac_f32 v6, v8, v169
    v_fmac_f32 v7, v9, v169
    v_lshlrev_b32 v8, 16, v58
    v_and_b32 v9, 0xffff0000, v58
    v_fmac_f32 v6, v8, v170
    v_fmac_f32 v7, v9, v170
    v_lshlrev_b32 v8, 16, v59
    v_and_b32 v9, 0xffff0000, v59
    v_fmac_f32 v6, v8, v171
    v_fmac_f32 v7, v9, v171
    v_lshlrev_b32 v8, 16, v60
    v_and_b32 v9, 0xffff0000, v60
    v_fmac_f32 v6, v8, v172
    v_fmac_f32 v7, v9, v172
    v_lshlrev_b32 v8, 16, v61
    v_and_b32 v9, 0xffff0000, v61
    v_fmac_f32 v6, v8, v173
    v_fmac_f32 v7, v9, v173
    v_lshlrev_b32 v8, 16, v62
    v_and_b32 v9, 0xffff0000, v62
    v_fmac_f32 v6, v8, v174
    v_fmac_f32 v7, v9, v174
    v_lshlrev_b32 v8, 16, v63
    v_and_b32 v9, 0xffff0000, v63
    v_fmac_f32 v6, v8, v175
    v_fmac_f32 v7, v9, v175
    v_lshlrev_b32 v8, 16, v64
    v_and_b32 v9, 0xffff0000, v64
    v_fmac_f32 v6, v8, v176
    v_fmac_f32 v7, v9, v176
    v_lshlrev_b32 v8, 16, v65
    v_and_b32 v9, 0xffff0000, v65
    v_fmac_f32 v6, v8, v177
    v_fmac_f32 v7, v9, v177
    v_lshlrev_b32 v8, 16, v66
    v_and_b32 v9, 0xffff0000, v66
    v_fmac_f32 v6, v8, v178
    v_fmac_f32 v7, v9, v178
    v_lshlrev_b32 v8, 16, v67
    v_and_b32 v9, 0xffff0000, v67
    v_fmac_f32 v6, v8, v179
    v_fmac_f32 v7, v9, v179
    v_lshlrev_b32 v8, 16, v68
    v_and_b32 v9, 0xffff0000, v68
    v_fmac_f32 v6, v8, v180
    v_fmac_f32 v7, v9, v180
    v_lshlrev_b32 v8, 16, v69
    v_and_b32 v9, 0xffff0000, v69
    v_fmac_f32 v6, v8, v181
    v_fmac_f32 v7, v9, v181
    v_lshlrev_b32 v8, 16, v70
    v_and_b32 v9, 0xffff0000, v70
    v_fmac_f32 v6, v8, v182
    v_fmac_f32 v7, v9, v182
    v_lshlrev_b32 v8, 16, v71
    v_and_b32 v9, 0xffff0000, v71
    v_fmac_f32 v6, v8, v183
    v_fmac_f32 v7, v9, v183
    s_waitcnt vmcnt(0) lgkmcnt(0)
    v_lshlrev_b32 v8, 16, v72
    v_and_b32 v9, 0xffff0000, v72
    v_fmac_f32 v6, v8, v184
    v_fmac_f32 v7, v9, v184
    v_lshlrev_b32 v8, 16, v73
    v_and_b32 v9, 0xffff0000, v73
    v_fmac_f32 v6, v8, v185
    v_fmac_f32 v7, v9, v185
    v_lshlrev_b32 v8, 16, v74
    v_and_b32 v9, 0xffff0000, v74
    v_fmac_f32 v6, v8, v186
    v_fmac_f32 v7, v9, v186
    v_lshlrev_b32 v8, 16, v75
    v_and_b32 v9, 0xffff0000, v75
    v_fmac_f32 v6, v8, v187
    v_fmac_f32 v7, v9, v187
    v_lshlrev_b32 v8, 16, v76
    v_and_b32 v9, 0xffff0000, v76
    v_fmac_f32 v6, v8, v188
    v_fmac_f32 v7, v9, v188
    v_lshlrev_b32 v8, 16, v77
    v_and_b32 v9, 0xffff0000, v77
    v_fmac_f32 v6, v8, v189
    v_fmac_f32 v7, v9, v189
    v_lshlrev_b32 v8, 16, v78
    v_and_b32 v9, 0xffff0000, v78
    v_fmac_f32 v6, v8, v190
    v_fmac_f32 v7, v9, v190
    v_lshlrev_b32 v8, 16, v79
    v_and_b32 v9, 0xffff0000, v79
    v_fmac_f32 v6, v8, v191
    v_fmac_f32 v7, v9, v191
    v_lshlrev_b32 v8, 16, v80
    v_and_b32 v9, 0xffff0000, v80
    v_fmac_f32 v6, v8, v192
    v_fmac_f32 v7, v9, v192
    v_lshlrev_b32 v8, 16, v81
    v_and_b32 v9, 0xffff0000, v81
    v_fmac_f32 v6, v8, v193
    v_fmac_f32 v7, v9, v193
    v_lshlrev_b32 v8, 16, v82
    v_and_b32 v9, 0xffff0000, v82
    v_fmac_f32 v6, v8, v194
    v_fmac_f32 v7, v9, v194
    v_lshlrev_b32 v8, 16, v83
    v_and_b32 v9, 0xffff0000, v83
    v_fmac_f32 v6, v8, v195
    v_fmac_f32 v7, v9, v195
    v_lshlrev_b32 v8, 16, v84
    v_and_b32 v9, 0xffff0000, v84
    v_fmac_f32 v6, v8, v196
    v_fmac_f32 v7, v9, v196
    v_lshlrev_b32 v8, 16, v85
    v_and_b32 v9, 0xffff0000, v85
    v_fmac_f32 v6, v8, v197
    v_fmac_f32 v7, v9, v197
    v_lshlrev_b32 v8, 16, v86
    v_and_b32 v9, 0xffff0000, v86
    v_fmac_f32 v6, v8, v198
    v_fmac_f32 v7, v9, v198
    v_lshlrev_b32 v8, 16, v87
    v_and_b32 v9, 0xffff0000, v87
    v_fmac_f32 v6, v8, v199
    v_fmac_f32 v7, v9, v199
    v_lshlrev_b32 v8, 16, v88
    v_and_b32 v9, 0xffff0000, v88
    v_fmac_f32 v6, v8, v200
    v_fmac_f32 v7, v9, v200
    v_lshlrev_b32 v8, 16, v89
    v_and_b32 v9, 0xffff0000, v89
    v_fmac_f32 v6, v8, v201
    v_fmac_f32 v7, v9, v201
    v_lshlrev_b32 v8, 16, v90
    v_and_b32 v9, 0xffff0000, v90
    v_fmac_f32 v6, v8, v202
    v_fmac_f32 v7, v9, v202
    v_lshlrev_b32 v8, 16, v91
    v_and_b32 v9, 0xffff0000, v91
    v_fmac_f32 v6, v8, v203
    v_fmac_f32 v7, v9, v203
    v_lshlrev_b32 v8, 16, v92
    v_and_b32 v9, 0xffff0000, v92
    v_fmac_f32 v6, v8, v204
    v_fmac_f32 v7, v9, v204
    v_lshlrev_b32 v8, 16, v93
    v_and_b32 v9, 0xffff0000, v93
    v_fmac_f32 v6, v8, v205
    v_fmac_f32 v7, v9, v205
    v_lshlrev_b32 v8, 16, v94
    v_and_b32 v9, 0xffff0000, v94
    v_fmac_f32 v6, v8, v206
    v_fmac_f32 v7, v9, v206
    v_lshlrev_b32 v8, 16, v95
    v_and_b32 v9, 0xffff0000, v95
    v_fmac_f32 v6, v8, v207
    v_fmac_f32 v7, v9, v207
    v_lshlrev_b32 v8, 16, v96
    v_and_b32 v9, 0xffff0000, v96
    v_fmac_f32 v6, v8, v208
    v_fmac_f32 v7, v9, v208
    v_lshlrev_b32 v8, 16, v97
    v_and_b32 v9, 0xffff0000, v97
    v_fmac_f32 v6, v8, v209
    v_fmac_f32 v7, v9, v209
    v_lshlrev_b32 v8, 16, v98
    v_and_b32 v9, 0xffff0000, v98
    v_fmac_f32 v6, v8, v210
    v_fmac_f32 v7, v9, v210
    v_lshlrev_b32 v8, 16, v99
    v_and_b32 v9, 0xffff0000, v99
    v_fmac_f32 v6, v8, v211
    v_fmac_f32 v7, v9, v211
    v_lshlrev_b32 v8, 16, v100
    v_and_b32 v9, 0xffff0000, v100
    v_fmac_f32 v6, v8, v212
    v_fmac_f32 v7, v9, v212
    v_lshlrev_b32 v8, 16, v101
    v_and_b32 v9, 0xffff0000, v101
    v_fmac_f32 v6, v8, v213
    v_fmac_f32 v7, v9, v213
    v_lshlrev_b32 v8, 16, v102
    v_and_b32 v9, 0xffff0000, v102
    v_fmac_f32 v6, v8, v214
    v_fmac_f32 v7, v9, v214
    v_lshlrev_b32 v8, 16, v103
    v_and_b32 v9, 0xffff0000, v103
    v_fmac_f32 v6, v8, v215
    v_fmac_f32 v7, v9, v215
    v_lshlrev_b32 v8, 16, v104
    v_and_b32 v9, 0xffff0000, v104
    v_fmac_f32 v6, v8, v216
    v_fmac_f32 v7, v9, v216
    v_lshlrev_b32 v8, 16, v105
    v_and_b32 v9, 0xffff0000, v105
    v_fmac_f32 v6, v8, v217
    v_fmac_f32 v7, v9, v217
    v_lshlrev_b32 v8, 16, v106
    v_and_b32 v9, 0xffff0000, v106
    v_fmac_f32 v6, v8, v218
    v_fmac_f32 v7, v9, v218
    v_lshlrev_b32 v8, 16, v107
    v_and_b32 v9, 0xffff0000, v107
    v_fmac_f32 v6, v8, v219
    v_fmac_f32 v7, v9, v219
    v_lshlrev_b32 v8, 16, v108
    v_and_b32 v9, 0xffff0000, v108
    v_fmac_f32 v6, v8, v220
    v_fmac_f32 v7, v9, v220
    v_lshlrev_b32 v8, 16, v109
    v_and_b32 v9, 0xffff0000, v109
    v_fmac_f32 v6, v8, v221
    v_fmac_f32 v7, v9, v221
    v_lshlrev_b32 v8, 16, v110
    v_and_b32 v9, 0xffff0000, v110
    v_fmac_f32 v6, v8, v222
    v_fmac_f32 v7, v9, v222
    v_lshlrev_b32 v8, 16, v111
    v_and_b32 v9, 0xffff0000, v111
    v_fmac_f32 v6, v8, v223
    v_fmac_f32 v7, v9, v223
    v_lshlrev_b32 v8, 16, v112
    v_and_b32 v9, 0xffff0000, v112
    v_fmac_f32 v6, v8, v224
    v_fmac_f32 v7, v9, v224
    v_lshlrev_b32 v8, 16, v113
    v_and_b32 v9, 0xffff0000, v113
    v_fmac_f32 v6, v8, v225
    v_fmac_f32 v7, v9, v225
    v_lshlrev_b32 v8, 16, v114
    v_and_b32 v9, 0xffff0000, v114
    v_fmac_f32 v6, v8, v226
    v_fmac_f32 v7, v9, v226
    v_lshlrev_b32 v8, 16, v115
    v_and_b32 v9, 0xffff0000, v115
    v_fmac_f32 v6, v8, v227
    v_fmac_f32 v7, v9, v227
    v_lshlrev_b32 v8, 16, v116
    v_and_b32 v9, 0xffff0000, v116
    v_fmac_f32 v6, v8, v228
    v_fmac_f32 v7, v9, v228
    v_lshlrev_b32 v8, 16, v117
    v_and_b32 v9, 0xffff0000, v117
    v_fmac_f32 v6, v8, v229
    v_fmac_f32 v7, v9, v229
    v_lshlrev_b32 v8, 16, v118
    v_and_b32 v9, 0xffff0000, v118
    v_fmac_f32 v6, v8, v230
    v_fmac_f32 v7, v9, v230
    v_lshlrev_b32 v8, 16, v119
    v_and_b32 v9, 0xffff0000, v119
    v_fmac_f32 v6, v8, v231
    v_fmac_f32 v7, v9, v231
    v_lshlrev_b32 v8, 16, v120
    v_and_b32 v9, 0xffff0000, v120
    v_fmac_f32 v6, v8, v232
    v_fmac_f32 v7, v9, v232
    v_lshlrev_b32 v8, 16, v121
    v_and_b32 v9, 0xffff0000, v121
    v_fmac_f32 v6, v8, v233
    v_fmac_f32 v7, v9, v233
    v_lshlrev_b32 v8, 16, v122
    v_and_b32 v9, 0xffff0000, v122
    v_fmac_f32 v6, v8, v234
    v_fmac_f32 v7, v9, v234
    v_lshlrev_b32 v8, 16, v123
    v_and_b32 v9, 0xffff0000, v123
    v_fmac_f32 v6, v8, v235
    v_fmac_f32 v7, v9, v235
    v_lshlrev_b32 v8, 16, v124
    v_and_b32 v9, 0xffff0000, v124
    v_fmac_f32 v6, v8, v236
    v_fmac_f32 v7, v9, v236
    v_lshlrev_b32 v8, 16, v125
    v_and_b32 v9, 0xffff0000, v125
    v_fmac_f32 v6, v8, v237
    v_fmac_f32 v7, v9, v237
    v_lshlrev_b32 v8, 16, v126
    v_and_b32 v9, 0xffff0000, v126
    v_fmac_f32 v6, v8, v238
    v_fmac_f32 v7, v9, v238
    v_lshlrev_b32 v8, 16, v127
    v_and_b32 v9, 0xffff0000, v127
    v_fmac_f32 v6, v8, v239
    v_fmac_f32 v7, v9, v239
    s_lshl_b32 s27, s24, 9
    v_lshlrev_b32 v8, 3, v1
    v_add_u32 v9, s27, v8
    ds_write_b64 v9, v[6:7] offset:2048
    s_waitcnt lgkmcnt(0)
    s_barrier
    s_cmp_lg_u32 s24, 0
    s_cbranch_scc1 .prep_end_1
    ds_read_b64 v[16:17], v8 offset:2048
    ds_read_b64 v[18:19], v8 offset:2560
    ds_read_b64 v[20:21], v8 offset:3072
    ds_read_b64 v[22:23], v8 offset:3584
    s_waitcnt lgkmcnt(0)
    v_add_f32 v16, v16, v18
    v_add_f32 v20, v20, v22
    v_add_f32 v16, v16, v20
    v_add_f32 v17, v17, v19
    v_add_f32 v21, v21, v23
    v_add_f32 v17, v17, v21
    v_cvt_pk_bf16_f32 v16, v16, v17
    v_and_b32 v17, 0xffff0000, v16
    v_lshlrev_b32 v16, 16, v16
    s_lshr_b32 s25, s25, 1
    v_lshlrev_b32 v10, 1, v1
    v_add_u32 v10, s25, v10
    v_add_f32 v18, 1.0, v16
    v_add_f32 v19, 1.0, v17
    v_cvt_pk_bf16_f32 v18, v18, v19
    v_and_b32 v19, 0xffff0000, v18
    v_lshlrev_b32 v18, 16, v18
    v_subrev_u32 v11, 448, v10
    v_subrev_u32 v12, 1792, v10
    v_min_u32 v11, v11, v12
    v_cmp_gt_u32 vcc, 448, v11
    s_nop 1
    v_cndmask_b32 v16, v16, v18, vcc
    v_cndmask_b32 v17, v17, v19, vcc
    v_lshlrev_b32 v10, 2, v10
    global_store_dwordx2 v10, v[16:17], s[20:21] offset:0
    s_branch .prep_end_1
.prep_3:
    s_sub_u32 s25, s2, 21
    s_lshl_b32 s25, s25, 2
    s_add_u32 s25, s25, s24
    s_mul_i32 s26, s25, 1338
    s_lshr_b32 s26, s26, 16
    s_mul_i32 s29, s26, 49
    s_sub_u32 s29, s25, s29
    s_mul_i32 s27, s29, 9363
    s_lshr_b32 s27, s27, 16
    s_mul_i32 s30, s27, 7
    s_sub_u32 s28, s29, s30
    s_lshl_b32 s31, s27, 19
    s_lshl_b32 s32, s26, 9
    s_add_u32 s31, s31, s32
    v_lshlrev_b32 v4, 13, v2
    v_lshl_add_u32 v4, v3, 4, v4
    v_add_u32 v4, s31, v4
    v_add_u32 v5, 0x20000, v4
    v_add_u32 v6, 0x40000, v4
    v_add_u32 v7, 0x60000, v4
    s_lshl_b32 s31, s28, 19
    s_lshl_b32 s32, s26, 9
    s_add_u32 s31, s31, s32
    v_lshlrev_b32 v8, 13, v2
    v_lshl_add_u32 v8, v3, 4, v8
    v_add_u32 v8, s31, v8
    v_add_u32 v9, 0x20000, v8
    v_add_u32 v10, 0x40000, v8
    v_add_u32 v11, 0x60000, v8
    global_load_dwordx4 v[80:83], v4, s[4:5] offset:0
    global_load_dwordx4 v[84:87], v5, s[4:5] offset:0
    global_load_dwordx4 v[88:91], v6, s[4:5] offset:0
    global_load_dwordx4 v[92:95], v7, s[4:5] offset:0
    global_load_dwordx4 v[96:99], v8, s[6:7] offset:0
    global_load_dwordx4 v[100:103], v9, s[6:7] offset:0
    global_load_dwordx4 v[104:107], v10, s[6:7] offset:0
    global_load_dwordx4 v[108:111], v11, s[6:7] offset:0
    global_load_dwordx4 v[112:115], v4, s[4:5] offset:64
    global_load_dwordx4 v[116:119], v5, s[4:5] offset:64
    global_load_dwordx4 v[120:123], v6, s[4:5] offset:64
    global_load_dwordx4 v[124:127], v7, s[4:5] offset:64
    global_load_dwordx4 v[128:131], v8, s[6:7] offset:64
    global_load_dwordx4 v[132:135], v9, s[6:7] offset:64
    global_load_dwordx4 v[136:139], v10, s[6:7] offset:64
    global_load_dwordx4 v[140:143], v11, s[6:7] offset:64
    global_load_dwordx4 v[144:147], v4, s[4:5] offset:128
    global_load_dwordx4 v[148:151], v5, s[4:5] offset:128
    global_load_dwordx4 v[152:155], v6, s[4:5] offset:128
    global_load_dwordx4 v[156:159], v7, s[4:5] offset:128
    global_load_dwordx4 v[160:163], v8, s[6:7] offset:128
    global_load_dwordx4 v[164:167], v9, s[6:7] offset:128
    global_load_dwordx4 v[168:171], v10, s[6:7] offset:128
    global_load_dwordx4 v[172:175], v11, s[6:7] offset:128
    global_load_dwordx4 v[176:179], v4, s[4:5] offset:192
    global_load_dwordx4 v[180:183], v5, s[4:5] offset:192
    global_load_dwordx4 v[184:187], v6, s[4:5] offset:192
    global_load_dwordx4 v[188:191], v7, s[4:5] offset:192
    global_load_dwordx4 v[192:195], v8, s[6:7] offset:192
    global_load_dwordx4 v[196:199], v9, s[6:7] offset:192
    global_load_dwordx4 v[200:203], v10, s[6:7] offset:192
    global_load_dwordx4 v[204:207], v11, s[6:7] offset:192
    s_waitcnt vmcnt(24)
    v_mfma_f32_16x16x32_bf16 v[16:19], v[80:83], v[96:99], 0
    v_mfma_f32_16x16x32_bf16 v[20:23], v[80:83], v[100:103], 0
    v_mfma_f32_16x16x32_bf16 v[24:27], v[80:83], v[104:107], 0
    v_mfma_f32_16x16x32_bf16 v[28:31], v[80:83], v[108:111], 0
    v_mfma_f32_16x16x32_bf16 v[32:35], v[84:87], v[96:99], 0
    v_mfma_f32_16x16x32_bf16 v[36:39], v[84:87], v[100:103], 0
    v_mfma_f32_16x16x32_bf16 v[40:43], v[84:87], v[104:107], 0
    v_mfma_f32_16x16x32_bf16 v[44:47], v[84:87], v[108:111], 0
    v_mfma_f32_16x16x32_bf16 v[48:51], v[88:91], v[96:99], 0
    v_mfma_f32_16x16x32_bf16 v[52:55], v[88:91], v[100:103], 0
    v_mfma_f32_16x16x32_bf16 v[56:59], v[88:91], v[104:107], 0
    v_mfma_f32_16x16x32_bf16 v[60:63], v[88:91], v[108:111], 0
    v_mfma_f32_16x16x32_bf16 v[64:67], v[92:95], v[96:99], 0
    v_mfma_f32_16x16x32_bf16 v[68:71], v[92:95], v[100:103], 0
    v_mfma_f32_16x16x32_bf16 v[72:75], v[92:95], v[104:107], 0
    v_mfma_f32_16x16x32_bf16 v[76:79], v[92:95], v[108:111], 0
    global_load_dwordx4 v[80:83], v4, s[4:5] offset:256
    global_load_dwordx4 v[84:87], v5, s[4:5] offset:256
    global_load_dwordx4 v[88:91], v6, s[4:5] offset:256
    global_load_dwordx4 v[92:95], v7, s[4:5] offset:256
    global_load_dwordx4 v[96:99], v8, s[6:7] offset:256
    global_load_dwordx4 v[100:103], v9, s[6:7] offset:256
    global_load_dwordx4 v[104:107], v10, s[6:7] offset:256
    global_load_dwordx4 v[108:111], v11, s[6:7] offset:256
    s_waitcnt vmcnt(24)
    v_mfma_f32_16x16x32_bf16 v[16:19], v[112:115], v[128:131], v[16:19]
    v_mfma_f32_16x16x32_bf16 v[20:23], v[112:115], v[132:135], v[20:23]
    v_mfma_f32_16x16x32_bf16 v[24:27], v[112:115], v[136:139], v[24:27]
    v_mfma_f32_16x16x32_bf16 v[28:31], v[112:115], v[140:143], v[28:31]
    v_mfma_f32_16x16x32_bf16 v[32:35], v[116:119], v[128:131], v[32:35]
    v_mfma_f32_16x16x32_bf16 v[36:39], v[116:119], v[132:135], v[36:39]
    v_mfma_f32_16x16x32_bf16 v[40:43], v[116:119], v[136:139], v[40:43]
    v_mfma_f32_16x16x32_bf16 v[44:47], v[116:119], v[140:143], v[44:47]
    v_mfma_f32_16x16x32_bf16 v[48:51], v[120:123], v[128:131], v[48:51]
    v_mfma_f32_16x16x32_bf16 v[52:55], v[120:123], v[132:135], v[52:55]
    v_mfma_f32_16x16x32_bf16 v[56:59], v[120:123], v[136:139], v[56:59]
    v_mfma_f32_16x16x32_bf16 v[60:63], v[120:123], v[140:143], v[60:63]
    v_mfma_f32_16x16x32_bf16 v[64:67], v[124:127], v[128:131], v[64:67]
    v_mfma_f32_16x16x32_bf16 v[68:71], v[124:127], v[132:135], v[68:71]
    v_mfma_f32_16x16x32_bf16 v[72:75], v[124:127], v[136:139], v[72:75]
    v_mfma_f32_16x16x32_bf16 v[76:79], v[124:127], v[140:143], v[76:79]
    global_load_dwordx4 v[112:115], v4, s[4:5] offset:320
    global_load_dwordx4 v[116:119], v5, s[4:5] offset:320
    global_load_dwordx4 v[120:123], v6, s[4:5] offset:320
    global_load_dwordx4 v[124:127], v7, s[4:5] offset:320
    global_load_dwordx4 v[128:131], v8, s[6:7] offset:320
    global_load_dwordx4 v[132:135], v9, s[6:7] offset:320
    global_load_dwordx4 v[136:139], v10, s[6:7] offset:320
    global_load_dwordx4 v[140:143], v11, s[6:7] offset:320
    s_waitcnt vmcnt(24)
    v_mfma_f32_16x16x32_bf16 v[16:19], v[144:147], v[160:163], v[16:19]
    v_mfma_f32_16x16x32_bf16 v[20:23], v[144:147], v[164:167], v[20:23]
    v_mfma_f32_16x16x32_bf16 v[24:27], v[144:147], v[168:171], v[24:27]
    v_mfma_f32_16x16x32_bf16 v[28:31], v[144:147], v[172:175], v[28:31]
    v_mfma_f32_16x16x32_bf16 v[32:35], v[148:151], v[160:163], v[32:35]
    v_mfma_f32_16x16x32_bf16 v[36:39], v[148:151], v[164:167], v[36:39]
    v_mfma_f32_16x16x32_bf16 v[40:43], v[148:151], v[168:171], v[40:43]
    v_mfma_f32_16x16x32_bf16 v[44:47], v[148:151], v[172:175], v[44:47]
    v_mfma_f32_16x16x32_bf16 v[48:51], v[152:155], v[160:163], v[48:51]
    v_mfma_f32_16x16x32_bf16 v[52:55], v[152:155], v[164:167], v[52:55]
    v_mfma_f32_16x16x32_bf16 v[56:59], v[152:155], v[168:171], v[56:59]
    v_mfma_f32_16x16x32_bf16 v[60:63], v[152:155], v[172:175], v[60:63]
    v_mfma_f32_16x16x32_bf16 v[64:67], v[156:159], v[160:163], v[64:67]
    v_mfma_f32_16x16x32_bf16 v[68:71], v[156:159], v[164:167], v[68:71]
    v_mfma_f32_16x16x32_bf16 v[72:75], v[156:159], v[168:171], v[72:75]
    v_mfma_f32_16x16x32_bf16 v[76:79], v[156:159], v[172:175], v[76:79]
    global_load_dwordx4 v[144:147], v4, s[4:5] offset:384
    global_load_dwordx4 v[148:151], v5, s[4:5] offset:384
    global_load_dwordx4 v[152:155], v6, s[4:5] offset:384
    global_load_dwordx4 v[156:159], v7, s[4:5] offset:384
    global_load_dwordx4 v[160:163], v8, s[6:7] offset:384
    global_load_dwordx4 v[164:167], v9, s[6:7] offset:384
    global_load_dwordx4 v[168:171], v10, s[6:7] offset:384
    global_load_dwordx4 v[172:175], v11, s[6:7] offset:384
    s_waitcnt vmcnt(24)
    v_mfma_f32_16x16x32_bf16 v[16:19], v[176:179], v[192:195], v[16:19]
    v_mfma_f32_16x16x32_bf16 v[20:23], v[176:179], v[196:199], v[20:23]
    v_mfma_f32_16x16x32_bf16 v[24:27], v[176:179], v[200:203], v[24:27]
    v_mfma_f32_16x16x32_bf16 v[28:31], v[176:179], v[204:207], v[28:31]
    v_mfma_f32_16x16x32_bf16 v[32:35], v[180:183], v[192:195], v[32:35]
    v_mfma_f32_16x16x32_bf16 v[36:39], v[180:183], v[196:199], v[36:39]
    v_mfma_f32_16x16x32_bf16 v[40:43], v[180:183], v[200:203], v[40:43]
    v_mfma_f32_16x16x32_bf16 v[44:47], v[180:183], v[204:207], v[44:47]
    v_mfma_f32_16x16x32_bf16 v[48:51], v[184:187], v[192:195], v[48:51]
    v_mfma_f32_16x16x32_bf16 v[52:55], v[184:187], v[196:199], v[52:55]
    v_mfma_f32_16x16x32_bf16 v[56:59], v[184:187], v[200:203], v[56:59]
    v_mfma_f32_16x16x32_bf16 v[60:63], v[184:187], v[204:207], v[60:63]
    v_mfma_f32_16x16x32_bf16 v[64:67], v[188:191], v[192:195], v[64:67]
    v_mfma_f32_16x16x32_bf16 v[68:71], v[188:191], v[196:199], v[68:71]
    v_mfma_f32_16x16x32_bf16 v[72:75], v[188:191], v[200:203], v[72:75]
    v_mfma_f32_16x16x32_bf16 v[76:79], v[188:191], v[204:207], v[76:79]
    global_load_dwordx4 v[176:179], v4, s[4:5] offset:448
    global_load_dwordx4 v[180:183], v5, s[4:5] offset:448
    global_load_dwordx4 v[184:187], v6, s[4:5] offset:448
    global_load_dwordx4 v[188:191], v7, s[4:5] offset:448
    global_load_dwordx4 v[192:195], v8, s[6:7] offset:448
    global_load_dwordx4 v[196:199], v9, s[6:7] offset:448
    global_load_dwordx4 v[200:203], v10, s[6:7] offset:448
    global_load_dwordx4 v[204:207], v11, s[6:7] offset:448
    s_waitcnt vmcnt(24)
    v_mfma_f32_16x16x32_bf16 v[16:19], v[80:83], v[96:99], v[16:19]
    v_mfma_f32_16x16x32_bf16 v[20:23], v[80:83], v[100:103], v[20:23]
    v_mfma_f32_16x16x32_bf16 v[24:27], v[80:83], v[104:107], v[24:27]
    v_mfma_f32_16x16x32_bf16 v[28:31], v[80:83], v[108:111], v[28:31]
    v_mfma_f32_16x16x32_bf16 v[32:35], v[84:87], v[96:99], v[32:35]
    v_mfma_f32_16x16x32_bf16 v[36:39], v[84:87], v[100:103], v[36:39]
    v_mfma_f32_16x16x32_bf16 v[40:43], v[84:87], v[104:107], v[40:43]
    v_mfma_f32_16x16x32_bf16 v[44:47], v[84:87], v[108:111], v[44:47]
    v_mfma_f32_16x16x32_bf16 v[48:51], v[88:91], v[96:99], v[48:51]
    v_mfma_f32_16x16x32_bf16 v[52:55], v[88:91], v[100:103], v[52:55]
    v_mfma_f32_16x16x32_bf16 v[56:59], v[88:91], v[104:107], v[56:59]
    v_mfma_f32_16x16x32_bf16 v[60:63], v[88:91], v[108:111], v[60:63]
    v_mfma_f32_16x16x32_bf16 v[64:67], v[92:95], v[96:99], v[64:67]
    v_mfma_f32_16x16x32_bf16 v[68:71], v[92:95], v[100:103], v[68:71]
    v_mfma_f32_16x16x32_bf16 v[72:75], v[92:95], v[104:107], v[72:75]
    v_mfma_f32_16x16x32_bf16 v[76:79], v[92:95], v[108:111], v[76:79]
    s_waitcnt vmcnt(16)
    v_mfma_f32_16x16x32_bf16 v[16:19], v[112:115], v[128:131], v[16:19]
    v_mfma_f32_16x16x32_bf16 v[20:23], v[112:115], v[132:135], v[20:23]
    v_mfma_f32_16x16x32_bf16 v[24:27], v[112:115], v[136:139], v[24:27]
    v_mfma_f32_16x16x32_bf16 v[28:31], v[112:115], v[140:143], v[28:31]
    v_mfma_f32_16x16x32_bf16 v[32:35], v[116:119], v[128:131], v[32:35]
    v_mfma_f32_16x16x32_bf16 v[36:39], v[116:119], v[132:135], v[36:39]
    v_mfma_f32_16x16x32_bf16 v[40:43], v[116:119], v[136:139], v[40:43]
    v_mfma_f32_16x16x32_bf16 v[44:47], v[116:119], v[140:143], v[44:47]
    v_mfma_f32_16x16x32_bf16 v[48:51], v[120:123], v[128:131], v[48:51]
    v_mfma_f32_16x16x32_bf16 v[52:55], v[120:123], v[132:135], v[52:55]
    v_mfma_f32_16x16x32_bf16 v[56:59], v[120:123], v[136:139], v[56:59]
    v_mfma_f32_16x16x32_bf16 v[60:63], v[120:123], v[140:143], v[60:63]
    v_mfma_f32_16x16x32_bf16 v[64:67], v[124:127], v[128:131], v[64:67]
    v_mfma_f32_16x16x32_bf16 v[68:71], v[124:127], v[132:135], v[68:71]
    v_mfma_f32_16x16x32_bf16 v[72:75], v[124:127], v[136:139], v[72:75]
    v_mfma_f32_16x16x32_bf16 v[76:79], v[124:127], v[140:143], v[76:79]
    s_waitcnt vmcnt(8)
    v_mfma_f32_16x16x32_bf16 v[16:19], v[144:147], v[160:163], v[16:19]
    v_mfma_f32_16x16x32_bf16 v[20:23], v[144:147], v[164:167], v[20:23]
    v_mfma_f32_16x16x32_bf16 v[24:27], v[144:147], v[168:171], v[24:27]
    v_mfma_f32_16x16x32_bf16 v[28:31], v[144:147], v[172:175], v[28:31]
    v_mfma_f32_16x16x32_bf16 v[32:35], v[148:151], v[160:163], v[32:35]
    v_mfma_f32_16x16x32_bf16 v[36:39], v[148:151], v[164:167], v[36:39]
    v_mfma_f32_16x16x32_bf16 v[40:43], v[148:151], v[168:171], v[40:43]
    v_mfma_f32_16x16x32_bf16 v[44:47], v[148:151], v[172:175], v[44:47]
    v_mfma_f32_16x16x32_bf16 v[48:51], v[152:155], v[160:163], v[48:51]
    v_mfma_f32_16x16x32_bf16 v[52:55], v[152:155], v[164:167], v[52:55]
    v_mfma_f32_16x16x32_bf16 v[56:59], v[152:155], v[168:171], v[56:59]
    v_mfma_f32_16x16x32_bf16 v[60:63], v[152:155], v[172:175], v[60:63]
    v_mfma_f32_16x16x32_bf16 v[64:67], v[156:159], v[160:163], v[64:67]
    v_mfma_f32_16x16x32_bf16 v[68:71], v[156:159], v[164:167], v[68:71]
    v_mfma_f32_16x16x32_bf16 v[72:75], v[156:159], v[168:171], v[72:75]
    v_mfma_f32_16x16x32_bf16 v[76:79], v[156:159], v[172:175], v[76:79]
    s_waitcnt vmcnt(0)
    v_mfma_f32_16x16x32_bf16 v[16:19], v[176:179], v[192:195], v[16:19]
    v_mfma_f32_16x16x32_bf16 v[20:23], v[176:179], v[196:199], v[20:23]
    v_mfma_f32_16x16x32_bf16 v[24:27], v[176:179], v[200:203], v[24:27]
    v_mfma_f32_16x16x32_bf16 v[28:31], v[176:179], v[204:207], v[28:31]
    v_mfma_f32_16x16x32_bf16 v[32:35], v[180:183], v[192:195], v[32:35]
    v_mfma_f32_16x16x32_bf16 v[36:39], v[180:183], v[196:199], v[36:39]
    v_mfma_f32_16x16x32_bf16 v[40:43], v[180:183], v[200:203], v[40:43]
    v_mfma_f32_16x16x32_bf16 v[44:47], v[180:183], v[204:207], v[44:47]
    v_mfma_f32_16x16x32_bf16 v[48:51], v[184:187], v[192:195], v[48:51]
    v_mfma_f32_16x16x32_bf16 v[52:55], v[184:187], v[196:199], v[52:55]
    v_mfma_f32_16x16x32_bf16 v[56:59], v[184:187], v[200:203], v[56:59]
    v_mfma_f32_16x16x32_bf16 v[60:63], v[184:187], v[204:207], v[60:63]
    v_mfma_f32_16x16x32_bf16 v[64:67], v[188:191], v[192:195], v[64:67]
    v_mfma_f32_16x16x32_bf16 v[68:71], v[188:191], v[196:199], v[68:71]
    v_mfma_f32_16x16x32_bf16 v[72:75], v[188:191], v[200:203], v[72:75]
    v_mfma_f32_16x16x32_bf16 v[76:79], v[188:191], v[204:207], v[76:79]
    s_mul_i32 s31, s26, 28
    s_lshl_b32 s32, s28, 2
    s_add_u32 s31, s31, s32
    s_mul_i32 s31, s31, 14
    s_lshl_b32 s32, s27, 1
    s_add_u32 s31, s31, s32
    s_lshl_b32 s31, s31, 10
    s_add_u32 s31, s31, 0x600000
    v_lshlrev_b32 v12, 4, v2
    v_lshrrev_b32 v13, 1, v3
    v_lshl_add_u32 v12, v13, 8, v12
    v_and_b32 v13, 1, v3
    v_lshl_add_u32 v12, v13, 3, v12
    v_add_u32 v12, s31, v12
    s_nop 7
    v_mul_f32 v16, 0x3d800000, v16
    v_mul_f32 v17, 0x3d800000, v17
    v_mul_f32 v18, 0x3d800000, v18
    v_mul_f32 v19, 0x3d800000, v19
    v_cvt_pk_bf16_f32 v16, v16, v17
    v_cvt_pk_bf16_f32 v17, v18, v19
    global_store_dwordx2 v12, v[16:17], s[20:21] offset:0
    v_mul_f32 v32, 0x3d800000, v32
    v_mul_f32 v33, 0x3d800000, v33
    v_mul_f32 v34, 0x3d800000, v34
    v_mul_f32 v35, 0x3d800000, v35
    v_cvt_pk_bf16_f32 v32, v32, v33
    v_cvt_pk_bf16_f32 v33, v34, v35
    global_store_dwordx2 v12, v[32:33], s[20:21] offset:512
    v_mul_f32 v48, 0x3d800000, v48
    v_mul_f32 v49, 0x3d800000, v49
    v_mul_f32 v50, 0x3d800000, v50
    v_mul_f32 v51, 0x3d800000, v51
    v_cvt_pk_bf16_f32 v48, v48, v49
    v_cvt_pk_bf16_f32 v49, v50, v51
    global_store_dwordx2 v12, v[48:49], s[20:21] offset:1024
    v_mul_f32 v64, 0x3d800000, v64
    v_mul_f32 v65, 0x3d800000, v65
    v_mul_f32 v66, 0x3d800000, v66
    v_mul_f32 v67, 0x3d800000, v67
    v_cvt_pk_bf16_f32 v64, v64, v65
    v_cvt_pk_bf16_f32 v65, v66, v67
    global_store_dwordx2 v12, v[64:65], s[20:21] offset:1536
    v_add_u32 v12, 14336, v12
    v_mul_f32 v20, 0x3d800000, v20
    v_mul_f32 v21, 0x3d800000, v21
    v_mul_f32 v22, 0x3d800000, v22
    v_mul_f32 v23, 0x3d800000, v23
    v_cvt_pk_bf16_f32 v20, v20, v21
    v_cvt_pk_bf16_f32 v21, v22, v23
    global_store_dwordx2 v12, v[20:21], s[20:21] offset:0
    v_mul_f32 v36, 0x3d800000, v36
    v_mul_f32 v37, 0x3d800000, v37
    v_mul_f32 v38, 0x3d800000, v38
    v_mul_f32 v39, 0x3d800000, v39
    v_cvt_pk_bf16_f32 v36, v36, v37
    v_cvt_pk_bf16_f32 v37, v38, v39
    global_store_dwordx2 v12, v[36:37], s[20:21] offset:512
    v_mul_f32 v52, 0x3d800000, v52
    v_mul_f32 v53, 0x3d800000, v53
    v_mul_f32 v54, 0x3d800000, v54
    v_mul_f32 v55, 0x3d800000, v55
    v_cvt_pk_bf16_f32 v52, v52, v53
    v_cvt_pk_bf16_f32 v53, v54, v55
    global_store_dwordx2 v12, v[52:53], s[20:21] offset:1024
    v_mul_f32 v68, 0x3d800000, v68
    v_mul_f32 v69, 0x3d800000, v69
    v_mul_f32 v70, 0x3d800000, v70
    v_mul_f32 v71, 0x3d800000, v71
    v_cvt_pk_bf16_f32 v68, v68, v69
    v_cvt_pk_bf16_f32 v69, v70, v71
    global_store_dwordx2 v12, v[68:69], s[20:21] offset:1536
    v_add_u32 v12, 14336, v12
    v_mul_f32 v24, 0x3d800000, v24
    v_mul_f32 v25, 0x3d800000, v25
    v_mul_f32 v26, 0x3d800000, v26
    v_mul_f32 v27, 0x3d800000, v27
    v_cvt_pk_bf16_f32 v24, v24, v25
    v_cvt_pk_bf16_f32 v25, v26, v27
    global_store_dwordx2 v12, v[24:25], s[20:21] offset:0
    v_mul_f32 v40, 0x3d800000, v40
    v_mul_f32 v41, 0x3d800000, v41
    v_mul_f32 v42, 0x3d800000, v42
    v_mul_f32 v43, 0x3d800000, v43
    v_cvt_pk_bf16_f32 v40, v40, v41
    v_cvt_pk_bf16_f32 v41, v42, v43
    global_store_dwordx2 v12, v[40:41], s[20:21] offset:512
    v_mul_f32 v56, 0x3d800000, v56
    v_mul_f32 v57, 0x3d800000, v57
    v_mul_f32 v58, 0x3d800000, v58
    v_mul_f32 v59, 0x3d800000, v59
    v_cvt_pk_bf16_f32 v56, v56, v57
    v_cvt_pk_bf16_f32 v57, v58, v59
    global_store_dwordx2 v12, v[56:57], s[20:21] offset:1024
    v_mul_f32 v72, 0x3d800000, v72
    v_mul_f32 v73, 0x3d800000, v73
    v_mul_f32 v74, 0x3d800000, v74
    v_mul_f32 v75, 0x3d800000, v75
    v_cvt_pk_bf16_f32 v72, v72, v73
    v_cvt_pk_bf16_f32 v73, v74, v75
    global_store_dwordx2 v12, v[72:73], s[20:21] offset:1536
    v_add_u32 v12, 14336, v12
    v_mul_f32 v28, 0x3d800000, v28
    v_mul_f32 v29, 0x3d800000, v29
    v_mul_f32 v30, 0x3d800000, v30
    v_mul_f32 v31, 0x3d800000, v31
    v_cvt_pk_bf16_f32 v28, v28, v29
    v_cvt_pk_bf16_f32 v29, v30, v31
    global_store_dwordx2 v12, v[28:29], s[20:21] offset:0
    v_mul_f32 v44, 0x3d800000, v44
    v_mul_f32 v45, 0x3d800000, v45
    v_mul_f32 v46, 0x3d800000, v46
    v_mul_f32 v47, 0x3d800000, v47
    v_cvt_pk_bf16_f32 v44, v44, v45
    v_cvt_pk_bf16_f32 v45, v46, v47
    global_store_dwordx2 v12, v[44:45], s[20:21] offset:512
    v_mul_f32 v60, 0x3d800000, v60
    v_mul_f32 v61, 0x3d800000, v61
    v_mul_f32 v62, 0x3d800000, v62
    v_mul_f32 v63, 0x3d800000, v63
    v_cvt_pk_bf16_f32 v60, v60, v61
    v_cvt_pk_bf16_f32 v61, v62, v63
    global_store_dwordx2 v12, v[60:61], s[20:21] offset:1024
    v_mul_f32 v76, 0x3d800000, v76
    v_mul_f32 v77, 0x3d800000, v77
    v_mul_f32 v78, 0x3d800000, v78
    v_mul_f32 v79, 0x3d800000, v79
    v_cvt_pk_bf16_f32 v76, v76, v77
    v_cvt_pk_bf16_f32 v77, v78, v79
    global_store_dwordx2 v12, v[76:77], s[20:21] offset:1536
    s_branch .prep_end_1
.prep_4:
    s_sub_u32 s25, s2, 217
    s_lshl_b32 s25, s25, 4
    s_lshl_b32 s26, s24, 2
    s_add_u32 s25, s25, s26
    s_mov_b32 s33, 7168
    v_mul_lo_u32 v4, v3, s33
    v_lshl_add_u32 v4, v2, 1, v4
    v_lshlrev_b32 v5, 4, v1
    s_add_u32 s26, s25, 0
    s_and_b32 s28, s26, 7
    s_lshr_b32 s27, s26, 3
    s_mul_i32 s30, s27, 2341
    s_lshr_b32 s30, s30, 16
    s_mul_i32 s31, s30, 28
    s_sub_u32 s27, s27, s31
    s_mul_i32 s29, s30, 229376
    s_mul_i32 s28, s28, 28672
    s_add_u32 s29, s29, s28
    s_lshl_b32 s27, s27, 5
    s_add_u32 s29, s29, s27
    v_add_u32 v6, s29, v4
    global_load_ushort v48, v6, s[10:11]
    v_add_u32 v6, 896, v6
    global_load_ushort v49, v6, s[10:11]
    v_add_u32 v6, 896, v6
    global_load_ushort v50, v6, s[10:11]
    v_add_u32 v6, 896, v6
    global_load_ushort v51, v6, s[10:11]
    v_add_u32 v6, 896, v6
    global_load_ushort v52, v6, s[10:11]
    v_add_u32 v6, 896, v6
    global_load_ushort v53, v6, s[10:11]
    v_add_u32 v6, 896, v6
    global_load_ushort v54, v6, s[10:11]
    v_add_u32 v6, 896, v6
    global_load_ushort v55, v6, s[10:11]
    s_add_u32 s26, s25, 1
    s_and_b32 s28, s26, 7
    s_lshr_b32 s27, s26, 3
    s_mul_i32 s30, s27, 2341
    s_lshr_b32 s30, s30, 16
    s_mul_i32 s31, s30, 28
    s_sub_u32 s27, s27, s31
    s_mul_i32 s29, s30, 229376
    s_mul_i32 s28, s28, 28672
    s_add_u32 s29, s29, s28
    s_lshl_b32 s27, s27, 5
    s_add_u32 s29, s29, s27
    v_add_u32 v6, s29, v4
    global_load_ushort v56, v6, s[10:11]
    v_add_u32 v6, 896, v6
    global_load_ushort v57, v6, s[10:11]
    v_add_u32 v6, 896, v6
    global_load_ushort v58, v6, s[10:11]
    v_add_u32 v6, 896, v6
    global_load_ushort v59, v6, s[10:11]
    v_add_u32 v6, 896, v6
    global_load_ushort v60, v6, s[10:11]
    v_add_u32 v6, 896, v6
    global_load_ushort v61, v6, s[10:11]
    v_add_u32 v6, 896, v6
    global_load_ushort v62, v6, s[10:11]
    v_add_u32 v6, 896, v6
    global_load_ushort v63, v6, s[10:11]
    s_add_u32 s26, s25, 2
    s_and_b32 s28, s26, 7
    s_lshr_b32 s27, s26, 3
    s_mul_i32 s30, s27, 2341
    s_lshr_b32 s30, s30, 16
    s_mul_i32 s31, s30, 28
    s_sub_u32 s27, s27, s31
    s_mul_i32 s29, s30, 229376
    s_mul_i32 s28, s28, 28672
    s_add_u32 s29, s29, s28
    s_lshl_b32 s27, s27, 5
    s_add_u32 s29, s29, s27
    v_add_u32 v6, s29, v4
    global_load_ushort v64, v6, s[10:11]
    v_add_u32 v6, 896, v6
    global_load_ushort v65, v6, s[10:11]
    v_add_u32 v6, 896, v6
    global_load_ushort v66, v6, s[10:11]
    v_add_u32 v6, 896, v6
    global_load_ushort v67, v6, s[10:11]
    v_add_u32 v6, 896, v6
    global_load_ushort v68, v6, s[10:11]
    v_add_u32 v6, 896, v6
    global_load_ushort v69, v6, s[10:11]
    v_add_u32 v6, 896, v6
    global_load_ushort v70, v6, s[10:11]
    v_add_u32 v6, 896, v6
    global_load_ushort v71, v6, s[10:11]
    s_add_u32 s26, s25, 3
    s_and_b32 s28, s26, 7
    s_lshr_b32 s27, s26, 3
    s_mul_i32 s30, s27, 2341
    s_lshr_b32 s30, s30, 16
    s_mul_i32 s31, s30, 28
    s_sub_u32 s27, s27, s31
    s_mul_i32 s29, s30, 229376
    s_mul_i32 s28, s28, 28672
    s_add_u32 s29, s29, s28
    s_lshl_b32 s27, s27, 5
    s_add_u32 s29, s29, s27
    v_add_u32 v6, s29, v4
    global_load_ushort v72, v6, s[10:11]
    v_add_u32 v6, 896, v6
    global_load_ushort v73, v6, s[10:11]
    v_add_u32 v6, 896, v6
    global_load_ushort v74, v6, s[10:11]
    v_add_u32 v6, 896, v6
    global_load_ushort v75, v6, s[10:11]
    v_add_u32 v6, 896, v6
    global_load_ushort v76, v6, s[10:11]
    v_add_u32 v6, 896, v6
    global_load_ushort v77, v6, s[10:11]
    v_add_u32 v6, 896, v6
    global_load_ushort v78, v6, s[10:11]
    v_add_u32 v6, 896, v6
    global_load_ushort v79, v6, s[10:11]
    s_waitcnt vmcnt(0)
    v_lshl_or_b32 v16, v49, 16, v48
    v_lshl_or_b32 v17, v51, 16, v50
    v_lshl_or_b32 v18, v53, 16, v52
    v_lshl_or_b32 v19, v55, 16, v54
    v_lshl_or_b32 v20, v57, 16, v56
    v_lshl_or_b32 v21, v59, 16, v58
    v_lshl_or_b32 v22, v61, 16, v60
    v_lshl_or_b32 v23, v63, 16, v62
    v_lshl_or_b32 v24, v65, 16, v64
    v_lshl_or_b32 v25, v67, 16, v66
    v_lshl_or_b32 v26, v69, 16, v68
    v_lshl_or_b32 v27, v71, 16, v70
    v_lshl_or_b32 v28, v73, 16, v72
    v_lshl_or_b32 v29, v75, 16, v74
    v_lshl_or_b32 v30, v77, 16, v76
    v_lshl_or_b32 v31, v79, 16, v78
    s_add_u32 s26, s25, 0
    s_lshl_b32 s26, s26, 10
    s_add_u32 s26, s26, 0x7a00000
    v_add_u32 v6, s26, v5
    global_store_dwordx4 v6, v[16:19], s[20:21]
    s_add_u32 s26, s25, 1
    s_lshl_b32 s26, s26, 10
    s_add_u32 s26, s26, 0x7a00000
    v_add_u32 v6, s26, v5
    global_store_dwordx4 v6, v[20:23], s[20:21]
    s_add_u32 s26, s25, 2
    s_lshl_b32 s26, s26, 10
    s_add_u32 s26, s26, 0x7a00000
    v_add_u32 v6, s26, v5
    global_store_dwordx4 v6, v[24:27], s[20:21]
    s_add_u32 s26, s25, 3
    s_lshl_b32 s26, s26, 10
    s_add_u32 s26, s26, 0x7a00000
    v_add_u32 v6, s26, v5
    global_store_dwordx4 v6, v[28:31], s[20:21]
    s_branch .prep_end_1
.prep_5:
    s_sub_u32 s25, s2, 441
    s_lshl_b32 s25, s25, 4
    s_lshl_b32 s26, s24, 2
    s_add_u32 s25, s25, s26
    s_mov_b32 s33, 28672
    v_mul_lo_u32 v4, v3, s33
    v_lshl_add_u32 v4, v2, 1, v4
    v_lshlrev_b32 v5, 4, v1
    s_add_u32 s26, s25, 0
    s_mul_i32 s27, s26, 4682
    s_lshr_b32 s27, s27, 16
    s_mul_i32 s28, s27, 14
    s_sub_u32 s28, s26, s28
    s_mul_i32 s29, s28, 114688
    s_lshl_b32 s30, s27, 5
    s_add_u32 s29, s29, s30
    v_add_u32 v6, s29, v4
    global_load_ushort v48, v6, s[12:13]
    v_add_u32 v6, 3584, v6
    global_load_ushort v49, v6, s[12:13]
    v_add_u32 v6, 3584, v6
    global_load_ushort v50, v6, s[12:13]
    v_add_u32 v6, 3584, v6
    global_load_ushort v51, v6, s[12:13]
    v_add_u32 v6, 3584, v6
    global_load_ushort v52, v6, s[12:13]
    v_add_u32 v6, 3584, v6
    global_load_ushort v53, v6, s[12:13]
    v_add_u32 v6, 3584, v6
    global_load_ushort v54, v6, s[12:13]
    v_add_u32 v6, 3584, v6
    global_load_ushort v55, v6, s[12:13]
    s_add_u32 s26, s25, 1
    s_mul_i32 s27, s26, 4682
    s_lshr_b32 s27, s27, 16
    s_mul_i32 s28, s27, 14
    s_sub_u32 s28, s26, s28
    s_mul_i32 s29, s28, 114688
    s_lshl_b32 s30, s27, 5
    s_add_u32 s29, s29, s30
    v_add_u32 v6, s29, v4
    global_load_ushort v56, v6, s[12:13]
    v_add_u32 v6, 3584, v6
    global_load_ushort v57, v6, s[12:13]
    v_add_u32 v6, 3584, v6
    global_load_ushort v58, v6, s[12:13]
    v_add_u32 v6, 3584, v6
    global_load_ushort v59, v6, s[12:13]
    v_add_u32 v6, 3584, v6
    global_load_ushort v60, v6, s[12:13]
    v_add_u32 v6, 3584, v6
    global_load_ushort v61, v6, s[12:13]
    v_add_u32 v6, 3584, v6
    global_load_ushort v62, v6, s[12:13]
    v_add_u32 v6, 3584, v6
    global_load_ushort v63, v6, s[12:13]
    s_add_u32 s26, s25, 2
    s_mul_i32 s27, s26, 4682
    s_lshr_b32 s27, s27, 16
    s_mul_i32 s28, s27, 14
    s_sub_u32 s28, s26, s28
    s_mul_i32 s29, s28, 114688
    s_lshl_b32 s30, s27, 5
    s_add_u32 s29, s29, s30
    v_add_u32 v6, s29, v4
    global_load_ushort v64, v6, s[12:13]
    v_add_u32 v6, 3584, v6
    global_load_ushort v65, v6, s[12:13]
    v_add_u32 v6, 3584, v6
    global_load_ushort v66, v6, s[12:13]
    v_add_u32 v6, 3584, v6
    global_load_ushort v67, v6, s[12:13]
    v_add_u32 v6, 3584, v6
    global_load_ushort v68, v6, s[12:13]
    v_add_u32 v6, 3584, v6
    global_load_ushort v69, v6, s[12:13]
    v_add_u32 v6, 3584, v6
    global_load_ushort v70, v6, s[12:13]
    v_add_u32 v6, 3584, v6
    global_load_ushort v71, v6, s[12:13]
    s_add_u32 s26, s25, 3
    s_mul_i32 s27, s26, 4682
    s_lshr_b32 s27, s27, 16
    s_mul_i32 s28, s27, 14
    s_sub_u32 s28, s26, s28
    s_mul_i32 s29, s28, 114688
    s_lshl_b32 s30, s27, 5
    s_add_u32 s29, s29, s30
    v_add_u32 v6, s29, v4
    global_load_ushort v72, v6, s[12:13]
    v_add_u32 v6, 3584, v6
    global_load_ushort v73, v6, s[12:13]
    v_add_u32 v6, 3584, v6
    global_load_ushort v74, v6, s[12:13]
    v_add_u32 v6, 3584, v6
    global_load_ushort v75, v6, s[12:13]
    v_add_u32 v6, 3584, v6
    global_load_ushort v76, v6, s[12:13]
    v_add_u32 v6, 3584, v6
    global_load_ushort v77, v6, s[12:13]
    v_add_u32 v6, 3584, v6
    global_load_ushort v78, v6, s[12:13]
    v_add_u32 v6, 3584, v6
    global_load_ushort v79, v6, s[12:13]
    s_waitcnt vmcnt(0)
    v_lshl_or_b32 v16, v49, 16, v48
    v_lshl_or_b32 v17, v51, 16, v50
    v_lshl_or_b32 v18, v53, 16, v52
    v_lshl_or_b32 v19, v55, 16, v54
    v_lshl_or_b32 v20, v57, 16, v56
    v_lshl_or_b32 v21, v59, 16, v58
    v_lshl_or_b32 v22, v61, 16, v60
    v_lshl_or_b32 v23, v63, 16, v62
    v_lshl_or_b32 v24, v65, 16, v64
    v_lshl_or_b32 v25, v67, 16, v66
    v_lshl_or_b32 v26, v69, 16, v68
    v_lshl_or_b32 v27, v71, 16, v70
    v_lshl_or_b32 v28, v73, 16, v72
    v_lshl_or_b32 v29, v75, 16, v74
    v_lshl_or_b32 v30, v77, 16, v76
    v_lshl_or_b32 v31, v79, 16, v78
    s_add_u32 s26, s25, 0
    s_lshl_b32 s26, s26, 10
    s_add_u32 s26, s26, 0x1400000
    v_add_u32 v6, s26, v5
    global_store_dwordx4 v6, v[16:19], s[20:21]
    s_add_u32 s26, s25, 1
    s_lshl_b32 s26, s26, 10
    s_add_u32 s26, s26, 0x1400000
    v_add_u32 v6, s26, v5
    global_store_dwordx4 v6, v[20:23], s[20:21]
    s_add_u32 s26, s25, 2
    s_lshl_b32 s26, s26, 10
    s_add_u32 s26, s26, 0x1400000
    v_add_u32 v6, s26, v5
    global_store_dwordx4 v6, v[24:27], s[20:21]
    s_add_u32 s26, s25, 3
    s_lshl_b32 s26, s26, 10
    s_add_u32 s26, s26, 0x1400000
    v_add_u32 v6, s26, v5
    global_store_dwordx4 v6, v[28:31], s[20:21]
    s_branch .prep_end_1
.prep_6:
    s_sub_u32 s25, s2, 539
    s_lshl_b32 s25, s25, 4
    s_lshl_b32 s26, s24, 2
    s_add_u32 s25, s25, s26
    s_mov_b32 s33, 3584
    v_mul_lo_u32 v4, v3, s33
    v_lshl_add_u32 v4, v2, 1, v4
    v_lshlrev_b32 v5, 4, v1
    s_add_u32 s26, s25, 0
    s_mul_i32 s27, s26, 1171
    s_lshr_b32 s27, s27, 16
    s_mul_i32 s28, s27, 56
    s_sub_u32 s28, s26, s28
    s_mul_i32 s29, s28, 28672
    s_lshl_b32 s30, s27, 5
    s_add_u32 s29, s29, s30
    v_add_u32 v6, s29, v4
    global_load_ushort v48, v6, s[14:15]
    v_add_u32 v6, 896, v6
    global_load_ushort v49, v6, s[14:15]
    v_add_u32 v6, 896, v6
    global_load_ushort v50, v6, s[14:15]
    v_add_u32 v6, 896, v6
    global_load_ushort v51, v6, s[14:15]
    v_add_u32 v6, 11648, v6
    global_load_ushort v52, v6, s[14:15]
    v_add_u32 v6, 896, v6
    global_load_ushort v53, v6, s[14:15]
    v_add_u32 v6, 896, v6
    global_load_ushort v54, v6, s[14:15]
    v_add_u32 v6, 896, v6
    global_load_ushort v55, v6, s[14:15]
    s_add_u32 s26, s25, 1
    s_mul_i32 s27, s26, 1171
    s_lshr_b32 s27, s27, 16
    s_mul_i32 s28, s27, 56
    s_sub_u32 s28, s26, s28
    s_mul_i32 s29, s28, 28672
    s_lshl_b32 s30, s27, 5
    s_add_u32 s29, s29, s30
    v_add_u32 v6, s29, v4
    global_load_ushort v56, v6, s[14:15]
    v_add_u32 v6, 896, v6
    global_load_ushort v57, v6, s[14:15]
    v_add_u32 v6, 896, v6
    global_load_ushort v58, v6, s[14:15]
    v_add_u32 v6, 896, v6
    global_load_ushort v59, v6, s[14:15]
    v_add_u32 v6, 11648, v6
    global_load_ushort v60, v6, s[14:15]
    v_add_u32 v6, 896, v6
    global_load_ushort v61, v6, s[14:15]
    v_add_u32 v6, 896, v6
    global_load_ushort v62, v6, s[14:15]
    v_add_u32 v6, 896, v6
    global_load_ushort v63, v6, s[14:15]
    s_add_u32 s26, s25, 2
    s_mul_i32 s27, s26, 1171
    s_lshr_b32 s27, s27, 16
    s_mul_i32 s28, s27, 56
    s_sub_u32 s28, s26, s28
    s_mul_i32 s29, s28, 28672
    s_lshl_b32 s30, s27, 5
    s_add_u32 s29, s29, s30
    v_add_u32 v6, s29, v4
    global_load_ushort v64, v6, s[14:15]
    v_add_u32 v6, 896, v6
    global_load_ushort v65, v6, s[14:15]
    v_add_u32 v6, 896, v6
    global_load_ushort v66, v6, s[14:15]
    v_add_u32 v6, 896, v6
    global_load_ushort v67, v6, s[14:15]
    v_add_u32 v6, 11648, v6
    global_load_ushort v68, v6, s[14:15]
    v_add_u32 v6, 896, v6
    global_load_ushort v69, v6, s[14:15]
    v_add_u32 v6, 896, v6
    global_load_ushort v70, v6, s[14:15]
    v_add_u32 v6, 896, v6
    global_load_ushort v71, v6, s[14:15]
    s_add_u32 s26, s25, 3
    s_mul_i32 s27, s26, 1171
    s_lshr_b32 s27, s27, 16
    s_mul_i32 s28, s27, 56
    s_sub_u32 s28, s26, s28
    s_mul_i32 s29, s28, 28672
    s_lshl_b32 s30, s27, 5
    s_add_u32 s29, s29, s30
    v_add_u32 v6, s29, v4
    global_load_ushort v72, v6, s[14:15]
    v_add_u32 v6, 896, v6
    global_load_ushort v73, v6, s[14:15]
    v_add_u32 v6, 896, v6
    global_load_ushort v74, v6, s[14:15]
    v_add_u32 v6, 896, v6
    global_load_ushort v75, v6, s[14:15]
    v_add_u32 v6, 11648, v6
    global_load_ushort v76, v6, s[14:15]
    v_add_u32 v6, 896, v6
    global_load_ushort v77, v6, s[14:15]
    v_add_u32 v6, 896, v6
    global_load_ushort v78, v6, s[14:15]
    v_add_u32 v6, 896, v6
    global_load_ushort v79, v6, s[14:15]
    s_waitcnt vmcnt(0)
    v_lshl_or_b32 v16, v49, 16, v48
    v_lshl_or_b32 v17, v51, 16, v50
    v_lshl_or_b32 v18, v53, 16, v52
    v_lshl_or_b32 v19, v55, 16, v54
    v_lshl_or_b32 v20, v57, 16, v56
    v_lshl_or_b32 v21, v59, 16, v58
    v_lshl_or_b32 v22, v61, 16, v60
    v_lshl_or_b32 v23, v63, 16, v62
    v_lshl_or_b32 v24, v65, 16, v64
    v_lshl_or_b32 v25, v67, 16, v66
    v_lshl_or_b32 v26, v69, 16, v68
    v_lshl_or_b32 v27, v71, 16, v70
    v_lshl_or_b32 v28, v73, 16, v72
    v_lshl_or_b32 v29, v75, 16, v74
    v_lshl_or_b32 v30, v77, 16, v76
    v_lshl_or_b32 v31, v79, 16, v78
    s_add_u32 s26, s25, 0
    s_lshl_b32 s26, s26, 10
    s_add_u32 s26, s26, 0x1600000
    v_add_u32 v6, s26, v5
    global_store_dwordx4 v6, v[16:19], s[20:21]
    s_add_u32 s26, s25, 1
    s_lshl_b32 s26, s26, 10
    s_add_u32 s26, s26, 0x1600000
    v_add_u32 v6, s26, v5
    global_store_dwordx4 v6, v[20:23], s[20:21]
    s_add_u32 s26, s25, 2
    s_lshl_b32 s26, s26, 10
    s_add_u32 s26, s26, 0x1600000
    v_add_u32 v6, s26, v5
    global_store_dwordx4 v6, v[24:27], s[20:21]
    s_add_u32 s26, s25, 3
    s_lshl_b32 s26, s26, 10
    s_add_u32 s26, s26, 0x1600000
    v_add_u32 v6, s26, v5
    global_store_dwordx4 v6, v[28:31], s[20:21]
    s_branch .prep_end_1
.prep_7:
    s_sub_u32 s25, s2, 637
    s_lshl_b32 s25, s25, 15
    s_add_u32 s25, s25, 0x11c00
    v_lshlrev_b32 v4, 4, v0
    v_add_u32 v4, s25, v4
    v_mov_b32 v8, -1
    v_mov_b32 v9, -1
    v_mov_b32 v10, -1
    v_mov_b32 v11, -1
    global_store_dwordx4 v4, v[8:11], s[20:21]
    v_add_u32 v4, 4096, v4
    global_store_dwordx4 v4, v[8:11], s[20:21]
    v_add_u32 v4, 4096, v4
    global_store_dwordx4 v4, v[8:11], s[20:21]
    v_add_u32 v4, 4096, v4
    global_store_dwordx4 v4, v[8:11], s[20:21]
    v_add_u32 v4, 4096, v4
    global_store_dwordx4 v4, v[8:11], s[20:21]
    v_add_u32 v4, 4096, v4
    global_store_dwordx4 v4, v[8:11], s[20:21]
    v_add_u32 v4, 4096, v4
    global_store_dwordx4 v4, v[8:11], s[20:21]
    v_add_u32 v4, 4096, v4
    global_store_dwordx4 v4, v[8:11], s[20:21]
    s_branch .prep_end_1
.prep_8:
    v_mov_b32 v12, 0
    v_mov_b32 v13, 0
    v_lshlrev_b32 v14, 3, v0
    v_add_u32 v14, 0x8000, v14
    global_store_dwordx2 v14, v[12:13], s[20:21]
    v_mov_b32 v4, v0
    v_and_b32 v5, 7, v4
    v_lshrrev_b32 v6, 3, v4
    s_mov_b32 s25, 896
    v_mul_lo_u32 v5, v5, s25
    v_lshl_add_u32 v5, v6, 4, v5
    global_load_dwordx4 v[8:11], v5, s[22:23]
    s_waitcnt vmcnt(0)
    v_min_u32 v8, 0xfffffffe, v8
    v_min_u32 v9, 0xfffffffe, v9
    v_min_u32 v10, 0xfffffffe, v10
    v_min_u32 v11, 0xfffffffe, v11
    v_lshlrev_b32 v4, 4, v4
    v_add_u32 v5, 0x10000, v4
    global_store_dwordx4 v5, v[8:11], s[20:21]
    v_add_u32 v5, 0x130000, v4
    global_store_dwordx4 v5, v[8:11], s[20:21]
    s_nop 1
    v_add_u32 v4, 256, v0
    v_min_u32 v4, 447, v4
    v_and_b32 v5, 7, v4
    v_lshrrev_b32 v6, 3, v4
    s_mov_b32 s25, 896
    v_mul_lo_u32 v5, v5, s25
    v_lshl_add_u32 v5, v6, 4, v5
    global_load_dwordx4 v[8:11], v5, s[22:23]
    s_waitcnt vmcnt(0)
    v_min_u32 v8, 0xfffffffe, v8
    v_min_u32 v9, 0xfffffffe, v9
    v_min_u32 v10, 0xfffffffe, v10
    v_min_u32 v11, 0xfffffffe, v11
    v_lshlrev_b32 v4, 4, v4
    v_add_u32 v5, 0x10000, v4
    global_store_dwordx4 v5, v[8:11], s[20:21]
    v_add_u32 v5, 0x130000, v4
    global_store_dwordx4 v5, v[8:11], s[20:21]
    s_nop 1
.prep_end_1:
    s_endpgm
.text
.globl pre2_kernel
.p2align 8
.type pre2_kernel,@function
pre2_kernel:
    s_load_dwordx2 s[4:5], s[0:1], 0
    s_load_dwordx2 s[6:7], s[0:1], 128
    s_load_dwordx2 s[8:9], s[0:1], 32
    s_load_dwordx2 s[20:21], s[0:1], 128
    s_waitcnt lgkmcnt(0)
    v_lshrrev_b32 v2, 6, v0
    s_nop 0
    v_readfirstlane_b32 s24, v2
    v_and_b32 v1, 63, v0
    v_and_b32 v2, 15, v1
    v_lshrrev_b32 v3, 4, v1
    s_cmp_ge_u32 s2, 708
    s_cbranch_scc1 .p2_end_10
    s_cmp_ge_u32 s2, 196
    s_cbranch_scc1 .p2_ln_11
    s_sub_u32 s25, s2, 0
    s_lshl_b32 s25, s25, 2
    s_add_u32 s25, s25, s24
    s_mul_i32 s26, s25, 1338
    s_lshr_b32 s26, s26, 16
    s_mul_i32 s29, s26, 49
    s_sub_u32 s29, s25, s29
    s_mul_i32 s27, s29, 9363
    s_lshr_b32 s27, s27, 16
    s_mul_i32 s30, s27, 7
    s_sub_u32 s28, s29, s30
    s_lshl_b32 s31, s27, 19
    s_lshl_b32 s32, s26, 9
    s_add_u32 s31, s31, s32
    v_lshlrev_b32 v4, 13, v2
    v_lshl_add_u32 v4, v3, 4, v4
    v_add_u32 v4, s31, v4
    v_add_u32 v5, 0x20000, v4
    v_add_u32 v6, 0x40000, v4
    v_add_u32 v7, 0x60000, v4
    s_mul_i32 s31, s26, 28
    s_lshl_b32 s32, s28, 2
    s_add_u32 s31, s31, s32
    s_lshl_b32 s31, s31, 13
    s_add_u32 s31, s31, 0x7a01000
    v_lshlrev_b32 v8, 4, v1
    v_add_u32 v8, s31, v8
    v_add_u32 v9, 8192, v8
    v_add_u32 v10, 16384, v8
    v_add_u32 v11, 24576, v8
    global_load_dwordx4 v[80:83], v4, s[8:9] offset:0
    global_load_dwordx4 v[84:87], v5, s[8:9] offset:0
    global_load_dwordx4 v[88:91], v6, s[8:9] offset:0
    global_load_dwordx4 v[92:95], v7, s[8:9] offset:0
    global_load_dwordx4 v[96:99], v8, s[20:21] offset:-4096
    global_load_dwordx4 v[100:103], v9, s[20:21] offset:-4096
    global_load_dwordx4 v[104:107], v10, s[20:21] offset:-4096
    global_load_dwordx4 v[108:111], v11, s[20:21] offset:-4096
    global_load_dwordx4 v[112:115], v4, s[8:9] offset:64
    global_load_dwordx4 v[116:119], v5, s[8:9] offset:64
    global_load_dwordx4 v[120:123], v6, s[8:9] offset:64
    global_load_dwordx4 v[124:127], v7, s[8:9] offset:64
    global_load_dwordx4 v[128:131], v8, s[20:21] offset:-3072
    global_load_dwordx4 v[132:135], v9, s[20:21] offset:-3072
    global_load_dwordx4 v[136:139], v10, s[20:21] offset:-3072
    global_load_dwordx4 v[140:143], v11, s[20:21] offset:-3072
    global_load_dwordx4 v[144:147], v4, s[8:9] offset:128
    global_load_dwordx4 v[148:151], v5, s[8:9] offset:128
    global_load_dwordx4 v[152:155], v6, s[8:9] offset:128
    global_load_dwordx4 v[156:159], v7, s[8:9] offset:128
    global_load_dwordx4 v[160:163], v8, s[20:21] offset:-2048
    global_load_dwordx4 v[164:167], v9, s[20:21] offset:-2048
    global_load_dwordx4 v[168:171], v10, s[20:21] offset:-2048
    global_load_dwordx4 v[172:175], v11, s[20:21] offset:-2048
    global_load_dwordx4 v[176:179], v4, s[8:9] offset:192
    global_load_dwordx4 v[180:183], v5, s[8:9] offset:192
    global_load_dwordx4 v[184:187], v6, s[8:9] offset:192
    global_load_dwordx4 v[188:191], v7, s[8:9] offset:192
    global_load_dwordx4 v[192:195], v8, s[20:21] offset:-1024
    global_load_dwordx4 v[196:199], v9, s[20:21] offset:-1024
    global_load_dwordx4 v[200:203], v10, s[20:21] offset:-1024
    global_load_dwordx4 v[204:207], v11, s[20:21] offset:-1024
    s_waitcnt vmcnt(24)
    v_mfma_f32_16x16x32_bf16 v[16:19], v[80:83], v[96:99], 0
    v_mfma_f32_16x16x32_bf16 v[20:23], v[80:83], v[100:103], 0
    v_mfma_f32_16x16x32_bf16 v[24:27], v[80:83], v[104:107], 0
    v_mfma_f32_16x16x32_bf16 v[28:31], v[80:83], v[108:111], 0
    v_mfma_f32_16x16x32_bf16 v[32:35], v[84:87], v[96:99], 0
    v_mfma_f32_16x16x32_bf16 v[36:39], v[84:87], v[100:103], 0
    v_mfma_f32_16x16x32_bf16 v[40:43], v[84:87], v[104:107], 0
    v_mfma_f32_16x16x32_bf16 v[44:47], v[84:87], v[108:111], 0
    v_mfma_f32_16x16x32_bf16 v[48:51], v[88:91], v[96:99], 0
    v_mfma_f32_16x16x32_bf16 v[52:55], v[88:91], v[100:103], 0
    v_mfma_f32_16x16x32_bf16 v[56:59], v[88:91], v[104:107], 0
    v_mfma_f32_16x16x32_bf16 v[60:63], v[88:91], v[108:111], 0
    v_mfma_f32_16x16x32_bf16 v[64:67], v[92:95], v[96:99], 0
    v_mfma_f32_16x16x32_bf16 v[68:71], v[92:95], v[100:103], 0
    v_mfma_f32_16x16x32_bf16 v[72:75], v[92:95], v[104:107], 0
    v_mfma_f32_16x16x32_bf16 v[76:79], v[92:95], v[108:111], 0
    global_load_dwordx4 v[80:83], v4, s[8:9] offset:256
    global_load_dwordx4 v[84:87], v5, s[8:9] offset:256
    global_load_dwordx4 v[88:91], v6, s[8:9] offset:256
    global_load_dwordx4 v[92:95], v7, s[8:9] offset:256
    global_load_dwordx4 v[96:99], v8, s[20:21] offset:0
    global_load_dwordx4 v[100:103], v9, s[20:21] offset:0
    global_load_dwordx4 v[104:107], v10, s[20:21] offset:0
    global_load_dwordx4 v[108:111], v11, s[20:21] offset:0
    s_waitcnt vmcnt(24)
    v_mfma_f32_16x16x32_bf16 v[16:19], v[112:115], v[128:131], v[16:19]
    v_mfma_f32_16x16x32_bf16 v[20:23], v[112:115], v[132:135], v[20:23]
    v_mfma_f32_16x16x32_bf16 v[24:27], v[112:115], v[136:139], v[24:27]
    v_mfma_f32_16x16x32_bf16 v[28:31], v[112:115], v[140:143], v[28:31]
    v_mfma_f32_16x16x32_bf16 v[32:35], v[116:119], v[128:131], v[32:35]
    v_mfma_f32_16x16x32_bf16 v[36:39], v[116:119], v[132:135], v[36:39]
    v_mfma_f32_16x16x32_bf16 v[40:43], v[116:119], v[136:139], v[40:43]
    v_mfma_f32_16x16x32_bf16 v[44:47], v[116:119], v[140:143], v[44:47]
    v_mfma_f32_16x16x32_bf16 v[48:51], v[120:123], v[128:131], v[48:51]
    v_mfma_f32_16x16x32_bf16 v[52:55], v[120:123], v[132:135], v[52:55]
    v_mfma_f32_16x16x32_bf16 v[56:59], v[120:123], v[136:139], v[56:59]
    v_mfma_f32_16x16x32_bf16 v[60:63], v[120:123], v[140:143], v[60:63]
    v_mfma_f32_16x16x32_bf16 v[64:67], v[124:127], v[128:131], v[64:67]
    v_mfma_f32_16x16x32_bf16 v[68:71], v[124:127], v[132:135], v[68:71]
    v_mfma_f32_16x16x32_bf16 v[72:75], v[124:127], v[136:139], v[72:75]
    v_mfma_f32_16x16x32_bf16 v[76:79], v[124:127], v[140:143], v[76:79]
    global_load_dwordx4 v[112:115], v4, s[8:9] offset:320
    global_load_dwordx4 v[116:119], v5, s[8:9] offset:320
    global_load_dwordx4 v[120:123], v6, s[8:9] offset:320
    global_load_dwordx4 v[124:127], v7, s[8:9] offset:320
    global_load_dwordx4 v[128:131], v8, s[20:21] offset:1024
    global_load_dwordx4 v[132:135], v9, s[20:21] offset:1024
    global_load_dwordx4 v[136:139], v10, s[20:21] offset:1024
    global_load_dwordx4 v[140:143], v11, s[20:21] offset:1024
    s_waitcnt vmcnt(24)
    v_mfma_f32_16x16x32_bf16 v[16:19], v[144:147], v[160:163], v[16:19]
    v_mfma_f32_16x16x32_bf16 v[20:23], v[144:147], v[164:167], v[20:23]
    v_mfma_f32_16x16x32_bf16 v[24:27], v[144:147], v[168:171], v[24:27]
    v_mfma_f32_16x16x32_bf16 v[28:31], v[144:147], v[172:175], v[28:31]
    v_mfma_f32_16x16x32_bf16 v[32:35], v[148:151], v[160:163], v[32:35]
    v_mfma_f32_16x16x32_bf16 v[36:39], v[148:151], v[164:167], v[36:39]
    v_mfma_f32_16x16x32_bf16 v[40:43], v[148:151], v[168:171], v[40:43]
    v_mfma_f32_16x16x32_bf16 v[44:47], v[148:151], v[172:175], v[44:47]
    v_mfma_f32_16x16x32_bf16 v[48:51], v[152:155], v[160:163], v[48:51]
    v_mfma_f32_16x16x32_bf16 v[52:55], v[152:155], v[164:167], v[52:55]
    v_mfma_f32_16x16x32_bf16 v[56:59], v[152:155], v[168:171], v[56:59]
    v_mfma_f32_16x16x32_bf16 v[60:63], v[152:155], v[172:175], v[60:63]
    v_mfma_f32_16x16x32_bf16 v[64:67], v[156:159], v[160:163], v[64:67]
    v_mfma_f32_16x16x32_bf16 v[68:71], v[156:159], v[164:167], v[68:71]
    v_mfma_f32_16x16x32_bf16 v[72:75], v[156:159], v[168:171], v[72:75]
    v_mfma_f32_16x16x32_bf16 v[76:79], v[156:159], v[172:175], v[76:79]
    global_load_dwordx4 v[144:147], v4, s[8:9] offset:384
    global_load_dwordx4 v[148:151], v5, s[8:9] offset:384
    global_load_dwordx4 v[152:155], v6, s[8:9] offset:384
    global_load_dwordx4 v[156:159], v7, s[8:9] offset:384
    global_load_dwordx4 v[160:163], v8, s[20:21] offset:2048
    global_load_dwordx4 v[164:167], v9, s[20:21] offset:2048
    global_load_dwordx4 v[168:171], v10, s[20:21] offset:2048
    global_load_dwordx4 v[172:175], v11, s[20:21] offset:2048
    s_waitcnt vmcnt(24)
    v_mfma_f32_16x16x32_bf16 v[16:19], v[176:179], v[192:195], v[16:19]
    v_mfma_f32_16x16x32_bf16 v[20:23], v[176:179], v[196:199], v[20:23]
    v_mfma_f32_16x16x32_bf16 v[24:27], v[176:179], v[200:203], v[24:27]
    v_mfma_f32_16x16x32_bf16 v[28:31], v[176:179], v[204:207], v[28:31]
    v_mfma_f32_16x16x32_bf16 v[32:35], v[180:183], v[192:195], v[32:35]
    v_mfma_f32_16x16x32_bf16 v[36:39], v[180:183], v[196:199], v[36:39]
    v_mfma_f32_16x16x32_bf16 v[40:43], v[180:183], v[200:203], v[40:43]
    v_mfma_f32_16x16x32_bf16 v[44:47], v[180:183], v[204:207], v[44:47]
    v_mfma_f32_16x16x32_bf16 v[48:51], v[184:187], v[192:195], v[48:51]
    v_mfma_f32_16x16x32_bf16 v[52:55], v[184:187], v[196:199], v[52:55]
    v_mfma_f32_16x16x32_bf16 v[56:59], v[184:187], v[200:203], v[56:59]
    v_mfma_f32_16x16x32_bf16 v[60:63], v[184:187], v[204:207], v[60:63]
    v_mfma_f32_16x16x32_bf16 v[64:67], v[188:191], v[192:195], v[64:67]
    v_mfma_f32_16x16x32_bf16 v[68:71], v[188:191], v[196:199], v[68:71]
    v_mfma_f32_16x16x32_bf16 v[72:75], v[188:191], v[200:203], v[72:75]
    v_mfma_f32_16x16x32_bf16 v[76:79], v[188:191], v[204:207], v[76:79]
    global_load_dwordx4 v[176:179], v4, s[8:9] offset:448
    global_load_dwordx4 v[180:183], v5, s[8:9] offset:448
    global_load_dwordx4 v[184:187], v6, s[8:9] offset:448
    global_load_dwordx4 v[188:191], v7, s[8:9] offset:448
    global_load_dwordx4 v[192:195], v8, s[20:21] offset:3072
    global_load_dwordx4 v[196:199], v9, s[20:21] offset:3072
    global_load_dwordx4 v[200:203], v10, s[20:21] offset:3072
    global_load_dwordx4 v[204:207], v11, s[20:21] offset:3072
    s_waitcnt vmcnt(24)
    v_mfma_f32_16x16x32_bf16 v[16:19], v[80:83], v[96:99], v[16:19]
    v_mfma_f32_16x16x32_bf16 v[20:23], v[80:83], v[100:103], v[20:23]
    v_mfma_f32_16x16x32_bf16 v[24:27], v[80:83], v[104:107], v[24:27]
    v_mfma_f32_16x16x32_bf16 v[28:31], v[80:83], v[108:111], v[28:31]
    v_mfma_f32_16x16x32_bf16 v[32:35], v[84:87], v[96:99], v[32:35]
    v_mfma_f32_16x16x32_bf16 v[36:39], v[84:87], v[100:103], v[36:39]
    v_mfma_f32_16x16x32_bf16 v[40:43], v[84:87], v[104:107], v[40:43]
    v_mfma_f32_16x16x32_bf16 v[44:47], v[84:87], v[108:111], v[44:47]
    v_mfma_f32_16x16x32_bf16 v[48:51], v[88:91], v[96:99], v[48:51]
    v_mfma_f32_16x16x32_bf16 v[52:55], v[88:91], v[100:103], v[52:55]
    v_mfma_f32_16x16x32_bf16 v[56:59], v[88:91], v[104:107], v[56:59]
    v_mfma_f32_16x16x32_bf16 v[60:63], v[88:91], v[108:111], v[60:63]
    v_mfma_f32_16x16x32_bf16 v[64:67], v[92:95], v[96:99], v[64:67]
    v_mfma_f32_16x16x32_bf16 v[68:71], v[92:95], v[100:103], v[68:71]
    v_mfma_f32_16x16x32_bf16 v[72:75], v[92:95], v[104:107], v[72:75]
    v_mfma_f32_16x16x32_bf16 v[76:79], v[92:95], v[108:111], v[76:79]
    s_waitcnt vmcnt(16)
    v_mfma_f32_16x16x32_bf16 v[16:19], v[112:115], v[128:131], v[16:19]
    v_mfma_f32_16x16x32_bf16 v[20:23], v[112:115], v[132:135], v[20:23]
    v_mfma_f32_16x16x32_bf16 v[24:27], v[112:115], v[136:139], v[24:27]
    v_mfma_f32_16x16x32_bf16 v[28:31], v[112:115], v[140:143], v[28:31]
    v_mfma_f32_16x16x32_bf16 v[32:35], v[116:119], v[128:131], v[32:35]
    v_mfma_f32_16x16x32_bf16 v[36:39], v[116:119], v[132:135], v[36:39]
    v_mfma_f32_16x16x32_bf16 v[40:43], v[116:119], v[136:139], v[40:43]
    v_mfma_f32_16x16x32_bf16 v[44:47], v[116:119], v[140:143], v[44:47]
    v_mfma_f32_16x16x32_bf16 v[48:51], v[120:123], v[128:131], v[48:51]
    v_mfma_f32_16x16x32_bf16 v[52:55], v[120:123], v[132:135], v[52:55]
    v_mfma_f32_16x16x32_bf16 v[56:59], v[120:123], v[136:139], v[56:59]
    v_mfma_f32_16x16x32_bf16 v[60:63], v[120:123], v[140:143], v[60:63]
    v_mfma_f32_16x16x32_bf16 v[64:67], v[124:127], v[128:131], v[64:67]
    v_mfma_f32_16x16x32_bf16 v[68:71], v[124:127], v[132:135], v[68:71]
    v_mfma_f32_16x16x32_bf16 v[72:75], v[124:127], v[136:139], v[72:75]
    v_mfma_f32_16x16x32_bf16 v[76:79], v[124:127], v[140:143], v[76:79]
    s_waitcnt vmcnt(8)
    v_mfma_f32_16x16x32_bf16 v[16:19], v[144:147], v[160:163], v[16:19]
    v_mfma_f32_16x16x32_bf16 v[20:23], v[144:147], v[164:167], v[20:23]
    v_mfma_f32_16x16x32_bf16 v[24:27], v[144:147], v[168:171], v[24:27]
    v_mfma_f32_16x16x32_bf16 v[28:31], v[144:147], v[172:175], v[28:31]
    v_mfma_f32_16x16x32_bf16 v[32:35], v[148:151], v[160:163], v[32:35]
    v_mfma_f32_16x16x32_bf16 v[36:39], v[148:151], v[164:167], v[36:39]
    v_mfma_f32_16x16x32_bf16 v[40:43], v[148:151], v[168:171], v[40:43]
    v_mfma_f32_16x16x32_bf16 v[44:47], v[148:151], v[172:175], v[44:47]
    v_mfma_f32_16x16x32_bf16 v[48:51], v[152:155], v[160:163], v[48:51]
    v_mfma_f32_16x16x32_bf16 v[52:55], v[152:155], v[164:167], v[52:55]
    v_mfma_f32_16x16x32_bf16 v[56:59], v[152:155], v[168:171], v[56:59]
    v_mfma_f32_16x16x32_bf16 v[60:63], v[152:155], v[172:175], v[60:63]
    v_mfma_f32_16x16x32_bf16 v[64:67], v[156:159], v[160:163], v[64:67]
    v_mfma_f32_16x16x32_bf16 v[68:71], v[156:159], v[164:167], v[68:71]
    v_mfma_f32_16x16x32_bf16 v[72:75], v[156:159], v[168:171], v[72:75]
    v_mfma_f32_16x16x32_bf16 v[76:79], v[156:159], v[172:175], v[76:79]
    s_waitcnt vmcnt(0)
    v_mfma_f32_16x16x32_bf16 v[16:19], v[176:179], v[192:195], v[16:19]
    v_mfma_f32_16x16x32_bf16 v[20:23], v[176:179], v[196:199], v[20:23]
    v_mfma_f32_16x16x32_bf16 v[24:27], v[176:179], v[200:203], v[24:27]
    v_mfma_f32_16x16x32_bf16 v[28:31], v[176:179], v[204:207], v[28:31]
    v_mfma_f32_16x16x32_bf16 v[32:35], v[180:183], v[192:195], v[32:35]
    v_mfma_f32_16x16x32_bf16 v[36:39], v[180:183], v[196:199], v[36:39]
    v_mfma_f32_16x16x32_bf16 v[40:43], v[180:183], v[200:203], v[40:43]
    v_mfma_f32_16x16x32_bf16 v[44:47], v[180:183], v[204:207], v[44:47]
    v_mfma_f32_16x16x32_bf16 v[48:51], v[184:187], v[192:195], v[48:51]
    v_mfma_f32_16x16x32_bf16 v[52:55], v[184:187], v[196:199], v[52:55]
    v_mfma_f32_16x16x32_bf16 v[56:59], v[184:187], v[200:203], v[56:59]
    v_mfma_f32_16x16x32_bf16 v[60:63], v[184:187], v[204:207], v[60:63]
    v_mfma_f32_16x16x32_bf16 v[64:67], v[188:191], v[192:195], v[64:67]
    v_mfma_f32_16x16x32_bf16 v[68:71], v[188:191], v[196:199], v[68:71]
    v_mfma_f32_16x16x32_bf16 v[72:75], v[188:191], v[200:203], v[72:75]
    v_mfma_f32_16x16x32_bf16 v[76:79], v[188:191], v[204:207], v[76:79]
    s_mul_i32 s31, s26, 28
    s_lshl_b32 s32, s28, 2
    s_add_u32 s31, s31, s32
    s_mul_i32 s31, s31, 14
    s_lshl_b32 s32, s27, 1
    s_add_u32 s31, s31, s32
    s_lshl_b32 s31, s31, 10
    s_add_u32 s31, s31, 0xd00000
    v_lshlrev_b32 v12, 4, v2
    v_lshrrev_b32 v13, 1, v3
    v_lshl_add_u32 v12, v13, 8, v12
    v_and_b32 v13, 1, v3
    v_lshl_add_u32 v12, v13, 3, v12
    v_add_u32 v12, s31, v12
    s_nop 7
    v_cvt_pk_bf16_f32 v16, v16, v17
    v_cvt_pk_bf16_f32 v17, v18, v19
    global_store_dwordx2 v12, v[16:17], s[20:21] offset:0
    v_cvt_pk_bf16_f32 v32, v32, v33
    v_cvt_pk_bf16_f32 v33, v34, v35
    global_store_dwordx2 v12, v[32:33], s[20:21] offset:512
    v_cvt_pk_bf16_f32 v48, v48, v49
    v_cvt_pk_bf16_f32 v49, v50, v51
    global_store_dwordx2 v12, v[48:49], s[20:21] offset:1024
    v_cvt_pk_bf16_f32 v64, v64, v65
    v_cvt_pk_bf16_f32 v65, v66, v67
    global_store_dwordx2 v12, v[64:65], s[20:21] offset:1536
    v_add_u32 v12, 14336, v12
    v_cvt_pk_bf16_f32 v20, v20, v21
    v_cvt_pk_bf16_f32 v21, v22, v23
    global_store_dwordx2 v12, v[20:21], s[20:21] offset:0
    v_cvt_pk_bf16_f32 v36, v36, v37
    v_cvt_pk_bf16_f32 v37, v38, v39
    global_store_dwordx2 v12, v[36:37], s[20:21] offset:512
    v_cvt_pk_bf16_f32 v52, v52, v53
    v_cvt_pk_bf16_f32 v53, v54, v55
    global_store_dwordx2 v12, v[52:53], s[20:21] offset:1024
    v_cvt_pk_bf16_f32 v68, v68, v69
    v_cvt_pk_bf16_f32 v69, v70, v71
    global_store_dwordx2 v12, v[68:69], s[20:21] offset:1536
    v_add_u32 v12, 14336, v12
    v_cvt_pk_bf16_f32 v24, v24, v25
    v_cvt_pk_bf16_f32 v25, v26, v27
    global_store_dwordx2 v12, v[24:25], s[20:21] offset:0
    v_cvt_pk_bf16_f32 v40, v40, v41
    v_cvt_pk_bf16_f32 v41, v42, v43
    global_store_dwordx2 v12, v[40:41], s[20:21] offset:512
    v_cvt_pk_bf16_f32 v56, v56, v57
    v_cvt_pk_bf16_f32 v57, v58, v59
    global_store_dwordx2 v12, v[56:57], s[20:21] offset:1024
    v_cvt_pk_bf16_f32 v72, v72, v73
    v_cvt_pk_bf16_f32 v73, v74, v75
    global_store_dwordx2 v12, v[72:73], s[20:21] offset:1536
    v_add_u32 v12, 14336, v12
    v_cvt_pk_bf16_f32 v28, v28, v29
    v_cvt_pk_bf16_f32 v29, v30, v31
    global_store_dwordx2 v12, v[28:29], s[20:21] offset:0
    v_cvt_pk_bf16_f32 v44, v44, v45
    v_cvt_pk_bf16_f32 v45, v46, v47
    global_store_dwordx2 v12, v[44:45], s[20:21] offset:512
    v_cvt_pk_bf16_f32 v60, v60, v61
    v_cvt_pk_bf16_f32 v61, v62, v63
    global_store_dwordx2 v12, v[60:61], s[20:21] offset:1024
    v_cvt_pk_bf16_f32 v76, v76, v77
    v_cvt_pk_bf16_f32 v77, v78, v79
    global_store_dwordx2 v12, v[76:77], s[20:21] offset:1536
    s_branch .p2_end_10
.p2_ln_11:
    s_sub_u32 s9, s2, 196
    s_lshl_b32 s9, s9, 2
    s_add_u32 s9, s9, s24
    v_min_u32 v4, 55, v1
    v_cmp_gt_u32 s[22:23], 56, v1
    s_mul_i32 s10, s9, 896
    v_lshlrev_b32 v5, 4, v4
    v_add_u32 v5, s10, v5
    global_load_dwordx4 v[8:11], v5, s[4:5]
    v_lshlrev_b32 v6, 5, v4
    global_load_dwordx4 v[24:27], v6, s[6:7]
    global_load_dwordx4 v[28:31], v6, s[6:7] offset:16
    global_load_dwordx4 v[32:35], v6, s[6:7] offset:1792
    global_load_dwordx4 v[36:39], v6, s[6:7] offset:1808
    s_waitcnt vmcnt(0)
    v_lshlrev_b32 v16, 16, v8
    v_and_b32 v17, 0xffff0000, v8
    v_lshlrev_b32 v18, 16, v9
    v_and_b32 v19, 0xffff0000, v9
    v_lshlrev_b32 v20, 16, v10
    v_and_b32 v21, 0xffff0000, v10
    v_lshlrev_b32 v22, 16, v11
    v_and_b32 v23, 0xffff0000, v11
    v_add_f32 v12, v16, v17
    v_add_f32 v12, v12, v18
    v_add_f32 v12, v12, v19
    v_add_f32 v12, v12, v20
    v_add_f32 v12, v12, v21
    v_add_f32 v12, v12, v22
    v_add_f32 v12, v12, v23
    v_cndmask_b32 v12, 0, v12, s[22:23]
    s_nop 1
    v_add_f32_dpp v13, v12, v12 row_ror:1 row_mask:0xf bank_mask:0xf
    v_mov_b32 v12, v13
    s_nop 1
    v_add_f32_dpp v13, v12, v12 row_ror:2 row_mask:0xf bank_mask:0xf
    v_mov_b32 v12, v13
    s_nop 1
    v_add_f32_dpp v13, v12, v12 row_ror:4 row_mask:0xf bank_mask:0xf
    v_mov_b32 v12, v13
    s_nop 1
    v_add_f32_dpp v13, v12, v12 row_ror:8 row_mask:0xf bank_mask:0xf
    v_mov_b32 v12, v13
    v_mov_b32 v13, v12
    s_nop 1
    v_permlane32_swap_b32 v12, v13
    s_nop 1
    v_add_f32 v12, v12, v13
    v_mov_b32 v13, v12
    s_nop 1
    v_permlane16_swap_b32 v12, v13
    s_nop 1
    v_add_f32 v12, v12, v13
    v_mul_f32 v12, 0x3b124925, v12
    v_sub_f32 v16, v16, v12
    v_sub_f32 v17, v17, v12
    v_sub_f32 v18, v18, v12
    v_sub_f32 v19, v19, v12
    v_sub_f32 v20, v20, v12
    v_sub_f32 v21, v21, v12
    v_sub_f32 v22, v22, v12
    v_sub_f32 v23, v23, v12
    v_mul_f32 v14, v16, v16
    v_fmac_f32 v14, v17, v17
    v_fmac_f32 v14, v18, v18
    v_fmac_f32 v14, v19, v19
    v_fmac_f32 v14, v20, v20
    v_fmac_f32 v14, v21, v21
    v_fmac_f32 v14, v22, v22
    v_fmac_f32 v14, v23, v23
    v_cndmask_b32 v14, 0, v14, s[22:23]
    s_nop 1
    v_add_f32_dpp v13, v14, v14 row_ror:1 row_mask:0xf bank_mask:0xf
    v_mov_b32 v14, v13
    s_nop 1
    v_add_f32_dpp v13, v14, v14 row_ror:2 row_mask:0xf bank_mask:0xf
    v_mov_b32 v14, v13
    s_nop 1
    v_add_f32_dpp v13, v14, v14 row_ror:4 row_mask:0xf bank_mask:0xf
    v_mov_b32 v14, v13
    s_nop 1
    v_add_f32_dpp v13, v14, v14 row_ror:8 row_mask:0xf bank_mask:0xf
    v_mov_b32 v14, v13
    v_mov_b32 v13, v14
    s_nop 1
    v_permlane32_swap_b32 v14, v13
    s_nop 1
    v_add_f32 v14, v14, v13
    v_mov_b32 v13, v14
    s_nop 1
    v_permlane16_swap_b32 v14, v13
    s_nop 1
    v_add_f32 v14, v14, v13
    v_mov_b32 v13, 0x3727c5ac
    v_fmac_f32 v13, 0x3b124925, v14
    v_rsq_f32 v13, v13
    s_nop 0
    v_mul_f32 v16, v16, v13
    v_fma_f32 v16, v16, v32, v24
    v_mul_f32 v17, v17, v13
    v_fma_f32 v17, v17, v33, v25
    v_mul_f32 v18, v18, v13
    v_fma_f32 v18, v18, v34, v26
    v_mul_f32 v19, v19, v13
    v_fma_f32 v19, v19, v35, v27
    v_mul_f32 v20, v20, v13
    v_fma_f32 v20, v20, v36, v28
    v_mul_f32 v21, v21, v13
    v_fma_f32 v21, v21, v37, v29
    v_mul_f32 v22, v22, v13
    v_fma_f32 v22, v22, v38, v30
    v_mul_f32 v23, v23, v13
    v_fma_f32 v23, v23, v39, v31
    v_cvt_pk_bf16_f32 v8, v16, v17
    v_cvt_pk_bf16_f32 v9, v18, v19
    v_cvt_pk_bf16_f32 v10, v20, v21
    v_cvt_pk_bf16_f32 v11, v22, v23
    s_lshr_b32 s10, s9, 4
    s_and_b32 s11, s9, 15
    s_mul_i32 s12, s10, 14336
    s_lshl_b32 s13, s11, 4
    s_add_u32 s14, s12, s13
    s_add_u32 s15, s14, 0x200000
    v_lshlrev_b32 v6, 8, v4
    v_add_u32 v6, s15, v6
    s_mov_b64 exec, s[22:23]
    global_store_dwordx4 v6, v[8:11], s[6:7]
    v_lshlrev_b32 v12, 3, v4
    v_mov_b32 v13, 0
    v_cmp_le_u32 vcc, 112, v12
    s_nop 1
    v_addc_co_u32 v13, vcc, 0, v13, vcc
    v_cmp_le_u32 vcc, 224, v12
    s_nop 1
    v_addc_co_u32 v13, vcc, 0, v13, vcc
    v_cmp_le_u32 vcc, 336, v12
    s_nop 1
    v_addc_co_u32 v13, vcc, 0, v13, vcc
    s_mov_b32 s16, 112
    v_mul_lo_u32 v14, v13, s16
    v_sub_u32 v12, v12, v14
    s_mov_b32 s16, 3584
    v_mul_lo_u32 v13, v13, s16
    v_lshrrev_b32 v14, 5, v12
    v_lshlrev_b32 v14, 10, v14
    v_bfe_u32 v15, v12, 2, 2
    v_lshl_add_u32 v14, v15, 8, v14
    v_bfe_u32 v15, v12, 4, 1
    v_lshl_add_u32 v14, v15, 3, v14
    v_add_u32 v14, s13, v14
    v_bfe_u32 v15, v12, 2, 2
    v_lshlrev_b32 v15, 7, v15
    s_lshl_b32 s16, s11, 3
    s_add_u32 s16, s16, 3072
    v_add_u32 v15, s16, v15
    v_cmp_le_u32 vcc, 96, v12
    s_nop 1
    v_cndmask_b32 v14, v14, v15, vcc
    v_add_u32 v14, v14, v13
    s_add_u32 s16, s12, 0x400000
    v_add_u32 v14, s16, v14
    global_store_dwordx2 v14, v[8:9], s[6:7]
    v_lshlrev_b32 v12, 3, v4
    v_add_u32 v12, 4, v12
    v_mov_b32 v13, 0
    v_cmp_le_u32 vcc, 112, v12
    s_nop 1
    v_addc_co_u32 v13, vcc, 0, v13, vcc
    v_cmp_le_u32 vcc, 224, v12
    s_nop 1
    v_addc_co_u32 v13, vcc, 0, v13, vcc
    v_cmp_le_u32 vcc, 336, v12
    s_nop 1
    v_addc_co_u32 v13, vcc, 0, v13, vcc
    s_mov_b32 s16, 112
    v_mul_lo_u32 v14, v13, s16
    v_sub_u32 v12, v12, v14
    s_mov_b32 s16, 3584
    v_mul_lo_u32 v13, v13, s16
    v_lshrrev_b32 v14, 5, v12
    v_lshlrev_b32 v14, 10, v14
    v_bfe_u32 v15, v12, 2, 2
    v_lshl_add_u32 v14, v15, 8, v14
    v_bfe_u32 v15, v12, 4, 1
    v_lshl_add_u32 v14, v15, 3, v14
    v_add_u32 v14, s13, v14
    v_bfe_u32 v15, v12, 2, 2
    v_lshlrev_b32 v15, 7, v15
    s_lshl_b32 s16, s11, 3
    s_add_u32 s16, s16, 3072
    v_add_u32 v15, s16, v15
    v_cmp_le_u32 vcc, 96, v12
    s_nop 1
    v_cndmask_b32 v14, v14, v15, vcc
    v_add_u32 v14, v14, v13
    s_add_u32 s16, s12, 0x400000
    v_add_u32 v14, s16, v14
    global_store_dwordx2 v14, v[10:11], s[6:7]
.p2_end_10:
    s_endpgm
.text
.globl mega_kernel
.p2align 8
.type mega_kernel,@function
mega_kernel:
    s_load_dwordx2 s[4:5], s[0:1], 120
    s_load_dwordx2 s[6:7], s[0:1], 128
    s_load_dwordx2 s[30:31], s[0:1], 0
    s_load_dwordx2 s[32:33], s[0:1], 72
    s_load_dwordx2 s[34:35], s[0:1], 88
    s_load_dwordx2 s[36:37], s[0:1], 112
    s_waitcnt lgkmcnt(0)
    v_lshrrev_b32 v2, 6, v0
    s_nop 0
    v_readfirstlane_b32 s8, v2
    v_and_b32 v1, 63, v0
    v_and_b32 v2, 15, v1
    v_lshrrev_b32 v3, 4, v1
    s_cmp_ge_u32 s2, 256
    s_cbranch_scc1 .mg_end2_16
    s_mov_b32 s12, 0x400000
    s_cmp_lg_u32 s8, 0
    s_cbranch_scc1 .mg_wait_13
    s_getreg_b32 s13, hwreg(HW_REG_XCC_ID)
    s_and_b32 s13, s13, 15
    s_mov_b64 exec, 1
    v_mov_b32 v5, 1
    v_mov_b32 v6, 255
    v_mov_b32 v7, 128
    v_mov_b32 v11, 0
    s_cmp_lg_u32 s13, 0
    s_cbranch_scc1 .ch_21
    global_atomic_add v6, v11, v5, s[4:5] sc0
    s_waitcnt vmcnt(0)
.ch_21:
    global_atomic_add v7, v5, s[4:5]
    s_mov_b32 s15, 0
.ch_17:
    global_load_dword v9, v11, s[4:5] sc1
    s_waitcnt vmcnt(0)
    v_readfirstlane_b32 s14, v9
    s_nop 3
    s_cmp_ge_u32 s14, 30
    s_cbranch_scc1 .ch_18
    s_add_u32 s15, s15, 1
    s_cmp_lt_u32 s15, 64
    s_cbranch_scc1 .ch_17
.ch_23:
    global_load_dword v9, v11, s[4:5] sc1
    global_load_dword v10, v7, s[4:5] sc1
    s_waitcnt vmcnt(0)
    v_readfirstlane_b32 s14, v9
    v_readfirstlane_b32 s15, v10
    s_nop 3
    s_cmp_ge_u32 s14, 30
    s_cbranch_scc1 .ch_18
    s_cmp_ge_u32 s15, 256
    s_cbranch_scc1 .ch_19
    s_sub_u32 s12, s12, 1
    s_cmp_eq_u32 s12, 0
    s_cbranch_scc0 .ch_23
.ch_19:
    global_load_dword v9, v11, s[4:5] sc1
    s_waitcnt vmcnt(0)
    v_readfirstlane_b32 s14, v9
    s_mov_b32 s10, 1
    v_readfirstlane_b32 s9, v6
    s_cmp_eq_u32 s13, 0
    s_cbranch_scc1 .ch_22
    v_mov_b32 v7, 132
    global_atomic_add v8, v7, v5, s[4:5] sc0
    s_waitcnt vmcnt(0)
    v_readfirstlane_b32 s17, v8
    s_nop 3
    s_add_u32 s9, s14, s17
    s_cmp_lt_u32 s9, 30
    s_cbranch_scc1 .ch_22
    s_mov_b32 s9, 255
    s_branch .ch_22
.ch_18:
    s_mov_b32 s10, 0
    v_readfirstlane_b32 s9, v6
    s_nop 3
.ch_22:
    v_mov_b32 v4, s9
    v_mov_b32 v5, s10
    v_mov_b32 v6, 7168
    ds_write_b64 v6, v[4:5]
    s_waitcnt lgkmcnt(0)
    s_mov_b64 exec, -1
.mg_wait_13:
    s_barrier
    v_mov_b32 v6, 7168
    ds_read_b64 v[4:5], v6
    s_waitcnt lgkmcnt(0)
    v_readfirstlane_b32 s9, v4
    v_readfirstlane_b32 s10, v5
    s_nop 3
    s_mov_b32 s12, 0x1000000
    s_cmp_eq_u32 s9, 255
    s_cbranch_scc1 .mg_worker_15
    s_cmp_lt_u32 s9, 30
    s_cbranch_scc1 .mg_chain_24
    s_cmp_lg_u32 s10, 0
    s_cbranch_scc1 .mg_worker_15
    s_branch .mg_end_12
.mg_chain_24:
    s_mul_i32 s13, s8, 112
    v_add_u32 v6, s13, v1
    v_add_u32 v7, 64, v6
    v_cmp_gt_u32 vcc, 48, v1
    s_nop 1
    v_cndmask_b32 v7, v6, v7, vcc
    v_lshlrev_b32 v6, 4, v6
    v_lshlrev_b32 v7, 4, v7
    v_add_u32 v4, 0x10000, v6
    v_add_u32 v5, 0x10000, v7
    v_and_b32 v9, 7, v2
    v_lshlrev_b32 v8, 4, v9
    v_lshl_add_u32 v8, v3, 7, v8
    s_mov_b32 s11, 0
    s_mov_b32 s18, 0x00ff00ff
    s_mov_b32 s19, 0x00ff00ff
    s_cmp_ge_u32 s9, 16
    s_cbranch_scc1 .mg_val_14
    s_mul_i32 s13, s9, 28
    s_mul_i32 s14, s8, 7
    s_add_u32 s13, s13, s14
    s_mul_i32 s13, s13, 14336
    s_add_u32 s13, s13, 0x600000
    v_lshlrev_b32 v10, 4, v1
    v_add_u32 v10, s13, v10
    global_load_dwordx4 a[0:3], v10, s[6:7] offset:0
    global_load_dwordx4 a[4:7], v10, s[6:7] offset:1024
    global_load_dwordx4 a[8:11], v10, s[6:7] offset:2048
    global_load_dwordx4 a[12:15], v10, s[6:7] offset:3072
    v_add_u32 v10, 4096, v10
    global_load_dwordx4 a[16:19], v10, s[6:7] offset:0
    global_load_dwordx4 a[20:23], v10, s[6:7] offset:1024
    global_load_dwordx4 a[24:27], v10, s[6:7] offset:2048
    global_load_dwordx4 a[28:31], v10, s[6:7] offset:3072
    v_add_u32 v10, 4096, v10
    global_load_dwordx4 a[32:35], v10, s[6:7] offset:0
    global_load_dwordx4 a[36:39], v10, s[6:7] offset:1024
    global_load_dwordx4 a[40:43], v10, s[6:7] offset:2048
    global_load_dwordx4 a[44:47], v10, s[6:7] offset:3072
    v_add_u32 v10, 4096, v10
    global_load_dwordx4 a[48:51], v10, s[6:7] offset:0
    global_load_dwordx4 a[52:55], v10, s[6:7] offset:1024
    global_load_dwordx4 a[56:59], v10, s[6:7] offset:2048
    global_load_dwordx4 a[60:63], v10, s[6:7] offset:3072
    v_add_u32 v10, 4096, v10
    global_load_dwordx4 a[64:67], v10, s[6:7] offset:0
    global_load_dwordx4 a[68:71], v10, s[6:7] offset:1024
    global_load_dwordx4 a[72:75], v10, s[6:7] offset:2048
    global_load_dwordx4 a[76:79], v10, s[6:7] offset:3072
    v_add_u32 v10, 4096, v10
    global_load_dwordx4 a[80:83], v10, s[6:7] offset:0
    global_load_dwordx4 a[84:87], v10, s[6:7] offset:1024
    global_load_dwordx4 a[88:91], v10, s[6:7] offset:2048
    global_load_dwordx4 a[92:95], v10, s[6:7] offset:3072
    v_add_u32 v10, 4096, v10
    global_load_dwordx4 a[96:99], v10, s[6:7] offset:0
    global_load_dwordx4 a[100:103], v10, s[6:7] offset:1024
    global_load_dwordx4 a[104:107], v10, s[6:7] offset:2048
    global_load_dwordx4 a[108:111], v10, s[6:7] offset:3072
    v_add_u32 v10, 4096, v10
    global_load_dwordx4 a[112:115], v10, s[6:7] offset:0
    global_load_dwordx4 a[116:119], v10, s[6:7] offset:1024
    global_load_dwordx4 a[120:123], v10, s[6:7] offset:2048
    global_load_dwordx4 a[124:127], v10, s[6:7] offset:3072
    v_add_u32 v10, 4096, v10
    s_waitcnt vmcnt(24)
    global_load_dwordx4 a[128:131], v10, s[6:7] offset:0
    global_load_dwordx4 a[132:135], v10, s[6:7] offset:1024
    global_load_dwordx4 a[136:139], v10, s[6:7] offset:2048
    global_load_dwordx4 a[140:143], v10, s[6:7] offset:3072
    v_add_u32 v10, 4096, v10
    global_load_dwordx4 a[144:147], v10, s[6:7] offset:0
    global_load_dwordx4 a[148:151], v10, s[6:7] offset:1024
    global_load_dwordx4 a[152:155], v10, s[6:7] offset:2048
    global_load_dwordx4 a[156:159], v10, s[6:7] offset:3072
    v_add_u32 v10, 4096, v10
    global_load_dwordx4 a[160:163], v10, s[6:7] offset:0
    global_load_dwordx4 a[164:167], v10, s[6:7] offset:1024
    global_load_dwordx4 a[168:171], v10, s[6:7] offset:2048
    global_load_dwordx4 a[172:175], v10, s[6:7] offset:3072
    v_add_u32 v10, 4096, v10
    global_load_dwordx4 a[176:179], v10, s[6:7] offset:0
    global_load_dwordx4 a[180:183], v10, s[6:7] offset:1024
    global_load_dwordx4 a[184:187], v10, s[6:7] offset:2048
    global_load_dwordx4 a[188:191], v10, s[6:7] offset:3072
    v_add_u32 v10, 4096, v10
    global_load_dwordx4 a[192:195], v10, s[6:7] offset:0
    global_load_dwordx4 a[196:199], v10, s[6:7] offset:1024
    global_load_dwordx4 a[200:203], v10, s[6:7] offset:2048
    global_load_dwordx4 a[204:207], v10, s[6:7] offset:3072
    v_add_u32 v10, 4096, v10
    global_load_dwordx4 a[208:211], v10, s[6:7] offset:0
    global_load_dwordx4 a[212:215], v10, s[6:7] offset:1024
    global_load_dwordx4 a[216:219], v10, s[6:7] offset:2048
    global_load_dwordx4 a[220:223], v10, s[6:7] offset:3072
    v_add_u32 v10, 4096, v10
    global_load_dwordx4 a[224:227], v10, s[6:7] offset:0
    global_load_dwordx4 a[228:231], v10, s[6:7] offset:1024
    global_load_dwordx4 a[232:235], v10, s[6:7] offset:2048
    global_load_dwordx4 a[236:239], v10, s[6:7] offset:3072
    v_add_u32 v10, 4096, v10
    global_load_dwordx4 a[240:243], v10, s[6:7] offset:0
    global_load_dwordx4 a[244:247], v10, s[6:7] offset:1024
    global_load_dwordx4 a[248:251], v10, s[6:7] offset:2048
    global_load_dwordx4 a[252:255], v10, s[6:7] offset:3072
    v_add_u32 v10, 4096, v10
    s_waitcnt vmcnt(24)
    global_load_dwordx4 v[120:123], v10, s[6:7] offset:0
    global_load_dwordx4 v[124:127], v10, s[6:7] offset:1024
    global_load_dwordx4 v[128:131], v10, s[6:7] offset:2048
    global_load_dwordx4 v[132:135], v10, s[6:7] offset:3072
    v_add_u32 v10, 4096, v10
    global_load_dwordx4 v[136:139], v10, s[6:7] offset:0
    global_load_dwordx4 v[140:143], v10, s[6:7] offset:1024
    global_load_dwordx4 v[144:147], v10, s[6:7] offset:2048
    global_load_dwordx4 v[148:151], v10, s[6:7] offset:3072
    v_add_u32 v10, 4096, v10
    global_load_dwordx4 v[152:155], v10, s[6:7] offset:0
    global_load_dwordx4 v[156:159], v10, s[6:7] offset:1024
    global_load_dwordx4 v[160:163], v10, s[6:7] offset:2048
    global_load_dwordx4 v[164:167], v10, s[6:7] offset:3072
    v_add_u32 v10, 4096, v10
    global_load_dwordx4 v[168:171], v10, s[6:7] offset:0
    global_load_dwordx4 v[172:175], v10, s[6:7] offset:1024
    global_load_dwordx4 v[176:179], v10, s[6:7] offset:2048
    global_load_dwordx4 v[180:183], v10, s[6:7] offset:3072
    v_add_u32 v10, 4096, v10
    global_load_dwordx4 v[184:187], v10, s[6:7] offset:0
    global_load_dwordx4 v[188:191], v10, s[6:7] offset:1024
    global_load_dwordx4 v[192:195], v10, s[6:7] offset:2048
    global_load_dwordx4 v[196:199], v10, s[6:7] offset:3072
    v_add_u32 v10, 4096, v10
    global_load_dwordx4 v[200:203], v10, s[6:7] offset:0
    global_load_dwordx4 v[204:207], v10, s[6:7] offset:1024
    global_load_dwordx4 v[208:211], v10, s[6:7] offset:2048
    global_load_dwordx4 v[212:215], v10, s[6:7] offset:3072
    v_add_u32 v10, 4096, v10
    global_load_dwordx4 v[216:219], v10, s[6:7] offset:0
    global_load_dwordx4 v[220:223], v10, s[6:7] offset:1024
    global_load_dwordx4 v[224:227], v10, s[6:7] offset:2048
    global_load_dwordx4 v[228:231], v10, s[6:7] offset:3072
    v_add_u32 v10, 4096, v10
    global_load_dwordx4 v[232:235], v10, s[6:7] offset:0
    global_load_dwordx4 v[236:239], v10, s[6:7] offset:1024
    global_load_dwordx4 v[240:243], v10, s[6:7] offset:2048
    global_load_dwordx4 v[244:247], v10, s[6:7] offset:3072
    v_add_u32 v10, 4096, v10
    s_waitcnt vmcnt(24)
    global_load_dwordx4 v[248:251], v10, s[6:7] offset:0
    global_load_dwordx4 v[252:255], v10, s[6:7] offset:1024
    s_mul_i32 s13, s8, 1792
    v_lshrrev_b32 v12, 1, v3
    v_lshlrev_b32 v12, 7, v12
    v_lshl_add_u32 v12, v9, 4, v12
    v_and_b32 v13, 1, v3
    v_lshl_add_u32 v12, v13, 3, v12
    v_add_u32 v9, s13, v12
    s_mul_i32 s13, s8, 3584
    s_add_u32 s13, s13, 0x400000
    v_lshlrev_b32 v10, 4, v1
    v_add_u32 v10, s13, v10
    v_lshlrev_b32 v11, 3, v1
    v_add_u32 v11, s13, v11
    v_add_u32 v118, 14336, v10
    v_add_u32 v119, 14336, v11
    s_mul_i32 s13, s8, 3072
    s_add_u32 s13, s13, 8192
    v_lshlrev_b32 v12, 4, v1
    v_add_u32 v12, s13, v12
    v_and_b32 v16, 7, v1
    v_lshrrev_b32 v17, 3, v1
    v_and_b32 v18, 3, v17
    v_lshrrev_b32 v19, 2, v17
    v_lshl_add_u32 v15, v18, 4, v16
    v_lshlrev_b32 v15, 4, v15
    v_lshl_add_u32 v15, v19, 10, v15
    v_add_u32 v15, 8192, v15
    v_lshl_add_u32 v2, v19, 4, v16
    v_lshlrev_b32 v2, 4, v2
    v_lshl_add_u32 v2, v18, 2, v2
    v_add_u32 v2, 10240, v2
    s_lshr_b32 s13, s9, 2
    s_mul_i32 s13, s13, 2560
    s_add_u32 s13, s13, 0x81c00
    s_lshr_b32 s14, s9, 1
    s_and_b32 s14, s14, 1
    s_and_b32 s15, s9, 1
    s_lshl_b32 s16, s14, 10
    s_lshl_b32 s17, s15, 7
    s_add_u32 s16, s16, s17
    s_add_u32 s16, s16, s13
    v_lshlrev_b32 v13, 8, v18
    v_lshl_add_u32 v13, v16, 4, v13
    v_lshl_add_u32 v13, v19, 3, v13
    v_add_u32 v13, s16, v13
    s_lshl_b32 s16, s14, 7
    s_lshl_b32 s17, s15, 3
    s_add_u32 s16, s16, s17
    s_add_u32 s16, s16, s13
    s_add_u32 s16, s16, 2048
    v_lshlrev_b32 v14, 8, v19
    v_lshl_add_u32 v14, v16, 4, v14
    v_lshrrev_b32 v18, 1, v18
    v_lshl_add_u32 v14, v18, 2, v14
    v_add_u32 v14, s16, v14
    v_mov_b32 v1, 0x3fb8aa3b
.sloop_25:
    global_load_dwordx4 v[56:59], v10, s[6:7] offset:0
    global_load_dwordx4 v[60:63], v10, s[6:7] offset:1024
    global_load_dwordx4 v[64:67], v10, s[6:7] offset:2048
    global_load_dwordx2 v[68:69], v11, s[6:7] offset:3072
    global_load_dwordx4 v[70:73], v118, s[6:7] offset:0
    global_load_dwordx4 v[74:77], v118, s[6:7] offset:1024
    global_load_dwordx4 v[78:81], v118, s[6:7] offset:2048
    global_load_dwordx2 v[82:83], v119, s[6:7] offset:3072
    v_add_u32 v10, 28672, v10
    v_add_u32 v11, 28672, v11
    v_add_u32 v118, 28672, v118
    v_add_u32 v119, 28672, v119
.pm_27:
    global_load_dwordx4 v[110:113], v4, s[6:7] sc1
    global_load_dwordx4 v[114:117], v5, s[6:7] sc1
    s_sub_u32 s12, s12, 1
    s_cmp_eq_u32 s12, 0
    s_cbranch_scc1 .mg_end_12
    s_waitcnt vmcnt(0)
    v_max3_u32 v0, v110, v111, v112
    v_max3_u32 v0, v0, v113, v114
    v_max3_u32 v0, v0, v115, v116
    v_max_u32 v0, v0, v117
    v_cmp_eq_u32 vcc, -1, v0
    s_cbranch_vccnz .pm_27
    ds_write_b128 v6, v[110:113]
    ds_write_b128 v7, v[114:117]
    v_add_u32 v4, 7168, v4
    v_add_u32 v5, 7168, v5
    s_waitcnt lgkmcnt(0)
    s_barrier
    ds_read_b128 v[16:19], v8 offset:0
    ds_read_b128 v[20:23], v8 offset:512
    ds_read_b128 v[24:27], v8 offset:1024
    ds_read2_b64 v[84:87], v9 offset0:0 offset1:32
    ds_read2_b64 v[88:91], v9 offset0:64 offset1:96
    ds_read2_b64 v[92:95], v9 offset0:128 offset1:160
    ds_read_b64 v[96:97], v9 offset:1536
    s_waitcnt lgkmcnt(6)
    v_mfma_f32_16x16x32_bf16 v[28:31], a[0:3], v[16:19], 0
    v_mfma_f32_16x16x32_bf16 v[32:35], a[56:59], v[16:19], 0
    v_mfma_f32_16x16x32_bf16 v[36:39], a[112:115], v[16:19], 0
    v_mfma_f32_16x16x32_bf16 v[40:43], a[168:171], v[16:19], 0
    v_mfma_f32_16x16x32_bf16 v[44:47], a[224:227], v[16:19], 0
    v_mfma_f32_16x16x32_bf16 v[48:51], v[144:147], v[16:19], 0
    v_mfma_f32_16x16x32_bf16 v[52:55], v[200:203], v[16:19], 0
    ds_read_b128 v[16:19], v8 offset:1536
    s_waitcnt lgkmcnt(6)
    v_mfma_f32_16x16x32_bf16 v[28:31], a[4:7], v[20:23], v[28:31]
    v_mfma_f32_16x16x32_bf16 v[32:35], a[60:63], v[20:23], v[32:35]
    v_mfma_f32_16x16x32_bf16 v[36:39], a[116:119], v[20:23], v[36:39]
    v_mfma_f32_16x16x32_bf16 v[40:43], a[172:175], v[20:23], v[40:43]
    v_mfma_f32_16x16x32_bf16 v[44:47], a[228:231], v[20:23], v[44:47]
    v_mfma_f32_16x16x32_bf16 v[48:51], v[148:151], v[20:23], v[48:51]
    v_mfma_f32_16x16x32_bf16 v[52:55], v[204:207], v[20:23], v[52:55]
    ds_read_b128 v[20:23], v8 offset:2048
    s_waitcnt lgkmcnt(6)
    v_mfma_f32_16x16x32_bf16 v[28:31], a[8:11], v[24:27], v[28:31]
    v_mfma_f32_16x16x32_bf16 v[32:35], a[64:67], v[24:27], v[32:35]
    v_mfma_f32_16x16x32_bf16 v[36:39], a[120:123], v[24:27], v[36:39]
    v_mfma_f32_16x16x32_bf16 v[40:43], a[176:179], v[24:27], v[40:43]
    v_mfma_f32_16x16x32_bf16 v[44:47], a[232:235], v[24:27], v[44:47]
    v_mfma_f32_16x16x32_bf16 v[48:51], v[152:155], v[24:27], v[48:51]
    v_mfma_f32_16x16x32_bf16 v[52:55], v[208:211], v[24:27], v[52:55]
    ds_read_b128 v[24:27], v8 offset:2560
    s_waitcnt lgkmcnt(2)
    v_mfma_f32_16x16x32_bf16 v[28:31], a[12:15], v[16:19], v[28:31]
    v_mfma_f32_16x16x32_bf16 v[32:35], a[68:71], v[16:19], v[32:35]
    v_mfma_f32_16x16x32_bf16 v[36:39], a[124:127], v[16:19], v[36:39]
    v_mfma_f32_16x16x32_bf16 v[40:43], a[180:183], v[16:19], v[40:43]
    v_mfma_f32_16x16x32_bf16 v[44:47], a[236:239], v[16:19], v[44:47]
    v_mfma_f32_16x16x32_bf16 v[48:51], v[156:159], v[16:19], v[48:51]
    v_mfma_f32_16x16x32_bf16 v[52:55], v[212:215], v[16:19], v[52:55]
    ds_read_b128 v[16:19], v8 offset:3072
    s_waitcnt lgkmcnt(2)
    v_mfma_f32_16x16x32_bf16 v[28:31], a[16:19], v[20:23], v[28:31]
    v_mfma_f32_16x16x32_bf16 v[32:35], a[72:75], v[20:23], v[32:35]
    v_mfma_f32_16x16x32_bf16 v[36:39], a[128:131], v[20:23], v[36:39]
    v_mfma_f32_16x16x32_bf16 v[40:43], a[184:187], v[20:23], v[40:43]
    v_mfma_f32_16x16x32_bf16 v[44:47], a[240:243], v[20:23], v[44:47]
    v_mfma_f32_16x16x32_bf16 v[48:51], v[160:163], v[20:23], v[48:51]
    v_mfma_f32_16x16x32_bf16 v[52:55], v[216:219], v[20:23], v[52:55]
    ds_read_b128 v[20:23], v8 offset:3584
    s_waitcnt lgkmcnt(2)
    v_mfma_f32_16x16x32_bf16 v[28:31], a[20:23], v[24:27], v[28:31]
    v_mfma_f32_16x16x32_bf16 v[32:35], a[76:79], v[24:27], v[32:35]
    v_mfma_f32_16x16x32_bf16 v[36:39], a[132:135], v[24:27], v[36:39]
    v_mfma_f32_16x16x32_bf16 v[40:43], a[188:191], v[24:27], v[40:43]
    v_mfma_f32_16x16x32_bf16 v[44:47], a[244:247], v[24:27], v[44:47]
    v_mfma_f32_16x16x32_bf16 v[48:51], v[164:167], v[24:27], v[48:51]
    v_mfma_f32_16x16x32_bf16 v[52:55], v[220:223], v[24:27], v[52:55]
    ds_read_b128 v[24:27], v8 offset:4096
    s_waitcnt lgkmcnt(2)
    v_mfma_f32_16x16x32_bf16 v[28:31], a[24:27], v[16:19], v[28:31]
    v_mfma_f32_16x16x32_bf16 v[32:35], a[80:83], v[16:19], v[32:35]
    v_mfma_f32_16x16x32_bf16 v[36:39], a[136:139], v[16:19], v[36:39]
    v_mfma_f32_16x16x32_bf16 v[40:43], a[192:195], v[16:19], v[40:43]
    v_mfma_f32_16x16x32_bf16 v[44:47], a[248:251], v[16:19], v[44:47]
    v_mfma_f32_16x16x32_bf16 v[48:51], v[168:171], v[16:19], v[48:51]
    v_mfma_f32_16x16x32_bf16 v[52:55], v[224:227], v[16:19], v[52:55]
    ds_read_b128 v[16:19], v8 offset:4608
    s_waitcnt lgkmcnt(2)
    v_mfma_f32_16x16x32_bf16 v[28:31], a[28:31], v[20:23], v[28:31]
    v_mfma_f32_16x16x32_bf16 v[32:35], a[84:87], v[20:23], v[32:35]
    v_mfma_f32_16x16x32_bf16 v[36:39], a[140:143], v[20:23], v[36:39]
    v_mfma_f32_16x16x32_bf16 v[40:43], a[196:199], v[20:23], v[40:43]
    v_mfma_f32_16x16x32_bf16 v[44:47], a[252:255], v[20:23], v[44:47]
    v_mfma_f32_16x16x32_bf16 v[48:51], v[172:175], v[20:23], v[48:51]
    v_mfma_f32_16x16x32_bf16 v[52:55], v[228:231], v[20:23], v[52:55]
    ds_read_b128 v[20:23], v8 offset:5120
    s_waitcnt lgkmcnt(2)
    v_mfma_f32_16x16x32_bf16 v[28:31], a[32:35], v[24:27], v[28:31]
    v_mfma_f32_16x16x32_bf16 v[32:35], a[88:91], v[24:27], v[32:35]
    v_mfma_f32_16x16x32_bf16 v[36:39], a[144:147], v[24:27], v[36:39]
    v_mfma_f32_16x16x32_bf16 v[40:43], a[200:203], v[24:27], v[40:43]
    v_mfma_f32_16x16x32_bf16 v[44:47], v[120:123], v[24:27], v[44:47]
    v_mfma_f32_16x16x32_bf16 v[48:51], v[176:179], v[24:27], v[48:51]
    v_mfma_f32_16x16x32_bf16 v[52:55], v[232:235], v[24:27], v[52:55]
    ds_read_b128 v[24:27], v8 offset:5632
    s_waitcnt lgkmcnt(2)
    v_mfma_f32_16x16x32_bf16 v[28:31], a[36:39], v[16:19], v[28:31]
    v_mfma_f32_16x16x32_bf16 v[32:35], a[92:95], v[16:19], v[32:35]
    v_mfma_f32_16x16x32_bf16 v[36:39], a[148:151], v[16:19], v[36:39]
    v_mfma_f32_16x16x32_bf16 v[40:43], a[204:207], v[16:19], v[40:43]
    v_mfma_f32_16x16x32_bf16 v[44:47], v[124:127], v[16:19], v[44:47]
    v_mfma_f32_16x16x32_bf16 v[48:51], v[180:183], v[16:19], v[48:51]
    v_mfma_f32_16x16x32_bf16 v[52:55], v[236:239], v[16:19], v[52:55]
    ds_read_b128 v[16:19], v8 offset:6144
    s_waitcnt lgkmcnt(2)
    v_mfma_f32_16x16x32_bf16 v[28:31], a[40:43], v[20:23], v[28:31]
    v_mfma_f32_16x16x32_bf16 v[32:35], a[96:99], v[20:23], v[32:35]
    v_mfma_f32_16x16x32_bf16 v[36:39], a[152:155], v[20:23], v[36:39]
    v_mfma_f32_16x16x32_bf16 v[40:43], a[208:211], v[20:23], v[40:43]
    v_mfma_f32_16x16x32_bf16 v[44:47], v[128:131], v[20:23], v[44:47]
    v_mfma_f32_16x16x32_bf16 v[48:51], v[184:187], v[20:23], v[48:51]
    v_mfma_f32_16x16x32_bf16 v[52:55], v[240:243], v[20:23], v[52:55]
    ds_read_b128 v[20:23], v8 offset:6656
    s_waitcnt lgkmcnt(2)
    v_mfma_f32_16x16x32_bf16 v[28:31], a[44:47], v[24:27], v[28:31]
    v_mfma_f32_16x16x32_bf16 v[32:35], a[100:103], v[24:27], v[32:35]
    v_mfma_f32_16x16x32_bf16 v[36:39], a[156:159], v[24:27], v[36:39]
    v_mfma_f32_16x16x32_bf16 v[40:43], a[212:215], v[24:27], v[40:43]
    v_mfma_f32_16x16x32_bf16 v[44:47], v[132:135], v[24:27], v[44:47]
    v_mfma_f32_16x16x32_bf16 v[48:51], v[188:191], v[24:27], v[48:51]
    v_mfma_f32_16x16x32_bf16 v[52:55], v[244:247], v[24:27], v[52:55]
    s_waitcnt lgkmcnt(0)
    v_mfma_f32_16x16x32_bf16 v[28:31], a[48:51], v[16:19], v[28:31]
    v_mfma_f32_16x16x32_bf16 v[32:35], a[104:107], v[16:19], v[32:35]
    v_mfma_f32_16x16x32_bf16 v[28:31], a[52:55], v[20:23], v[28:31]
    v_mfma_f32_16x16x32_bf16 v[32:35], a[108:111], v[20:23], v[32:35]
    v_mfma_f32_16x16x32_bf16 v[36:39], a[160:163], v[16:19], v[36:39]
    v_mfma_f32_16x16x32_bf16 v[40:43], a[216:219], v[16:19], v[40:43]
    v_mfma_f32_16x16x32_bf16 v[36:39], a[164:167], v[20:23], v[36:39]
    v_mfma_f32_16x16x32_bf16 v[40:43], a[220:223], v[20:23], v[40:43]
    v_mfma_f32_16x16x32_bf16 v[44:47], v[136:139], v[16:19], v[44:47]
    v_mfma_f32_16x16x32_bf16 v[48:51], v[192:195], v[16:19], v[48:51]
    v_mfma_f32_16x16x32_bf16 v[44:47], v[140:143], v[20:23], v[44:47]
    v_mfma_f32_16x16x32_bf16 v[48:51], v[196:199], v[20:23], v[48:51]
    v_cvt_pk_bf16_f32 v24, v28, v29
    v_cvt_pk_bf16_f32 v25, v30, v31
    v_cvt_pk_bf16_f32 v26, v32, v33
    v_cvt_pk_bf16_f32 v27, v34, v35
    v_mfma_f32_16x16x32_bf16 v[52:55], v[248:251], v[16:19], v[52:55]
    v_mfma_f32_16x16x32_bf16 v[52:55], v[252:255], v[20:23], v[52:55]
    s_nop 1
    v_cvt_pk_bf16_f32 v110, v36, v37
    v_cvt_pk_bf16_f32 v111, v38, v39
    v_cvt_pk_bf16_f32 v112, v40, v41
    v_cvt_pk_bf16_f32 v113, v42, v43
    v_mfma_f32_16x16x32_bf16 v[98:101], v[56:59], v[24:27], 0
    v_mfma_f32_16x16x32_bf16 v[102:105], v[70:73], v[24:27], 0
    v_mfma_f32_16x16x32_bf16 v[106:109], v[84:87], v[24:27], 0
    v_cvt_pk_bf16_f32 v114, v44, v45
    v_cvt_pk_bf16_f32 v115, v46, v47
    v_cvt_pk_bf16_f32 v116, v48, v49
    v_cvt_pk_bf16_f32 v117, v50, v51
    v_mfma_f32_16x16x32_bf16 v[98:101], v[60:63], v[110:113], v[98:101]
    v_mfma_f32_16x16x32_bf16 v[102:105], v[74:77], v[110:113], v[102:105]
    v_mfma_f32_16x16x32_bf16 v[106:109], v[88:91], v[110:113], v[106:109]
    v_cvt_pk_bf16_f32 v52, v52, v53
    v_cvt_pk_bf16_f32 v53, v54, v55
    v_mfma_f32_16x16x32_bf16 v[98:101], v[64:67], v[114:117], v[98:101]
    v_mfma_f32_16x16x32_bf16 v[102:105], v[78:81], v[114:117], v[102:105]
    v_mfma_f32_16x16x32_bf16 v[106:109], v[92:95], v[114:117], v[106:109]
    v_mfma_f32_16x16x16_bf16 v[98:101], v[68:69], v[52:53], v[98:101]
    v_mfma_f32_16x16x16_bf16 v[102:105], v[82:83], v[52:53], v[102:105]
    v_mfma_f32_16x16x16_bf16 v[106:109], v[96:97], v[52:53], v[106:109]
    s_nop 5
    ds_write_b128 v12, v[98:101] offset:0
    ds_write_b128 v12, v[102:105] offset:1024
    ds_write_b128 v12, v[106:109] offset:2048
    s_waitcnt lgkmcnt(0)
    s_barrier
    s_cmp_lg_u32 s8, 0
    s_cbranch_scc1 .snext_26
    ds_read_b128 v[28:31], v15 offset:0
    ds_read_b32 v44, v2 offset:0
    ds_read_b128 v[32:35], v15 offset:3072
    ds_read_b32 v45, v2 offset:3072
    ds_read_b128 v[36:39], v15 offset:6144
    ds_read_b32 v46, v2 offset:6144
    ds_read_b128 v[40:43], v15 offset:9216
    ds_read_b32 v47, v2 offset:9216
    s_waitcnt lgkmcnt(4)
    v_pk_add_f32 v[28:29], v[28:29], v[32:33]
    v_pk_add_f32 v[30:31], v[30:31], v[34:35]
    v_add_f32 v44, v44, v45
    s_waitcnt lgkmcnt(0)
    v_pk_add_f32 v[36:37], v[36:37], v[40:41]
    v_pk_add_f32 v[38:39], v[38:39], v[42:43]
    v_add_f32 v46, v46, v47
    v_pk_add_f32 v[28:29], v[28:29], v[36:37]
    v_pk_add_f32 v[30:31], v[30:31], v[38:39]
    v_add_f32 v32, v44, v46
    v_max3_f32 v34, v28, v29, v30
    v_max3_f32 v34, v34, v31, v32
    s_nop 1
    v_max_f32_dpp v35, v34, v34 row_ror:8 row_mask:0xf bank_mask:0xf
    v_mov_b32 v36, v35
    s_nop 1
    v_permlane32_swap_b32 v35, v36
    s_nop 1
    v_max_f32 v35, v35, v36
    v_mov_b32 v36, v35
    s_nop 1
    v_permlane16_swap_b32 v35, v36
    s_nop 1
    v_max_f32 v35, v35, v36
    v_mul_f32 v35, v35, v1
    v_fma_f32 v28, v28, v1, -v35
    v_fma_f32 v29, v29, v1, -v35
    v_fma_f32 v30, v30, v1, -v35
    v_fma_f32 v31, v31, v1, -v35
    v_fma_f32 v32, v32, v1, -v35
    v_exp_f32 v28, v28
    v_exp_f32 v29, v29
    v_exp_f32 v30, v30
    v_exp_f32 v31, v31
    v_exp_f32 v32, v32
    s_nop 0
    v_add_f32 v34, v28, v29
    v_add_f32 v36, v30, v31
    v_add_f32 v34, v34, v32
    v_add_f32 v34, v34, v36
    s_nop 1
    v_add_f32_dpp v35, v34, v34 row_ror:8 row_mask:0xf bank_mask:0xf
    v_mov_b32 v36, v35
    s_nop 1
    v_permlane32_swap_b32 v35, v36
    s_nop 1
    v_add_f32 v35, v35, v36
    v_mov_b32 v36, v35
    s_nop 1
    v_permlane16_swap_b32 v35, v36
    s_nop 1
    v_add_f32 v35, v35, v36
    v_rcp_f32 v35, v35
    s_nop 0
    v_mul_f32 v28, v28, v35
    v_mul_f32 v29, v29, v35
    v_mul_f32 v30, v30, v35
    v_mul_f32 v31, v31, v35
    v_mul_f32 v32, v32, v35
    v_cvt_pk_bf16_f32 v36, v28, v29
    v_cvt_pk_bf16_f32 v37, v30, v31
    v_mov_b32_dpp v33, v32 row_ror:8 row_mask:0xf bank_mask:0xf
    v_min_u32 v36, 0xfffffffe, v36
    v_min_u32 v37, 0xfffffffe, v37
    v_cvt_pk_bf16_f32 v38, v32, v33
    v_min_u32 v38, 0xfffffffe, v38
    s_cmp_eq_u32 s10, 0
    s_cbranch_scc0 .ps_28
    global_store_dwordx2 v13, v[36:37], s[6:7]
    s_mov_b64 exec, s[18:19]
    global_store_dword v14, v38, s[6:7]
    s_mov_b64 exec, -1
    s_branch .ps_29
.ps_28:
    global_store_dwordx2 v13, v[36:37], s[6:7] sc1
    s_mov_b64 exec, s[18:19]
    global_store_dword v14, v38, s[6:7] sc1
    s_mov_b64 exec, -1
.ps_29:
    v_add_u32 v13, 10240, v13
    v_add_u32 v14, 10240, v14
.snext_26:
    s_add_u32 s11, s11, 1
    s_cmp_lt_u32 s11, 63
    s_cbranch_scc1 .sloop_25
    s_branch .mg_end_12
.mg_val_14:
    s_sub_u32 s20, s9, 16
    s_lshl_b32 s13, s8, 2
    s_mul_i32 s13, s13, 28
    s_lshl_b32 s14, s20, 1
    s_add_u32 s13, s13, s14
    s_mul_i32 s13, s13, 14336
    s_add_u32 s13, s13, 0xd00000
    v_lshlrev_b32 v11, 4, v1
    v_add_u32 v10, s13, v11
    global_load_dwordx4 a[0:3], v10, s[6:7] offset:0
    global_load_dwordx4 a[4:7], v10, s[6:7] offset:1024
    global_load_dwordx4 a[8:11], v10, s[6:7] offset:2048
    global_load_dwordx4 a[12:15], v10, s[6:7] offset:3072
    v_add_u32 v10, 4096, v10
    global_load_dwordx4 a[16:19], v10, s[6:7] offset:0
    global_load_dwordx4 a[20:23], v10, s[6:7] offset:1024
    global_load_dwordx4 a[24:27], v10, s[6:7] offset:2048
    global_load_dwordx4 a[28:31], v10, s[6:7] offset:3072
    v_add_u32 v10, 4096, v10
    global_load_dwordx4 a[32:35], v10, s[6:7] offset:0
    global_load_dwordx4 a[36:39], v10, s[6:7] offset:1024
    global_load_dwordx4 a[40:43], v10, s[6:7] offset:2048
    global_load_dwordx4 a[44:47], v10, s[6:7] offset:3072
    v_add_u32 v10, 4096, v10
    global_load_dwordx4 a[48:51], v10, s[6:7] offset:0
    global_load_dwordx4 a[52:55], v10, s[6:7] offset:1024
    global_load_dwordx4 a[56:59], v10, s[6:7] offset:2048
    global_load_dwordx4 a[60:63], v10, s[6:7] offset:3072
    v_add_u32 v10, 4096, v10
    global_load_dwordx4 a[64:67], v10, s[6:7] offset:0
    global_load_dwordx4 a[68:71], v10, s[6:7] offset:1024
    global_load_dwordx4 a[72:75], v10, s[6:7] offset:2048
    global_load_dwordx4 a[76:79], v10, s[6:7] offset:3072
    v_add_u32 v10, 4096, v10
    global_load_dwordx4 a[80:83], v10, s[6:7] offset:0
    global_load_dwordx4 a[84:87], v10, s[6:7] offset:1024
    global_load_dwordx4 a[88:91], v10, s[6:7] offset:2048
    global_load_dwordx4 a[92:95], v10, s[6:7] offset:3072
    v_add_u32 v10, 4096, v10
    global_load_dwordx4 a[96:99], v10, s[6:7] offset:0
    global_load_dwordx4 a[100:103], v10, s[6:7] offset:1024
    global_load_dwordx4 a[104:107], v10, s[6:7] offset:2048
    global_load_dwordx4 a[108:111], v10, s[6:7] offset:3072
    v_add_u32 v10, 4096, v10
    s_add_u32 s13, s13, 401408
    s_waitcnt vmcnt(28)
    v_add_u32 v10, s13, v11
    global_load_dwordx4 a[112:115], v10, s[6:7] offset:0
    global_load_dwordx4 a[116:119], v10, s[6:7] offset:1024
    global_load_dwordx4 a[120:123], v10, s[6:7] offset:2048
    global_load_dwordx4 a[124:127], v10, s[6:7] offset:3072
    v_add_u32 v10, 4096, v10
    global_load_dwordx4 a[128:131], v10, s[6:7] offset:0
    global_load_dwordx4 a[132:135], v10, s[6:7] offset:1024
    global_load_dwordx4 a[136:139], v10, s[6:7] offset:2048
    global_load_dwordx4 a[140:143], v10, s[6:7] offset:3072
    v_add_u32 v10, 4096, v10
    global_load_dwordx4 a[144:147], v10, s[6:7] offset:0
    global_load_dwordx4 a[148:151], v10, s[6:7] offset:1024
    global_load_dwordx4 a[152:155], v10, s[6:7] offset:2048
    global_load_dwordx4 a[156:159], v10, s[6:7] offset:3072
    v_add_u32 v10, 4096, v10
    global_load_dwordx4 a[160:163], v10, s[6:7] offset:0
    global_load_dwordx4 a[164:167], v10, s[6:7] offset:1024
    global_load_dwordx4 a[168:171], v10, s[6:7] offset:2048
    global_load_dwordx4 a[172:175], v10, s[6:7] offset:3072
    v_add_u32 v10, 4096, v10
    global_load_dwordx4 a[176:179], v10, s[6:7] offset:0
    global_load_dwordx4 a[180:183], v10, s[6:7] offset:1024
    global_load_dwordx4 a[184:187], v10, s[6:7] offset:2048
    global_load_dwordx4 a[188:191], v10, s[6:7] offset:3072
    v_add_u32 v10, 4096, v10
    global_load_dwordx4 a[192:195], v10, s[6:7] offset:0
    global_load_dwordx4 a[196:199], v10, s[6:7] offset:1024
    global_load_dwordx4 a[200:203], v10, s[6:7] offset:2048
    global_load_dwordx4 a[204:207], v10, s[6:7] offset:3072
    v_add_u32 v10, 4096, v10
    global_load_dwordx4 a[208:211], v10, s[6:7] offset:0
    global_load_dwordx4 a[212:215], v10, s[6:7] offset:1024
    global_load_dwordx4 a[216:219], v10, s[6:7] offset:2048
    global_load_dwordx4 a[220:223], v10, s[6:7] offset:3072
    v_add_u32 v10, 4096, v10
    s_add_u32 s13, s13, 401408
    s_waitcnt vmcnt(28)
    v_add_u32 v10, s13, v11
    global_load_dwordx4 a[224:227], v10, s[6:7] offset:0
    global_load_dwordx4 a[228:231], v10, s[6:7] offset:1024
    global_load_dwordx4 a[232:235], v10, s[6:7] offset:2048
    global_load_dwordx4 a[236:239], v10, s[6:7] offset:3072
    v_add_u32 v10, 4096, v10
    global_load_dwordx4 a[240:243], v10, s[6:7] offset:0
    global_load_dwordx4 a[244:247], v10, s[6:7] offset:1024
    global_load_dwordx4 a[248:251], v10, s[6:7] offset:2048
    global_load_dwordx4 a[252:255], v10, s[6:7] offset:3072
    v_add_u32 v10, 4096, v10
    global_load_dwordx4 v[176:179], v10, s[6:7] offset:0
    global_load_dwordx4 v[180:183], v10, s[6:7] offset:1024
    global_load_dwordx4 v[184:187], v10, s[6:7] offset:2048
    global_load_dwordx4 v[188:191], v10, s[6:7] offset:3072
    v_add_u32 v10, 4096, v10
    global_load_dwordx4 v[192:195], v10, s[6:7] offset:0
    global_load_dwordx4 v[196:199], v10, s[6:7] offset:1024
    global_load_dwordx4 v[200:203], v10, s[6:7] offset:2048
    global_load_dwordx4 v[204:207], v10, s[6:7] offset:3072
    v_add_u32 v10, 4096, v10
    global_load_dwordx4 v[208:211], v10, s[6:7] offset:0
    global_load_dwordx4 v[212:215], v10, s[6:7] offset:1024
    global_load_dwordx4 v[216:219], v10, s[6:7] offset:2048
    global_load_dwordx4 v[220:223], v10, s[6:7] offset:3072
    v_add_u32 v10, 4096, v10
    global_load_dwordx4 v[224:227], v10, s[6:7] offset:0
    global_load_dwordx4 v[228:231], v10, s[6:7] offset:1024
    global_load_dwordx4 v[232:235], v10, s[6:7] offset:2048
    global_load_dwordx4 v[236:239], v10, s[6:7] offset:3072
    v_add_u32 v10, 4096, v10
    global_load_dwordx4 v[240:243], v10, s[6:7] offset:0
    global_load_dwordx4 v[244:247], v10, s[6:7] offset:1024
    global_load_dwordx4 v[248:251], v10, s[6:7] offset:2048
    global_load_dwordx4 v[252:255], v10, s[6:7] offset:3072
    v_add_u32 v10, 4096, v10
    s_add_u32 s13, s13, 401408
    s_waitcnt vmcnt(28)
    s_mul_i32 s14, s8, 28672
    s_add_u32 s14, s14, 20480
    v_add_u32 v9, s14, v11
    v_add_u32 v10, s13, v11
    global_load_dwordx4 v[20:23], v10, s[6:7] offset:0
    global_load_dwordx4 v[24:27], v10, s[6:7] offset:1024
    global_load_dwordx4 v[28:31], v10, s[6:7] offset:2048
    global_load_dwordx4 v[32:35], v10, s[6:7] offset:3072
    v_add_u32 v10, 4096, v10
    global_load_dwordx4 v[36:39], v10, s[6:7] offset:0
    global_load_dwordx4 v[40:43], v10, s[6:7] offset:1024
    global_load_dwordx4 v[44:47], v10, s[6:7] offset:2048
    global_load_dwordx4 v[48:51], v10, s[6:7] offset:3072
    v_add_u32 v10, 4096, v10
    global_load_dwordx4 v[52:55], v10, s[6:7] offset:0
    global_load_dwordx4 v[56:59], v10, s[6:7] offset:1024
    global_load_dwordx4 v[60:63], v10, s[6:7] offset:2048
    global_load_dwordx4 v[64:67], v10, s[6:7] offset:3072
    v_add_u32 v10, 4096, v10
    global_load_dwordx4 v[68:71], v10, s[6:7] offset:0
    global_load_dwordx4 v[72:75], v10, s[6:7] offset:1024
    global_load_dwordx4 v[76:79], v10, s[6:7] offset:2048
    global_load_dwordx4 v[80:83], v10, s[6:7] offset:3072
    v_add_u32 v10, 4096, v10
    global_load_dwordx4 v[84:87], v10, s[6:7] offset:0
    global_load_dwordx4 v[88:91], v10, s[6:7] offset:1024
    global_load_dwordx4 v[92:95], v10, s[6:7] offset:2048
    global_load_dwordx4 v[96:99], v10, s[6:7] offset:3072
    v_add_u32 v10, 4096, v10
    global_load_dwordx4 v[100:103], v10, s[6:7] offset:0
    global_load_dwordx4 v[104:107], v10, s[6:7] offset:1024
    global_load_dwordx4 v[108:111], v10, s[6:7] offset:2048
    global_load_dwordx4 v[112:115], v10, s[6:7] offset:3072
    v_add_u32 v10, 4096, v10
    global_load_dwordx4 v[116:119], v10, s[6:7] offset:0
    global_load_dwordx4 v[120:123], v10, s[6:7] offset:1024
    global_load_dwordx4 v[124:127], v10, s[6:7] offset:2048
    global_load_dwordx4 v[128:131], v10, s[6:7] offset:3072
    v_add_u32 v10, 4096, v10
    s_waitcnt vmcnt(0)
    ds_write_b128 v9, v[20:23] offset:0
    ds_write_b128 v9, v[24:27] offset:1024
    ds_write_b128 v9, v[28:31] offset:2048
    ds_write_b128 v9, v[32:35] offset:3072
    ds_write_b128 v9, v[36:39] offset:4096
    ds_write_b128 v9, v[40:43] offset:5120
    ds_write_b128 v9, v[44:47] offset:6144
    ds_write_b128 v9, v[48:51] offset:7168
    ds_write_b128 v9, v[52:55] offset:8192
    ds_write_b128 v9, v[56:59] offset:9216
    ds_write_b128 v9, v[60:63] offset:10240
    ds_write_b128 v9, v[64:67] offset:11264
    ds_write_b128 v9, v[68:71] offset:12288
    ds_write_b128 v9, v[72:75] offset:13312
    ds_write_b128 v9, v[76:79] offset:14336
    ds_write_b128 v9, v[80:83] offset:15360
    ds_write_b128 v9, v[84:87] offset:16384
    ds_write_b128 v9, v[88:91] offset:17408
    ds_write_b128 v9, v[92:95] offset:18432
    ds_write_b128 v9, v[96:99] offset:19456
    ds_write_b128 v9, v[100:103] offset:20480
    ds_write_b128 v9, v[104:107] offset:21504
    ds_write_b128 v9, v[108:111] offset:22528
    ds_write_b128 v9, v[112:115] offset:23552
    ds_write_b128 v9, v[116:119] offset:24576
    ds_write_b128 v9, v[120:123] offset:25600
    ds_write_b128 v9, v[124:127] offset:26624
    ds_write_b128 v9, v[128:131] offset:27648
    s_waitcnt lgkmcnt(0)
    s_lshl_b32 s13, s8, 2
    s_mul_i32 s13, s13, 28
    s_lshl_b32 s14, s20, 1
    s_add_u32 s13, s13, s14
    s_lshl_b32 s13, s13, 10
    s_add_u32 s15, s13, 0x5e00000
    v_add_u32 v10, s15, v11
    s_lshl_b32 s13, s8, 1
    s_mul_i32 s13, s13, 28
    s_add_u32 s13, s13, s14
    s_lshl_b32 s13, s13, 10
    s_add_u32 s13, s13, 0x25c8000
    v_add_u32 v11, s13, v11
    s_mul_i32 s13, s8, 2560
    s_add_u32 s13, s13, 0x81c00
    v_lshlrev_b32 v12, 4, v1
    v_add_u32 v12, s13, v12
    s_lshl_b32 s13, s8, 11
    s_add_u32 s13, s13, 8192
    v_lshlrev_b32 v14, 9, v3
    v_lshl_add_u32 v14, v2, 2, v14
    v_add_u32 v14, s13, v14
    v_lshrrev_b32 v15, 3, v1
    v_lshlrev_b32 v15, 7, v15
    v_and_b32 v16, 7, v1
    v_lshl_add_u32 v15, v16, 4, v15
    v_add_u32 v15, 8192, v15
    s_lshl_b32 s13, s20, 9
    s_add_u32 s13, s13, 0x11c00
    v_lshrrev_b32 v17, 1, v16
    v_lshlrev_b32 v17, 7, v17
    v_and_b32 v16, 1, v16
    v_lshl_add_u32 v17, v16, 3, v17
    v_lshrrev_b32 v16, 3, v1
    v_lshl_add_u32 v17, v16, 4, v17
    v_add_u32 v16, s13, v17
    v_mov_b32 v136, 0
    v_mov_b32 v137, 0
    v_mov_b32 v138, 0
    v_mov_b32 v139, 0
    s_mov_b32 s22, -1
    s_mov_b32 s23, 0
    v_mov_b32 v1, 1
    s_mov_b32 s24, 0
    s_mov_b32 s25, 0x8508
.vloop_30:
.pm_34:
    global_load_dwordx4 v[160:163], v4, s[6:7] sc1
    global_load_dwordx4 v[164:167], v5, s[6:7] sc1
    s_sub_u32 s12, s12, 1
    s_cmp_eq_u32 s12, 0
    s_cbranch_scc1 .mg_end_12
    s_waitcnt vmcnt(0)
    v_max3_u32 v0, v160, v161, v162
    v_max3_u32 v0, v0, v163, v164
    v_max3_u32 v0, v0, v165, v166
    v_max_u32 v0, v0, v167
    v_cmp_eq_u32 vcc, -1, v0
    s_cbranch_vccnz .pm_34
    ds_write_b128 v6, v[160:163]
    ds_write_b128 v7, v[164:167]
    v_add_u32 v4, 7168, v4
    v_add_u32 v5, 7168, v5
    s_waitcnt lgkmcnt(0)
    s_barrier
    ds_read_b128 v[20:23], v8 offset:0
    ds_read_b128 v[24:27], v8 offset:512
    ds_read_b128 v[28:31], v8 offset:1024
    ds_read_b128 v[32:35], v9 offset:0
    ds_read_b128 v[36:39], v9 offset:14336
    ds_read_b128 v[40:43], v9 offset:1024
    ds_read_b128 v[44:47], v9 offset:15360
    s_and_b32 s13, s11, 1
    s_or_b32 s13, s13, s24
    s_cmp_lg_u32 s13, 0
    s_cbranch_scc1 .uf_36
    s_lshl_b32 s13, s11, 1
    s_add_u32 s13, s13, 0x8000
    v_mov_b32 v17, s13
    v_mov_b32 v19, 0x84b0
.uf_35:
    global_load_dword v18, v17, s[6:7] sc1
    global_load_dword v19, v19, s[6:7] sc1
    s_sub_u32 s12, s12, 1
    s_cmp_eq_u32 s12, 0
    s_cbranch_scc1 .mg_end_12
    s_waitcnt vmcnt(0)
    v_readfirstlane_b32 s13, v18
    v_readfirstlane_b32 s14, v19
    v_mov_b32 v19, 0x84b0
    s_nop 3
    s_cmp_lt_u32 s13, 16
    s_cbranch_scc1 .uf_35
    s_cmp_ge_u32 s14, 512
    s_cselect_b32 s24, 1, 0
.uf_36:
    s_waitcnt lgkmcnt(2)
    v_mfma_f32_16x16x32_bf16 v[48:51], v[20:23], a[0:3], 0
    v_mfma_f32_16x16x32_bf16 v[52:55], v[20:23], a[56:59], 0
    v_mfma_f32_16x16x32_bf16 v[56:59], v[20:23], a[112:115], 0
    v_mfma_f32_16x16x32_bf16 v[60:63], v[20:23], a[168:171], 0
    v_mfma_f32_16x16x32_bf16 v[64:67], v[20:23], a[224:227], 0
    v_mfma_f32_16x16x32_bf16 v[68:71], v[20:23], v[200:203], 0
    v_mfma_f32_16x16x32_bf16 v[72:75], v[20:23], v[32:35], 0
    v_mfma_f32_16x16x32_bf16 v[76:79], v[20:23], v[36:39], 0
    ds_read_b128 v[20:23], v8 offset:1536
    ds_read_b128 v[32:35], v9 offset:2048
    ds_read_b128 v[36:39], v9 offset:16384
    global_store_dwordx4 v11, v[80:83], s[6:7] offset:0 sc1
    global_store_dwordx4 v11, v[84:87], s[6:7] offset:1024 sc1
    v_add_u32 v18, 28672, v11
    global_store_dwordx4 v18, v[88:91], s[6:7] offset:0 sc1
    global_store_dwordx4 v18, v[92:95], s[6:7] offset:1024 sc1
    v_add_u32 v11, 229376, v11
    s_waitcnt lgkmcnt(3)
    v_mfma_f32_16x16x32_bf16 v[48:51], v[24:27], a[4:7], v[48:51]
    v_mfma_f32_16x16x32_bf16 v[52:55], v[24:27], a[60:63], v[52:55]
    v_mfma_f32_16x16x32_bf16 v[56:59], v[24:27], a[116:119], v[56:59]
    v_mfma_f32_16x16x32_bf16 v[60:63], v[24:27], a[172:175], v[60:63]
    v_mfma_f32_16x16x32_bf16 v[64:67], v[24:27], a[228:231], v[64:67]
    v_mfma_f32_16x16x32_bf16 v[68:71], v[24:27], v[204:207], v[68:71]
    v_mfma_f32_16x16x32_bf16 v[72:75], v[24:27], v[40:43], v[72:75]
    v_mfma_f32_16x16x32_bf16 v[76:79], v[24:27], v[44:47], v[76:79]
    ds_read_b128 v[24:27], v8 offset:2048
    ds_read_b128 v[40:43], v9 offset:3072
    ds_read_b128 v[44:47], v9 offset:17408
    s_cmp_eq_u32 s11, 0
    s_cbranch_scc1 .s0_37
    s_cmp_lg_u32 s8, 0
    s_cbranch_scc1 .s0_37
    v_add_u32 v18, 0x11e400, v16
    global_store_dwordx2 v18, v[168:169], s[6:7] sc1
.s0_37:
    s_lshl_b32 s13, s11, 2
    s_add_u32 s13, s13, s25
    s_add_u32 s13, s13, -8
    s_mov_b64 exec, 1
    v_mov_b32 v17, s13
    global_atomic_add v17, v1, s[6:7]
    s_mov_b64 exec, -1
    s_waitcnt lgkmcnt(3)
    v_mfma_f32_16x16x32_bf16 v[48:51], v[28:31], a[8:11], v[48:51]
    v_mfma_f32_16x16x32_bf16 v[52:55], v[28:31], a[64:67], v[52:55]
    v_mfma_f32_16x16x32_bf16 v[56:59], v[28:31], a[120:123], v[56:59]
    v_mfma_f32_16x16x32_bf16 v[60:63], v[28:31], a[176:179], v[60:63]
    v_mfma_f32_16x16x32_bf16 v[64:67], v[28:31], a[232:235], v[64:67]
    v_mfma_f32_16x16x32_bf16 v[68:71], v[28:31], v[208:211], v[68:71]
    v_mfma_f32_16x16x32_bf16 v[72:75], v[28:31], v[32:35], v[72:75]
    v_mfma_f32_16x16x32_bf16 v[76:79], v[28:31], v[36:39], v[76:79]
    ds_read_b128 v[28:31], v8 offset:2560
    ds_read_b128 v[32:35], v9 offset:4096
    ds_read_b128 v[36:39], v9 offset:18432
    global_load_dwordx4 v[96:99], v10, s[6:7] offset:0 sc1
    global_load_dwordx4 v[100:103], v10, s[6:7] offset:1024 sc1
    s_waitcnt lgkmcnt(3)
    v_mfma_f32_16x16x32_bf16 v[48:51], v[20:23], a[12:15], v[48:51]
    v_mfma_f32_16x16x32_bf16 v[52:55], v[20:23], a[68:71], v[52:55]
    v_mfma_f32_16x16x32_bf16 v[56:59], v[20:23], a[124:127], v[56:59]
    v_mfma_f32_16x16x32_bf16 v[60:63], v[20:23], a[180:183], v[60:63]
    v_mfma_f32_16x16x32_bf16 v[64:67], v[20:23], a[236:239], v[64:67]
    v_mfma_f32_16x16x32_bf16 v[68:71], v[20:23], v[212:215], v[68:71]
    v_mfma_f32_16x16x32_bf16 v[72:75], v[20:23], v[40:43], v[72:75]
    v_mfma_f32_16x16x32_bf16 v[76:79], v[20:23], v[44:47], v[76:79]
    ds_read_b128 v[20:23], v8 offset:3072
    ds_read_b128 v[40:43], v9 offset:5120
    ds_read_b128 v[44:47], v9 offset:19456
    v_add_u32 v18, 28672, v10
    global_load_dwordx4 v[104:107], v18, s[6:7] offset:0 sc1
    global_load_dwordx4 v[108:111], v18, s[6:7] offset:1024 sc1
    s_waitcnt lgkmcnt(3)
    v_mfma_f32_16x16x32_bf16 v[48:51], v[24:27], a[16:19], v[48:51]
    v_mfma_f32_16x16x32_bf16 v[52:55], v[24:27], a[72:75], v[52:55]
    v_mfma_f32_16x16x32_bf16 v[56:59], v[24:27], a[128:131], v[56:59]
    v_mfma_f32_16x16x32_bf16 v[60:63], v[24:27], a[184:187], v[60:63]
    v_mfma_f32_16x16x32_bf16 v[64:67], v[24:27], a[240:243], v[64:67]
    v_mfma_f32_16x16x32_bf16 v[68:71], v[24:27], v[216:219], v[68:71]
    v_mfma_f32_16x16x32_bf16 v[72:75], v[24:27], v[32:35], v[72:75]
    v_mfma_f32_16x16x32_bf16 v[76:79], v[24:27], v[36:39], v[76:79]
    ds_read_b128 v[24:27], v8 offset:3584
    ds_read_b128 v[32:35], v9 offset:6144
    ds_read_b128 v[36:39], v9 offset:20480
    v_add_u32 v18, 57344, v10
    global_load_dwordx4 v[112:115], v18, s[6:7] offset:0 sc1
    global_load_dwordx4 v[116:119], v18, s[6:7] offset:1024 sc1
    s_waitcnt lgkmcnt(3)
    v_mfma_f32_16x16x32_bf16 v[48:51], v[28:31], a[20:23], v[48:51]
    v_mfma_f32_16x16x32_bf16 v[52:55], v[28:31], a[76:79], v[52:55]
    v_mfma_f32_16x16x32_bf16 v[56:59], v[28:31], a[132:135], v[56:59]
    v_mfma_f32_16x16x32_bf16 v[60:63], v[28:31], a[188:191], v[60:63]
    v_mfma_f32_16x16x32_bf16 v[64:67], v[28:31], a[244:247], v[64:67]
    v_mfma_f32_16x16x32_bf16 v[68:71], v[28:31], v[220:223], v[68:71]
    v_mfma_f32_16x16x32_bf16 v[72:75], v[28:31], v[40:43], v[72:75]
    v_mfma_f32_16x16x32_bf16 v[76:79], v[28:31], v[44:47], v[76:79]
    ds_read_b128 v[28:31], v8 offset:4096
    ds_read_b128 v[40:43], v9 offset:7168
    ds_read_b128 v[44:47], v9 offset:21504
    v_add_u32 v18, 86016, v10
    global_load_dwordx4 v[120:123], v18, s[6:7] offset:0 sc1
    global_load_dwordx4 v[124:127], v18, s[6:7] offset:1024 sc1
    v_add_u32 v10, 458752, v10
    s_waitcnt lgkmcnt(3)
    v_mfma_f32_16x16x32_bf16 v[48:51], v[20:23], a[24:27], v[48:51]
    v_mfma_f32_16x16x32_bf16 v[52:55], v[20:23], a[80:83], v[52:55]
    v_mfma_f32_16x16x32_bf16 v[56:59], v[20:23], a[136:139], v[56:59]
    v_mfma_f32_16x16x32_bf16 v[60:63], v[20:23], a[192:195], v[60:63]
    v_mfma_f32_16x16x32_bf16 v[64:67], v[20:23], a[248:251], v[64:67]
    v_mfma_f32_16x16x32_bf16 v[68:71], v[20:23], v[224:227], v[68:71]
    v_mfma_f32_16x16x32_bf16 v[72:75], v[20:23], v[32:35], v[72:75]
    v_mfma_f32_16x16x32_bf16 v[76:79], v[20:23], v[36:39], v[76:79]
    ds_read_b128 v[20:23], v8 offset:4608
    ds_read_b128 v[32:35], v9 offset:8192
    ds_read_b128 v[36:39], v9 offset:22528
    s_waitcnt lgkmcnt(3)
    v_mfma_f32_16x16x32_bf16 v[48:51], v[24:27], a[28:31], v[48:51]
    v_mfma_f32_16x16x32_bf16 v[52:55], v[24:27], a[84:87], v[52:55]
    v_mfma_f32_16x16x32_bf16 v[56:59], v[24:27], a[140:143], v[56:59]
    v_mfma_f32_16x16x32_bf16 v[60:63], v[24:27], a[196:199], v[60:63]
    v_mfma_f32_16x16x32_bf16 v[64:67], v[24:27], a[252:255], v[64:67]
    v_mfma_f32_16x16x32_bf16 v[68:71], v[24:27], v[228:231], v[68:71]
    v_mfma_f32_16x16x32_bf16 v[72:75], v[24:27], v[40:43], v[72:75]
    v_mfma_f32_16x16x32_bf16 v[76:79], v[24:27], v[44:47], v[76:79]
    ds_read_b128 v[24:27], v8 offset:5120
    ds_read_b128 v[40:43], v9 offset:9216
    ds_read_b128 v[44:47], v9 offset:23552
    s_waitcnt lgkmcnt(3)
    v_mfma_f32_16x16x32_bf16 v[48:51], v[28:31], a[32:35], v[48:51]
    v_mfma_f32_16x16x32_bf16 v[52:55], v[28:31], a[88:91], v[52:55]
    v_mfma_f32_16x16x32_bf16 v[56:59], v[28:31], a[144:147], v[56:59]
    v_mfma_f32_16x16x32_bf16 v[60:63], v[28:31], a[200:203], v[60:63]
    v_mfma_f32_16x16x32_bf16 v[64:67], v[28:31], v[176:179], v[64:67]
    v_mfma_f32_16x16x32_bf16 v[68:71], v[28:31], v[232:235], v[68:71]
    v_mfma_f32_16x16x32_bf16 v[72:75], v[28:31], v[32:35], v[72:75]
    v_mfma_f32_16x16x32_bf16 v[76:79], v[28:31], v[36:39], v[76:79]
    ds_read_b128 v[28:31], v8 offset:5632
    ds_read_b128 v[32:35], v9 offset:10240
    ds_read_b128 v[36:39], v9 offset:24576
    s_waitcnt lgkmcnt(3)
    v_mfma_f32_16x16x32_bf16 v[48:51], v[20:23], a[36:39], v[48:51]
    v_mfma_f32_16x16x32_bf16 v[52:55], v[20:23], a[92:95], v[52:55]
    v_mfma_f32_16x16x32_bf16 v[56:59], v[20:23], a[148:151], v[56:59]
    v_mfma_f32_16x16x32_bf16 v[60:63], v[20:23], a[204:207], v[60:63]
    v_mfma_f32_16x16x32_bf16 v[64:67], v[20:23], v[180:183], v[64:67]
    v_mfma_f32_16x16x32_bf16 v[68:71], v[20:23], v[236:239], v[68:71]
    v_mfma_f32_16x16x32_bf16 v[72:75], v[20:23], v[40:43], v[72:75]
    v_mfma_f32_16x16x32_bf16 v[76:79], v[20:23], v[44:47], v[76:79]
    ds_read_b128 v[20:23], v8 offset:6144
    ds_read_b128 v[40:43], v9 offset:11264
    ds_read_b128 v[44:47], v9 offset:25600
    s_waitcnt lgkmcnt(3)
    v_mfma_f32_16x16x32_bf16 v[48:51], v[24:27], a[40:43], v[48:51]
    v_mfma_f32_16x16x32_bf16 v[52:55], v[24:27], a[96:99], v[52:55]
    v_mfma_f32_16x16x32_bf16 v[56:59], v[24:27], a[152:155], v[56:59]
    v_mfma_f32_16x16x32_bf16 v[60:63], v[24:27], a[208:211], v[60:63]
    v_mfma_f32_16x16x32_bf16 v[64:67], v[24:27], v[184:187], v[64:67]
    v_mfma_f32_16x16x32_bf16 v[68:71], v[24:27], v[240:243], v[68:71]
    v_mfma_f32_16x16x32_bf16 v[72:75], v[24:27], v[32:35], v[72:75]
    v_mfma_f32_16x16x32_bf16 v[76:79], v[24:27], v[36:39], v[76:79]
    ds_read_b128 v[24:27], v8 offset:6656
    ds_read_b128 v[32:35], v9 offset:12288
    ds_read_b128 v[36:39], v9 offset:26624
    s_waitcnt lgkmcnt(0)
    v_mfma_f32_16x16x32_bf16 v[48:51], v[28:31], a[44:47], v[48:51]
    v_mfma_f32_16x16x32_bf16 v[52:55], v[28:31], a[100:103], v[52:55]
    v_mfma_f32_16x16x32_bf16 v[56:59], v[28:31], a[156:159], v[56:59]
    v_mfma_f32_16x16x32_bf16 v[60:63], v[28:31], a[212:215], v[60:63]
    v_mfma_f32_16x16x32_bf16 v[64:67], v[28:31], v[188:191], v[64:67]
    v_mfma_f32_16x16x32_bf16 v[68:71], v[28:31], v[244:247], v[68:71]
    v_mfma_f32_16x16x32_bf16 v[72:75], v[28:31], v[40:43], v[72:75]
    v_mfma_f32_16x16x32_bf16 v[76:79], v[28:31], v[44:47], v[76:79]
    ds_read_b128 v[40:43], v9 offset:13312
    ds_read_b128 v[44:47], v9 offset:27648
    s_waitcnt lgkmcnt(0)
    v_mfma_f32_16x16x32_bf16 v[48:51], v[20:23], a[48:51], v[48:51]
    v_mfma_f32_16x16x32_bf16 v[52:55], v[20:23], a[104:107], v[52:55]
    v_mfma_f32_16x16x32_bf16 v[56:59], v[20:23], a[160:163], v[56:59]
    v_mfma_f32_16x16x32_bf16 v[60:63], v[20:23], a[216:219], v[60:63]
    v_mfma_f32_16x16x32_bf16 v[64:67], v[20:23], v[192:195], v[64:67]
    v_mfma_f32_16x16x32_bf16 v[68:71], v[20:23], v[248:251], v[68:71]
    v_mfma_f32_16x16x32_bf16 v[72:75], v[20:23], v[32:35], v[72:75]
    v_mfma_f32_16x16x32_bf16 v[76:79], v[20:23], v[36:39], v[76:79]
    s_waitcnt lgkmcnt(0)
    v_mfma_f32_16x16x32_bf16 v[48:51], v[24:27], a[52:55], v[48:51]
    v_mfma_f32_16x16x32_bf16 v[52:55], v[24:27], a[108:111], v[52:55]
    v_mfma_f32_16x16x32_bf16 v[56:59], v[24:27], a[164:167], v[56:59]
    v_mfma_f32_16x16x32_bf16 v[60:63], v[24:27], a[220:223], v[60:63]
    v_mfma_f32_16x16x32_bf16 v[64:67], v[24:27], v[196:199], v[64:67]
    v_mfma_f32_16x16x32_bf16 v[68:71], v[24:27], v[252:255], v[68:71]
    v_mfma_f32_16x16x32_bf16 v[72:75], v[24:27], v[40:43], v[72:75]
    v_mfma_f32_16x16x32_bf16 v[76:79], v[24:27], v[44:47], v[76:79]
    s_nop 7
    v_cvt_pk_bf16_f32 v80, v48, v49
    v_cvt_pk_bf16_f32 v81, v50, v51
    v_cvt_pk_bf16_f32 v82, v56, v57
    v_cvt_pk_bf16_f32 v83, v58, v59
    v_cvt_pk_bf16_f32 v84, v52, v53
    v_cvt_pk_bf16_f32 v85, v54, v55
    v_cvt_pk_bf16_f32 v86, v60, v61
    v_cvt_pk_bf16_f32 v87, v62, v63
    v_cvt_pk_bf16_f32 v88, v64, v65
    v_cvt_pk_bf16_f32 v89, v66, v67
    v_cvt_pk_bf16_f32 v90, v72, v73
    v_cvt_pk_bf16_f32 v91, v74, v75
    v_cvt_pk_bf16_f32 v92, v68, v69
    v_cvt_pk_bf16_f32 v93, v70, v71
    v_cvt_pk_bf16_f32 v94, v76, v77
    v_cvt_pk_bf16_f32 v95, v78, v79
    s_cmp_ge_u32 s11, 63
    s_cbranch_scc1 .vlast_32
.pp_38:
    global_load_dwordx4 v[128:131], v12, s[6:7] sc1
    global_load_dwordx4 v[132:135], v12, s[6:7] offset:1024 sc1
    s_mov_b64 exec, s[22:23]
    global_load_dwordx4 v[136:139], v12, s[6:7] offset:2048 sc1
    s_mov_b64 exec, -1
    s_sub_u32 s12, s12, 1
    s_cmp_eq_u32 s12, 0
    s_cbranch_scc1 .mg_end_12
    s_waitcnt vmcnt(0)
    v_max3_u32 v0, v128, v129, v130
    v_max3_u32 v17, v131, v132, v133
    v_max3_u32 v0, v0, v134, v135
    v_max3_u32 v17, v17, v136, v137
    v_max3_u32 v0, v0, v138, v139
    v_max_u32 v0, v0, v17
    v_cmp_eq_u32 vcc, -1, v0
    s_cbranch_vccnz .pp_38
    v_mfma_f32_16x16x32_bf16 v[152:155], v[128:131], v[96:99], 0
    v_mfma_f32_16x16x32_bf16 v[156:159], v[128:131], v[100:103], 0
    v_mfma_f32_16x16x32_bf16 v[144:147], v[128:131], v[104:107], 0
    v_mfma_f32_16x16x32_bf16 v[148:151], v[128:131], v[108:111], 0
    v_mfma_f32_16x16x32_bf16 v[152:155], v[132:135], v[112:115], v[152:155]
    v_mfma_f32_16x16x32_bf16 v[156:159], v[132:135], v[116:119], v[156:159]
    v_mfma_f32_16x16x32_bf16 v[144:147], v[132:135], v[120:123], v[144:147]
    v_mfma_f32_16x16x32_bf16 v[148:151], v[132:135], v[124:127], v[148:151]
    v_mfma_f32_16x16x32_bf16 v[152:155], v[136:139], v[80:83], v[152:155]
    v_mfma_f32_16x16x32_bf16 v[156:159], v[136:139], v[84:87], v[156:159]
    v_mfma_f32_16x16x32_bf16 v[144:147], v[136:139], v[88:91], v[144:147]
    v_mfma_f32_16x16x32_bf16 v[148:151], v[136:139], v[92:95], v[148:151]
    v_add_u32 v12, 10240, v12
    s_nop 6
    v_cndmask_b32 v152, v144, v152, s[22:23]
    v_cndmask_b32 v153, v145, v153, s[22:23]
    v_cndmask_b32 v154, v146, v154, s[22:23]
    v_cndmask_b32 v155, v147, v155, s[22:23]
    v_cndmask_b32 v156, v148, v156, s[22:23]
    v_cndmask_b32 v157, v149, v157, s[22:23]
    v_cndmask_b32 v158, v150, v158, s[22:23]
    v_cndmask_b32 v159, v151, v159, s[22:23]
    ds_write_b32 v14, v152 offset:0
    ds_write_b32 v14, v153 offset:128
    ds_write_b32 v14, v154 offset:256
    ds_write_b32 v14, v155 offset:384
    ds_write_b32 v14, v156 offset:64
    ds_write_b32 v14, v157 offset:192
    ds_write_b32 v14, v158 offset:320
    ds_write_b32 v14, v159 offset:448
    s_waitcnt lgkmcnt(0)
    s_barrier
    s_cmp_lg_u32 s8, 0
    s_cbranch_scc1 .vnext_31
    ds_read_b128 v[48:51], v15 offset:0
    ds_read_b128 v[52:55], v15 offset:1024
    ds_read_b128 v[56:59], v15 offset:2048
    ds_read_b128 v[60:63], v15 offset:3072
    ds_read_b128 v[64:67], v15 offset:4096
    ds_read_b128 v[68:71], v15 offset:5120
    ds_read_b128 v[72:75], v15 offset:6144
    ds_read_b128 v[76:79], v15 offset:7168
    s_waitcnt lgkmcnt(6)
    v_pk_add_f32 v[48:49], v[48:49], v[52:53]
    v_pk_add_f32 v[50:51], v[50:51], v[54:55]
    s_waitcnt lgkmcnt(4)
    v_pk_add_f32 v[56:57], v[56:57], v[60:61]
    v_pk_add_f32 v[58:59], v[58:59], v[62:63]
    s_waitcnt lgkmcnt(2)
    v_pk_add_f32 v[64:65], v[64:65], v[68:69]
    v_pk_add_f32 v[66:67], v[66:67], v[70:71]
    v_pk_add_f32 v[48:49], v[48:49], v[56:57]
    v_pk_add_f32 v[50:51], v[50:51], v[58:59]
    s_waitcnt lgkmcnt(0)
    v_pk_add_f32 v[72:73], v[72:73], v[76:77]
    v_pk_add_f32 v[74:75], v[74:75], v[78:79]
    v_pk_add_f32 v[64:65], v[64:65], v[72:73]
    v_pk_add_f32 v[66:67], v[66:67], v[74:75]
    v_pk_add_f32 v[48:49], v[48:49], v[64:65]
    v_pk_add_f32 v[50:51], v[50:51], v[66:67]
    v_cvt_pk_bf16_f32 v168, v48, v49
    v_min_u32 v168, 0xfffffffe, v168
    v_cvt_pk_bf16_f32 v169, v50, v51
    v_min_u32 v169, 0xfffffffe, v169
    s_cmp_eq_u32 s10, 0
    s_cbranch_scc0 .ps_39
    global_store_dwordx2 v16, v[168:169], s[6:7]
    s_branch .ps_40
.ps_39:
    global_store_dwordx2 v16, v[168:169], s[6:7] sc1
.ps_40:
    v_add_u32 v16, 7168, v16
.vnext_31:
    s_add_u32 s11, s11, 1
    s_branch .vloop_30
.vlast_32:
    global_store_dwordx4 v11, v[80:83], s[6:7] offset:0 sc1
    global_store_dwordx4 v11, v[84:87], s[6:7] offset:1024 sc1
    v_add_u32 v18, 28672, v11
    global_store_dwordx4 v18, v[88:91], s[6:7] offset:0 sc1
    global_store_dwordx4 v18, v[92:95], s[6:7] offset:1024 sc1
    v_add_u32 v11, 229376, v11
    s_waitcnt vmcnt(0)
    s_lshl_b32 s13, s11, 2
    s_add_u32 s13, s13, s25
    s_add_u32 s13, s13, -4
    s_mov_b64 exec, 1
    v_mov_b32 v17, s13
    global_atomic_add v17, v1, s[6:7]
    s_mov_b64 exec, -1
    s_lshl_b32 s13, s11, 2
    s_add_u32 s13, s13, s25
    s_mov_b64 exec, 1
    v_mov_b32 v17, s13
    global_atomic_add v17, v1, s[6:7]
    s_mov_b64 exec, -1
    s_branch .mg_end_12
.mg_worker_15:
    s_mov_b32 s39, 131072
.wk_loop_41:
    s_cmp_lg_u32 s8, 0
    s_cbranch_scc1 .ba_47
    s_mov_b64 exec, 1
    v_mov_b32 v4, 0x8680
    v_mov_b32 v5, 1
    global_atomic_add v6, v4, v5, s[6:7] sc0
    v_mov_b32 v4, s39
    s_waitcnt vmcnt(0)
    ds_write_b32 v4, v6
    s_waitcnt lgkmcnt(0)
    s_mov_b64 exec, -1
.ba_47:
    s_barrier
    v_mov_b32 v4, s39
    ds_read_b32 v6, v4
    s_xor_b32 s39, s39, 4
    s_waitcnt lgkmcnt(0)
    v_readfirstlane_b32 s38, v6
    s_nop 3
    s_cmp_ge_u32 s38, 1984
    s_cbranch_scc1 .mg_end_12
    s_cmp_lt_u32 s38, 1024
    s_cbranch_scc1 .wk_42
    s_sub_u32 s20, s38, 1024
    s_mul_i32 s9, s20, 4370
    s_lshr_b32 s9, s9, 16
    s_mul_i32 s22, s9, 15
    s_sub_u32 s22, s20, s22
    s_lshr_b32 s21, s9, 1
    s_cmp_lt_u32 s9, 3
    s_cbranch_scc1 .nc_48
    s_lshl_b32 s23, s9, 2
    s_add_u32 s23, s23, 0x84fc
    s_cmp_lg_u32 s8, 0
    s_cbranch_scc1 .wf_49
    v_mov_b32 v4, s23
.wf_50:
    global_load_dword v8, v4, s[6:7] sc1
    s_sub_u32 s12, s12, 1
    s_cmp_eq_u32 s12, 0
    s_cbranch_scc1 .mg_end_12
    s_waitcnt vmcnt(0)
    v_readfirstlane_b32 s13, v8
    s_nop 3
    s_cmp_lt_u32 s13, 56
    s_cbranch_scc1 .wf_51
    s_branch .wf_52
.wf_51:
    s_sleep 100
    s_branch .wf_50
.wf_52:
.wf_49:
    s_barrier
.nc_48:
    s_cmp_lt_u32 s22, 4
    s_cbranch_scc1 .wk_44
    s_cmp_lt_u32 s22, 11
    s_cbranch_scc1 .wk_45
    s_branch .wk_46
.wk_42:
    s_and_b32 s20, s38, 511
    s_lshr_b32 s21, s20, 4
    s_and_b32 s22, s20, 15
    v_lshlrev_b32 v4, 4, v1
    s_mul_i32 s23, s21, 57344
    s_add_u32 s23, s23, 0x200000
    v_add_u32 v5, s23, v4
    s_mul_i32 s24, s22, 28
    s_mul_i32 s25, s8, 7
    s_add_u32 s24, s24, s25
    s_mul_i32 s24, s24, 14336
    s_cmp_ge_u32 s38, 512
    s_cbranch_scc1 .wk_43
    s_add_u32 s24, s24, 0xd00000
    v_add_u32 v6, s24, v4
    v_add_u32 v7, 14336, v6
    v_add_u32 v8, 28672, v6
    v_add_u32 v9, 43008, v6
    v_add_u32 v10, 57344, v6
    v_add_u32 v11, 71680, v6
    v_add_u32 v12, 86016, v6
    v_add_u32 v216, 0, v5
    v_add_u32 v217, 14336, v5
    v_add_u32 v218, 28672, v5
    v_add_u32 v219, 43008, v5
    global_load_dwordx4 v[128:131], v6, s[6:7] offset:0
    global_load_dwordx4 v[132:135], v7, s[6:7] offset:0
    global_load_dwordx4 v[136:139], v8, s[6:7] offset:0
    global_load_dwordx4 v[140:143], v9, s[6:7] offset:0
    global_load_dwordx4 v[144:147], v10, s[6:7] offset:0
    global_load_dwordx4 v[148:151], v11, s[6:7] offset:0
    global_load_dwordx4 v[152:155], v12, s[6:7] offset:0
    global_load_dwordx4 v[156:159], v216, s[6:7] offset:0
    global_load_dwordx4 v[160:163], v217, s[6:7] offset:0
    global_load_dwordx4 v[164:167], v218, s[6:7] offset:0
    global_load_dwordx4 v[168:171], v219, s[6:7] offset:0
    global_load_dwordx4 v[172:175], v6, s[6:7] offset:1024
    global_load_dwordx4 v[176:179], v7, s[6:7] offset:1024
    global_load_dwordx4 v[180:183], v8, s[6:7] offset:1024
    global_load_dwordx4 v[184:187], v9, s[6:7] offset:1024
    global_load_dwordx4 v[188:191], v10, s[6:7] offset:1024
    global_load_dwordx4 v[192:195], v11, s[6:7] offset:1024
    global_load_dwordx4 v[196:199], v12, s[6:7] offset:1024
    global_load_dwordx4 v[200:203], v216, s[6:7] offset:1024
    global_load_dwordx4 v[204:207], v217, s[6:7] offset:1024
    global_load_dwordx4 v[208:211], v218, s[6:7] offset:1024
    global_load_dwordx4 v[212:215], v219, s[6:7] offset:1024
    s_waitcnt vmcnt(11)
    v_mfma_f32_16x16x32_bf16 v[16:19], v[156:159], v[128:131], 0
    v_mfma_f32_16x16x32_bf16 v[20:23], v[160:163], v[128:131], 0
    v_mfma_f32_16x16x32_bf16 v[24:27], v[164:167], v[128:131], 0
    v_mfma_f32_16x16x32_bf16 v[28:31], v[168:171], v[128:131], 0
    v_mfma_f32_16x16x32_bf16 v[32:35], v[156:159], v[132:135], 0
    v_mfma_f32_16x16x32_bf16 v[36:39], v[160:163], v[132:135], 0
    v_mfma_f32_16x16x32_bf16 v[40:43], v[164:167], v[132:135], 0
    v_mfma_f32_16x16x32_bf16 v[44:47], v[168:171], v[132:135], 0
    v_mfma_f32_16x16x32_bf16 v[48:51], v[156:159], v[136:139], 0
    v_mfma_f32_16x16x32_bf16 v[52:55], v[160:163], v[136:139], 0
    v_mfma_f32_16x16x32_bf16 v[56:59], v[164:167], v[136:139], 0
    v_mfma_f32_16x16x32_bf16 v[60:63], v[168:171], v[136:139], 0
    v_mfma_f32_16x16x32_bf16 v[64:67], v[156:159], v[140:143], 0
    v_mfma_f32_16x16x32_bf16 v[68:71], v[160:163], v[140:143], 0
    v_mfma_f32_16x16x32_bf16 v[72:75], v[164:167], v[140:143], 0
    v_mfma_f32_16x16x32_bf16 v[76:79], v[168:171], v[140:143], 0
    v_mfma_f32_16x16x32_bf16 v[80:83], v[156:159], v[144:147], 0
    v_mfma_f32_16x16x32_bf16 v[84:87], v[160:163], v[144:147], 0
    v_mfma_f32_16x16x32_bf16 v[88:91], v[164:167], v[144:147], 0
    v_mfma_f32_16x16x32_bf16 v[92:95], v[168:171], v[144:147], 0
    v_mfma_f32_16x16x32_bf16 v[96:99], v[156:159], v[148:151], 0
    v_mfma_f32_16x16x32_bf16 v[100:103], v[160:163], v[148:151], 0
    v_mfma_f32_16x16x32_bf16 v[104:107], v[164:167], v[148:151], 0
    v_mfma_f32_16x16x32_bf16 v[108:111], v[168:171], v[148:151], 0
    v_mfma_f32_16x16x32_bf16 v[112:115], v[156:159], v[152:155], 0
    v_mfma_f32_16x16x32_bf16 v[116:119], v[160:163], v[152:155], 0
    v_mfma_f32_16x16x32_bf16 v[120:123], v[164:167], v[152:155], 0
    v_mfma_f32_16x16x32_bf16 v[124:127], v[168:171], v[152:155], 0
    global_load_dwordx4 v[128:131], v6, s[6:7] offset:2048
    global_load_dwordx4 v[132:135], v7, s[6:7] offset:2048
    global_load_dwordx4 v[136:139], v8, s[6:7] offset:2048
    global_load_dwordx4 v[140:143], v9, s[6:7] offset:2048
    global_load_dwordx4 v[144:147], v10, s[6:7] offset:2048
    global_load_dwordx4 v[148:151], v11, s[6:7] offset:2048
    global_load_dwordx4 v[152:155], v12, s[6:7] offset:2048
    global_load_dwordx4 v[156:159], v216, s[6:7] offset:2048
    global_load_dwordx4 v[160:163], v217, s[6:7] offset:2048
    global_load_dwordx4 v[164:167], v218, s[6:7] offset:2048
    global_load_dwordx4 v[168:171], v219, s[6:7] offset:2048
    s_waitcnt vmcnt(11)
    v_mfma_f32_16x16x32_bf16 v[16:19], v[200:203], v[172:175], v[16:19]
    v_mfma_f32_16x16x32_bf16 v[20:23], v[204:207], v[172:175], v[20:23]
    v_mfma_f32_16x16x32_bf16 v[24:27], v[208:211], v[172:175], v[24:27]
    v_mfma_f32_16x16x32_bf16 v[28:31], v[212:215], v[172:175], v[28:31]
    v_mfma_f32_16x16x32_bf16 v[32:35], v[200:203], v[176:179], v[32:35]
    v_mfma_f32_16x16x32_bf16 v[36:39], v[204:207], v[176:179], v[36:39]
    v_mfma_f32_16x16x32_bf16 v[40:43], v[208:211], v[176:179], v[40:43]
    v_mfma_f32_16x16x32_bf16 v[44:47], v[212:215], v[176:179], v[44:47]
    v_mfma_f32_16x16x32_bf16 v[48:51], v[200:203], v[180:183], v[48:51]
    v_mfma_f32_16x16x32_bf16 v[52:55], v[204:207], v[180:183], v[52:55]
    v_mfma_f32_16x16x32_bf16 v[56:59], v[208:211], v[180:183], v[56:59]
    v_mfma_f32_16x16x32_bf16 v[60:63], v[212:215], v[180:183], v[60:63]
    v_mfma_f32_16x16x32_bf16 v[64:67], v[200:203], v[184:187], v[64:67]
    v_mfma_f32_16x16x32_bf16 v[68:71], v[204:207], v[184:187], v[68:71]
    v_mfma_f32_16x16x32_bf16 v[72:75], v[208:211], v[184:187], v[72:75]
    v_mfma_f32_16x16x32_bf16 v[76:79], v[212:215], v[184:187], v[76:79]
    v_mfma_f32_16x16x32_bf16 v[80:83], v[200:203], v[188:191], v[80:83]
    v_mfma_f32_16x16x32_bf16 v[84:87], v[204:207], v[188:191], v[84:87]
    v_mfma_f32_16x16x32_bf16 v[88:91], v[208:211], v[188:191], v[88:91]
    v_mfma_f32_16x16x32_bf16 v[92:95], v[212:215], v[188:191], v[92:95]
    v_mfma_f32_16x16x32_bf16 v[96:99], v[200:203], v[192:195], v[96:99]
    v_mfma_f32_16x16x32_bf16 v[100:103], v[204:207], v[192:195], v[100:103]
    v_mfma_f32_16x16x32_bf16 v[104:107], v[208:211], v[192:195], v[104:107]
    v_mfma_f32_16x16x32_bf16 v[108:111], v[212:215], v[192:195], v[108:111]
    v_mfma_f32_16x16x32_bf16 v[112:115], v[200:203], v[196:199], v[112:115]
    v_mfma_f32_16x16x32_bf16 v[116:119], v[204:207], v[196:199], v[116:119]
    v_mfma_f32_16x16x32_bf16 v[120:123], v[208:211], v[196:199], v[120:123]
    v_mfma_f32_16x16x32_bf16 v[124:127], v[212:215], v[196:199], v[124:127]
    global_load_dwordx4 v[172:175], v6, s[6:7] offset:3072
    global_load_dwordx4 v[176:179], v7, s[6:7] offset:3072
    global_load_dwordx4 v[180:183], v8, s[6:7] offset:3072
    global_load_dwordx4 v[184:187], v9, s[6:7] offset:3072
    global_load_dwordx4 v[188:191], v10, s[6:7] offset:3072
    global_load_dwordx4 v[192:195], v11, s[6:7] offset:3072
    global_load_dwordx4 v[196:199], v12, s[6:7] offset:3072
    global_load_dwordx4 v[200:203], v216, s[6:7] offset:3072
    global_load_dwordx4 v[204:207], v217, s[6:7] offset:3072
    global_load_dwordx4 v[208:211], v218, s[6:7] offset:3072
    global_load_dwordx4 v[212:215], v219, s[6:7] offset:3072
    v_add_u32 v6, 4096, v6
    v_add_u32 v7, 4096, v7
    v_add_u32 v8, 4096, v8
    v_add_u32 v9, 4096, v9
    v_add_u32 v10, 4096, v10
    v_add_u32 v11, 4096, v11
    v_add_u32 v12, 4096, v12
    v_add_u32 v216, 4096, v216
    v_add_u32 v217, 4096, v217
    v_add_u32 v218, 4096, v218
    v_add_u32 v219, 4096, v219
    s_waitcnt vmcnt(11)
    v_mfma_f32_16x16x32_bf16 v[16:19], v[156:159], v[128:131], v[16:19]
    v_mfma_f32_16x16x32_bf16 v[20:23], v[160:163], v[128:131], v[20:23]
    v_mfma_f32_16x16x32_bf16 v[24:27], v[164:167], v[128:131], v[24:27]
    v_mfma_f32_16x16x32_bf16 v[28:31], v[168:171], v[128:131], v[28:31]
    v_mfma_f32_16x16x32_bf16 v[32:35], v[156:159], v[132:135], v[32:35]
    v_mfma_f32_16x16x32_bf16 v[36:39], v[160:163], v[132:135], v[36:39]
    v_mfma_f32_16x16x32_bf16 v[40:43], v[164:167], v[132:135], v[40:43]
    v_mfma_f32_16x16x32_bf16 v[44:47], v[168:171], v[132:135], v[44:47]
    v_mfma_f32_16x16x32_bf16 v[48:51], v[156:159], v[136:139], v[48:51]
    v_mfma_f32_16x16x32_bf16 v[52:55], v[160:163], v[136:139], v[52:55]
    v_mfma_f32_16x16x32_bf16 v[56:59], v[164:167], v[136:139], v[56:59]
    v_mfma_f32_16x16x32_bf16 v[60:63], v[168:171], v[136:139], v[60:63]
    v_mfma_f32_16x16x32_bf16 v[64:67], v[156:159], v[140:143], v[64:67]
    v_mfma_f32_16x16x32_bf16 v[68:71], v[160:163], v[140:143], v[68:71]
    v_mfma_f32_16x16x32_bf16 v[72:75], v[164:167], v[140:143], v[72:75]
    v_mfma_f32_16x16x32_bf16 v[76:79], v[168:171], v[140:143], v[76:79]
    v_mfma_f32_16x16x32_bf16 v[80:83], v[156:159], v[144:147], v[80:83]
    v_mfma_f32_16x16x32_bf16 v[84:87], v[160:163], v[144:147], v[84:87]
    v_mfma_f32_16x16x32_bf16 v[88:91], v[164:167], v[144:147], v[88:91]
    v_mfma_f32_16x16x32_bf16 v[92:95], v[168:171], v[144:147], v[92:95]
    v_mfma_f32_16x16x32_bf16 v[96:99], v[156:159], v[148:151], v[96:99]
    v_mfma_f32_16x16x32_bf16 v[100:103], v[160:163], v[148:151], v[100:103]
    v_mfma_f32_16x16x32_bf16 v[104:107], v[164:167], v[148:151], v[104:107]
    v_mfma_f32_16x16x32_bf16 v[108:111], v[168:171], v[148:151], v[108:111]
    v_mfma_f32_16x16x32_bf16 v[112:115], v[156:159], v[152:155], v[112:115]
    v_mfma_f32_16x16x32_bf16 v[116:119], v[160:163], v[152:155], v[116:119]
    v_mfma_f32_16x16x32_bf16 v[120:123], v[164:167], v[152:155], v[120:123]
    v_mfma_f32_16x16x32_bf16 v[124:127], v[168:171], v[152:155], v[124:127]
    global_load_dwordx4 v[128:131], v6, s[6:7] offset:0
    global_load_dwordx4 v[132:135], v7, s[6:7] offset:0
    global_load_dwordx4 v[136:139], v8, s[6:7] offset:0
    global_load_dwordx4 v[140:143], v9, s[6:7] offset:0
    global_load_dwordx4 v[144:147], v10, s[6:7] offset:0
    global_load_dwordx4 v[148:151], v11, s[6:7] offset:0
    global_load_dwordx4 v[152:155], v12, s[6:7] offset:0
    global_load_dwordx4 v[156:159], v216, s[6:7] offset:0
    global_load_dwordx4 v[160:163], v217, s[6:7] offset:0
    global_load_dwordx4 v[164:167], v218, s[6:7] offset:0
    global_load_dwordx4 v[168:171], v219, s[6:7] offset:0
    s_waitcnt vmcnt(11)
    v_mfma_f32_16x16x32_bf16 v[16:19], v[200:203], v[172:175], v[16:19]
    v_mfma_f32_16x16x32_bf16 v[20:23], v[204:207], v[172:175], v[20:23]
    v_mfma_f32_16x16x32_bf16 v[24:27], v[208:211], v[172:175], v[24:27]
    v_mfma_f32_16x16x32_bf16 v[28:31], v[212:215], v[172:175], v[28:31]
    v_mfma_f32_16x16x32_bf16 v[32:35], v[200:203], v[176:179], v[32:35]
    v_mfma_f32_16x16x32_bf16 v[36:39], v[204:207], v[176:179], v[36:39]
    v_mfma_f32_16x16x32_bf16 v[40:43], v[208:211], v[176:179], v[40:43]
    v_mfma_f32_16x16x32_bf16 v[44:47], v[212:215], v[176:179], v[44:47]
    v_mfma_f32_16x16x32_bf16 v[48:51], v[200:203], v[180:183], v[48:51]
    v_mfma_f32_16x16x32_bf16 v[52:55], v[204:207], v[180:183], v[52:55]
    v_mfma_f32_16x16x32_bf16 v[56:59], v[208:211], v[180:183], v[56:59]
    v_mfma_f32_16x16x32_bf16 v[60:63], v[212:215], v[180:183], v[60:63]
    v_mfma_f32_16x16x32_bf16 v[64:67], v[200:203], v[184:187], v[64:67]
    v_mfma_f32_16x16x32_bf16 v[68:71], v[204:207], v[184:187], v[68:71]
    v_mfma_f32_16x16x32_bf16 v[72:75], v[208:211], v[184:187], v[72:75]
    v_mfma_f32_16x16x32_bf16 v[76:79], v[212:215], v[184:187], v[76:79]
    v_mfma_f32_16x16x32_bf16 v[80:83], v[200:203], v[188:191], v[80:83]
    v_mfma_f32_16x16x32_bf16 v[84:87], v[204:207], v[188:191], v[84:87]
    v_mfma_f32_16x16x32_bf16 v[88:91], v[208:211], v[188:191], v[88:91]
    v_mfma_f32_16x16x32_bf16 v[92:95], v[212:215], v[188:191], v[92:95]
    v_mfma_f32_16x16x32_bf16 v[96:99], v[200:203], v[192:195], v[96:99]
    v_mfma_f32_16x16x32_bf16 v[100:103], v[204:207], v[192:195], v[100:103]
    v_mfma_f32_16x16x32_bf16 v[104:107], v[208:211], v[192:195], v[104:107]
    v_mfma_f32_16x16x32_bf16 v[108:111], v[212:215], v[192:195], v[108:111]
    v_mfma_f32_16x16x32_bf16 v[112:115], v[200:203], v[196:199], v[112:115]
    v_mfma_f32_16x16x32_bf16 v[116:119], v[204:207], v[196:199], v[116:119]
    v_mfma_f32_16x16x32_bf16 v[120:123], v[208:211], v[196:199], v[120:123]
    v_mfma_f32_16x16x32_bf16 v[124:127], v[212:215], v[196:199], v[124:127]
    global_load_dwordx4 v[172:175], v6, s[6:7] offset:1024
    global_load_dwordx4 v[176:179], v7, s[6:7] offset:1024
    global_load_dwordx4 v[180:183], v8, s[6:7] offset:1024
    global_load_dwordx4 v[184:187], v9, s[6:7] offset:1024
    global_load_dwordx4 v[188:191], v10, s[6:7] offset:1024
    global_load_dwordx4 v[192:195], v11, s[6:7] offset:1024
    global_load_dwordx4 v[196:199], v12, s[6:7] offset:1024
    global_load_dwordx4 v[200:203], v216, s[6:7] offset:1024
    global_load_dwordx4 v[204:207], v217, s[6:7] offset:1024
    global_load_dwordx4 v[208:211], v218, s[6:7] offset:1024
    global_load_dwordx4 v[212:215], v219, s[6:7] offset:1024
    s_waitcnt vmcnt(11)
    v_mfma_f32_16x16x32_bf16 v[16:19], v[156:159], v[128:131], v[16:19]
    v_mfma_f32_16x16x32_bf16 v[20:23], v[160:163], v[128:131], v[20:23]
    v_mfma_f32_16x16x32_bf16 v[24:27], v[164:167], v[128:131], v[24:27]
    v_mfma_f32_16x16x32_bf16 v[28:31], v[168:171], v[128:131], v[28:31]
    v_mfma_f32_16x16x32_bf16 v[32:35], v[156:159], v[132:135], v[32:35]
    v_mfma_f32_16x16x32_bf16 v[36:39], v[160:163], v[132:135], v[36:39]
    v_mfma_f32_16x16x32_bf16 v[40:43], v[164:167], v[132:135], v[40:43]
    v_mfma_f32_16x16x32_bf16 v[44:47], v[168:171], v[132:135], v[44:47]
    v_mfma_f32_16x16x32_bf16 v[48:51], v[156:159], v[136:139], v[48:51]
    v_mfma_f32_16x16x32_bf16 v[52:55], v[160:163], v[136:139], v[52:55]
    v_mfma_f32_16x16x32_bf16 v[56:59], v[164:167], v[136:139], v[56:59]
    v_mfma_f32_16x16x32_bf16 v[60:63], v[168:171], v[136:139], v[60:63]
    v_mfma_f32_16x16x32_bf16 v[64:67], v[156:159], v[140:143], v[64:67]
    v_mfma_f32_16x16x32_bf16 v[68:71], v[160:163], v[140:143], v[68:71]
    v_mfma_f32_16x16x32_bf16 v[72:75], v[164:167], v[140:143], v[72:75]
    v_mfma_f32_16x16x32_bf16 v[76:79], v[168:171], v[140:143], v[76:79]
    v_mfma_f32_16x16x32_bf16 v[80:83], v[156:159], v[144:147], v[80:83]
    v_mfma_f32_16x16x32_bf16 v[84:87], v[160:163], v[144:147], v[84:87]
    v_mfma_f32_16x16x32_bf16 v[88:91], v[164:167], v[144:147], v[88:91]
    v_mfma_f32_16x16x32_bf16 v[92:95], v[168:171], v[144:147], v[92:95]
    v_mfma_f32_16x16x32_bf16 v[96:99], v[156:159], v[148:151], v[96:99]
    v_mfma_f32_16x16x32_bf16 v[100:103], v[160:163], v[148:151], v[100:103]
    v_mfma_f32_16x16x32_bf16 v[104:107], v[164:167], v[148:151], v[104:107]
    v_mfma_f32_16x16x32_bf16 v[108:111], v[168:171], v[148:151], v[108:111]
    v_mfma_f32_16x16x32_bf16 v[112:115], v[156:159], v[152:155], v[112:115]
    v_mfma_f32_16x16x32_bf16 v[116:119], v[160:163], v[152:155], v[116:119]
    v_mfma_f32_16x16x32_bf16 v[120:123], v[164:167], v[152:155], v[120:123]
    v_mfma_f32_16x16x32_bf16 v[124:127], v[168:171], v[152:155], v[124:127]
    global_load_dwordx4 v[128:131], v6, s[6:7] offset:2048
    global_load_dwordx4 v[132:135], v7, s[6:7] offset:2048
    global_load_dwordx4 v[136:139], v8, s[6:7] offset:2048
    global_load_dwordx4 v[140:143], v9, s[6:7] offset:2048
    global_load_dwordx4 v[144:147], v10, s[6:7] offset:2048
    global_load_dwordx4 v[148:151], v11, s[6:7] offset:2048
    global_load_dwordx4 v[152:155], v12, s[6:7] offset:2048
    global_load_dwordx4 v[156:159], v216, s[6:7] offset:2048
    global_load_dwordx4 v[160:163], v217, s[6:7] offset:2048
    global_load_dwordx4 v[164:167], v218, s[6:7] offset:2048
    global_load_dwordx4 v[168:171], v219, s[6:7] offset:2048
    s_waitcnt vmcnt(11)
    v_mfma_f32_16x16x32_bf16 v[16:19], v[200:203], v[172:175], v[16:19]
    v_mfma_f32_16x16x32_bf16 v[20:23], v[204:207], v[172:175], v[20:23]
    v_mfma_f32_16x16x32_bf16 v[24:27], v[208:211], v[172:175], v[24:27]
    v_mfma_f32_16x16x32_bf16 v[28:31], v[212:215], v[172:175], v[28:31]
    v_mfma_f32_16x16x32_bf16 v[32:35], v[200:203], v[176:179], v[32:35]
    v_mfma_f32_16x16x32_bf16 v[36:39], v[204:207], v[176:179], v[36:39]
    v_mfma_f32_16x16x32_bf16 v[40:43], v[208:211], v[176:179], v[40:43]
    v_mfma_f32_16x16x32_bf16 v[44:47], v[212:215], v[176:179], v[44:47]
    v_mfma_f32_16x16x32_bf16 v[48:51], v[200:203], v[180:183], v[48:51]
    v_mfma_f32_16x16x32_bf16 v[52:55], v[204:207], v[180:183], v[52:55]
    v_mfma_f32_16x16x32_bf16 v[56:59], v[208:211], v[180:183], v[56:59]
    v_mfma_f32_16x16x32_bf16 v[60:63], v[212:215], v[180:183], v[60:63]
    v_mfma_f32_16x16x32_bf16 v[64:67], v[200:203], v[184:187], v[64:67]
    v_mfma_f32_16x16x32_bf16 v[68:71], v[204:207], v[184:187], v[68:71]
    v_mfma_f32_16x16x32_bf16 v[72:75], v[208:211], v[184:187], v[72:75]
    v_mfma_f32_16x16x32_bf16 v[76:79], v[212:215], v[184:187], v[76:79]
    v_mfma_f32_16x16x32_bf16 v[80:83], v[200:203], v[188:191], v[80:83]
    v_mfma_f32_16x16x32_bf16 v[84:87], v[204:207], v[188:191], v[84:87]
    v_mfma_f32_16x16x32_bf16 v[88:91], v[208:211], v[188:191], v[88:91]
    v_mfma_f32_16x16x32_bf16 v[92:95], v[212:215], v[188:191], v[92:95]
    v_mfma_f32_16x16x32_bf16 v[96:99], v[200:203], v[192:195], v[96:99]
    v_mfma_f32_16x16x32_bf16 v[100:103], v[204:207], v[192:195], v[100:103]
    v_mfma_f32_16x16x32_bf16 v[104:107], v[208:211], v[192:195], v[104:107]
    v_mfma_f32_16x16x32_bf16 v[108:111], v[212:215], v[192:195], v[108:111]
    v_mfma_f32_16x16x32_bf16 v[112:115], v[200:203], v[196:199], v[112:115]
    v_mfma_f32_16x16x32_bf16 v[116:119], v[204:207], v[196:199], v[116:119]
    v_mfma_f32_16x16x32_bf16 v[120:123], v[208:211], v[196:199], v[120:123]
    v_mfma_f32_16x16x32_bf16 v[124:127], v[212:215], v[196:199], v[124:127]
    global_load_dwordx4 v[172:175], v6, s[6:7] offset:3072
    global_load_dwordx4 v[176:179], v7, s[6:7] offset:3072
    global_load_dwordx4 v[180:183], v8, s[6:7] offset:3072
    global_load_dwordx4 v[184:187], v9, s[6:7] offset:3072
    global_load_dwordx4 v[188:191], v10, s[6:7] offset:3072
    global_load_dwordx4 v[192:195], v11, s[6:7] offset:3072
    global_load_dwordx4 v[196:199], v12, s[6:7] offset:3072
    global_load_dwordx4 v[200:203], v216, s[6:7] offset:3072
    global_load_dwordx4 v[204:207], v217, s[6:7] offset:3072
    global_load_dwordx4 v[208:211], v218, s[6:7] offset:3072
    global_load_dwordx4 v[212:215], v219, s[6:7] offset:3072
    v_add_u32 v6, 4096, v6
    v_add_u32 v7, 4096, v7
    v_add_u32 v8, 4096, v8
    v_add_u32 v9, 4096, v9
    v_add_u32 v10, 4096, v10
    v_add_u32 v11, 4096, v11
    v_add_u32 v12, 4096, v12
    v_add_u32 v216, 4096, v216
    v_add_u32 v217, 4096, v217
    v_add_u32 v218, 4096, v218
    v_add_u32 v219, 4096, v219
    s_waitcnt vmcnt(11)
    v_mfma_f32_16x16x32_bf16 v[16:19], v[156:159], v[128:131], v[16:19]
    v_mfma_f32_16x16x32_bf16 v[20:23], v[160:163], v[128:131], v[20:23]
    v_mfma_f32_16x16x32_bf16 v[24:27], v[164:167], v[128:131], v[24:27]
    v_mfma_f32_16x16x32_bf16 v[28:31], v[168:171], v[128:131], v[28:31]
    v_mfma_f32_16x16x32_bf16 v[32:35], v[156:159], v[132:135], v[32:35]
    v_mfma_f32_16x16x32_bf16 v[36:39], v[160:163], v[132:135], v[36:39]
    v_mfma_f32_16x16x32_bf16 v[40:43], v[164:167], v[132:135], v[40:43]
    v_mfma_f32_16x16x32_bf16 v[44:47], v[168:171], v[132:135], v[44:47]
    v_mfma_f32_16x16x32_bf16 v[48:51], v[156:159], v[136:139], v[48:51]
    v_mfma_f32_16x16x32_bf16 v[52:55], v[160:163], v[136:139], v[52:55]
    v_mfma_f32_16x16x32_bf16 v[56:59], v[164:167], v[136:139], v[56:59]
    v_mfma_f32_16x16x32_bf16 v[60:63], v[168:171], v[136:139], v[60:63]
    v_mfma_f32_16x16x32_bf16 v[64:67], v[156:159], v[140:143], v[64:67]
    v_mfma_f32_16x16x32_bf16 v[68:71], v[160:163], v[140:143], v[68:71]
    v_mfma_f32_16x16x32_bf16 v[72:75], v[164:167], v[140:143], v[72:75]
    v_mfma_f32_16x16x32_bf16 v[76:79], v[168:171], v[140:143], v[76:79]
    v_mfma_f32_16x16x32_bf16 v[80:83], v[156:159], v[144:147], v[80:83]
    v_mfma_f32_16x16x32_bf16 v[84:87], v[160:163], v[144:147], v[84:87]
    v_mfma_f32_16x16x32_bf16 v[88:91], v[164:167], v[144:147], v[88:91]
    v_mfma_f32_16x16x32_bf16 v[92:95], v[168:171], v[144:147], v[92:95]
    v_mfma_f32_16x16x32_bf16 v[96:99], v[156:159], v[148:151], v[96:99]
    v_mfma_f32_16x16x32_bf16 v[100:103], v[160:163], v[148:151], v[100:103]
    v_mfma_f32_16x16x32_bf16 v[104:107], v[164:167], v[148:151], v[104:107]
    v_mfma_f32_16x16x32_bf16 v[108:111], v[168:171], v[148:151], v[108:111]
    v_mfma_f32_16x16x32_bf16 v[112:115], v[156:159], v[152:155], v[112:115]
    v_mfma_f32_16x16x32_bf16 v[116:119], v[160:163], v[152:155], v[116:119]
    v_mfma_f32_16x16x32_bf16 v[120:123], v[164:167], v[152:155], v[120:123]
    v_mfma_f32_16x16x32_bf16 v[124:127], v[168:171], v[152:155], v[124:127]
    global_load_dwordx4 v[128:131], v6, s[6:7] offset:0
    global_load_dwordx4 v[132:135], v7, s[6:7] offset:0
    global_load_dwordx4 v[136:139], v8, s[6:7] offset:0
    global_load_dwordx4 v[140:143], v9, s[6:7] offset:0
    global_load_dwordx4 v[144:147], v10, s[6:7] offset:0
    global_load_dwordx4 v[148:151], v11, s[6:7] offset:0
    global_load_dwordx4 v[152:155], v12, s[6:7] offset:0
    global_load_dwordx4 v[156:159], v216, s[6:7] offset:0
    global_load_dwordx4 v[160:163], v217, s[6:7] offset:0
    global_load_dwordx4 v[164:167], v218, s[6:7] offset:0
    global_load_dwordx4 v[168:171], v219, s[6:7] offset:0
    s_waitcnt vmcnt(11)
    v_mfma_f32_16x16x32_bf16 v[16:19], v[200:203], v[172:175], v[16:19]
    v_mfma_f32_16x16x32_bf16 v[20:23], v[204:207], v[172:175], v[20:23]
    v_mfma_f32_16x16x32_bf16 v[24:27], v[208:211], v[172:175], v[24:27]
    v_mfma_f32_16x16x32_bf16 v[28:31], v[212:215], v[172:175], v[28:31]
    v_mfma_f32_16x16x32_bf16 v[32:35], v[200:203], v[176:179], v[32:35]
    v_mfma_f32_16x16x32_bf16 v[36:39], v[204:207], v[176:179], v[36:39]
    v_mfma_f32_16x16x32_bf16 v[40:43], v[208:211], v[176:179], v[40:43]
    v_mfma_f32_16x16x32_bf16 v[44:47], v[212:215], v[176:179], v[44:47]
    v_mfma_f32_16x16x32_bf16 v[48:51], v[200:203], v[180:183], v[48:51]
    v_mfma_f32_16x16x32_bf16 v[52:55], v[204:207], v[180:183], v[52:55]
    v_mfma_f32_16x16x32_bf16 v[56:59], v[208:211], v[180:183], v[56:59]
    v_mfma_f32_16x16x32_bf16 v[60:63], v[212:215], v[180:183], v[60:63]
    v_mfma_f32_16x16x32_bf16 v[64:67], v[200:203], v[184:187], v[64:67]
    v_mfma_f32_16x16x32_bf16 v[68:71], v[204:207], v[184:187], v[68:71]
    v_mfma_f32_16x16x32_bf16 v[72:75], v[208:211], v[184:187], v[72:75]
    v_mfma_f32_16x16x32_bf16 v[76:79], v[212:215], v[184:187], v[76:79]
    v_mfma_f32_16x16x32_bf16 v[80:83], v[200:203], v[188:191], v[80:83]
    v_mfma_f32_16x16x32_bf16 v[84:87], v[204:207], v[188:191], v[84:87]
    v_mfma_f32_16x16x32_bf16 v[88:91], v[208:211], v[188:191], v[88:91]
    v_mfma_f32_16x16x32_bf16 v[92:95], v[212:215], v[188:191], v[92:95]
    v_mfma_f32_16x16x32_bf16 v[96:99], v[200:203], v[192:195], v[96:99]
    v_mfma_f32_16x16x32_bf16 v[100:103], v[204:207], v[192:195], v[100:103]
    v_mfma_f32_16x16x32_bf16 v[104:107], v[208:211], v[192:195], v[104:107]
    v_mfma_f32_16x16x32_bf16 v[108:111], v[212:215], v[192:195], v[108:111]
    v_mfma_f32_16x16x32_bf16 v[112:115], v[200:203], v[196:199], v[112:115]
    v_mfma_f32_16x16x32_bf16 v[116:119], v[204:207], v[196:199], v[116:119]
    v_mfma_f32_16x16x32_bf16 v[120:123], v[208:211], v[196:199], v[120:123]
    v_mfma_f32_16x16x32_bf16 v[124:127], v[212:215], v[196:199], v[124:127]
    global_load_dwordx4 v[172:175], v6, s[6:7] offset:1024
    global_load_dwordx4 v[176:179], v7, s[6:7] offset:1024
    global_load_dwordx4 v[180:183], v8, s[6:7] offset:1024
    global_load_dwordx4 v[184:187], v9, s[6:7] offset:1024
    global_load_dwordx4 v[188:191], v10, s[6:7] offset:1024
    global_load_dwordx4 v[192:195], v11, s[6:7] offset:1024
    global_load_dwordx4 v[196:199], v12, s[6:7] offset:1024
    global_load_dwordx4 v[200:203], v216, s[6:7] offset:1024
    global_load_dwordx4 v[204:207], v217, s[6:7] offset:1024
    global_load_dwordx4 v[208:211], v218, s[6:7] offset:1024
    global_load_dwordx4 v[212:215], v219, s[6:7] offset:1024
    s_waitcnt vmcnt(11)
    v_mfma_f32_16x16x32_bf16 v[16:19], v[156:159], v[128:131], v[16:19]
    v_mfma_f32_16x16x32_bf16 v[20:23], v[160:163], v[128:131], v[20:23]
    v_mfma_f32_16x16x32_bf16 v[24:27], v[164:167], v[128:131], v[24:27]
    v_mfma_f32_16x16x32_bf16 v[28:31], v[168:171], v[128:131], v[28:31]
    v_mfma_f32_16x16x32_bf16 v[32:35], v[156:159], v[132:135], v[32:35]
    v_mfma_f32_16x16x32_bf16 v[36:39], v[160:163], v[132:135], v[36:39]
    v_mfma_f32_16x16x32_bf16 v[40:43], v[164:167], v[132:135], v[40:43]
    v_mfma_f32_16x16x32_bf16 v[44:47], v[168:171], v[132:135], v[44:47]
    v_mfma_f32_16x16x32_bf16 v[48:51], v[156:159], v[136:139], v[48:51]
    v_mfma_f32_16x16x32_bf16 v[52:55], v[160:163], v[136:139], v[52:55]
    v_mfma_f32_16x16x32_bf16 v[56:59], v[164:167], v[136:139], v[56:59]
    v_mfma_f32_16x16x32_bf16 v[60:63], v[168:171], v[136:139], v[60:63]
    v_mfma_f32_16x16x32_bf16 v[64:67], v[156:159], v[140:143], v[64:67]
    v_mfma_f32_16x16x32_bf16 v[68:71], v[160:163], v[140:143], v[68:71]
    v_mfma_f32_16x16x32_bf16 v[72:75], v[164:167], v[140:143], v[72:75]
    v_mfma_f32_16x16x32_bf16 v[76:79], v[168:171], v[140:143], v[76:79]
    v_mfma_f32_16x16x32_bf16 v[80:83], v[156:159], v[144:147], v[80:83]
    v_mfma_f32_16x16x32_bf16 v[84:87], v[160:163], v[144:147], v[84:87]
    v_mfma_f32_16x16x32_bf16 v[88:91], v[164:167], v[144:147], v[88:91]
    v_mfma_f32_16x16x32_bf16 v[92:95], v[168:171], v[144:147], v[92:95]
    v_mfma_f32_16x16x32_bf16 v[96:99], v[156:159], v[148:151], v[96:99]
    v_mfma_f32_16x16x32_bf16 v[100:103], v[160:163], v[148:151], v[100:103]
    v_mfma_f32_16x16x32_bf16 v[104:107], v[164:167], v[148:151], v[104:107]
    v_mfma_f32_16x16x32_bf16 v[108:111], v[168:171], v[148:151], v[108:111]
    v_mfma_f32_16x16x32_bf16 v[112:115], v[156:159], v[152:155], v[112:115]
    v_mfma_f32_16x16x32_bf16 v[116:119], v[160:163], v[152:155], v[116:119]
    v_mfma_f32_16x16x32_bf16 v[120:123], v[164:167], v[152:155], v[120:123]
    v_mfma_f32_16x16x32_bf16 v[124:127], v[168:171], v[152:155], v[124:127]
    global_load_dwordx4 v[128:131], v6, s[6:7] offset:2048
    global_load_dwordx4 v[132:135], v7, s[6:7] offset:2048
    global_load_dwordx4 v[136:139], v8, s[6:7] offset:2048
    global_load_dwordx4 v[140:143], v9, s[6:7] offset:2048
    global_load_dwordx4 v[144:147], v10, s[6:7] offset:2048
    global_load_dwordx4 v[148:151], v11, s[6:7] offset:2048
    global_load_dwordx4 v[152:155], v12, s[6:7] offset:2048
    global_load_dwordx4 v[156:159], v216, s[6:7] offset:2048
    global_load_dwordx4 v[160:163], v217, s[6:7] offset:2048
    global_load_dwordx4 v[164:167], v218, s[6:7] offset:2048
    global_load_dwordx4 v[168:171], v219, s[6:7] offset:2048
    s_waitcnt vmcnt(11)
    v_mfma_f32_16x16x32_bf16 v[16:19], v[200:203], v[172:175], v[16:19]
    v_mfma_f32_16x16x32_bf16 v[20:23], v[204:207], v[172:175], v[20:23]
    v_mfma_f32_16x16x32_bf16 v[24:27], v[208:211], v[172:175], v[24:27]
    v_mfma_f32_16x16x32_bf16 v[28:31], v[212:215], v[172:175], v[28:31]
    v_mfma_f32_16x16x32_bf16 v[32:35], v[200:203], v[176:179], v[32:35]
    v_mfma_f32_16x16x32_bf16 v[36:39], v[204:207], v[176:179], v[36:39]
    v_mfma_f32_16x16x32_bf16 v[40:43], v[208:211], v[176:179], v[40:43]
    v_mfma_f32_16x16x32_bf16 v[44:47], v[212:215], v[176:179], v[44:47]
    v_mfma_f32_16x16x32_bf16 v[48:51], v[200:203], v[180:183], v[48:51]
    v_mfma_f32_16x16x32_bf16 v[52:55], v[204:207], v[180:183], v[52:55]
    v_mfma_f32_16x16x32_bf16 v[56:59], v[208:211], v[180:183], v[56:59]
    v_mfma_f32_16x16x32_bf16 v[60:63], v[212:215], v[180:183], v[60:63]
    v_mfma_f32_16x16x32_bf16 v[64:67], v[200:203], v[184:187], v[64:67]
    v_mfma_f32_16x16x32_bf16 v[68:71], v[204:207], v[184:187], v[68:71]
    v_mfma_f32_16x16x32_bf16 v[72:75], v[208:211], v[184:187], v[72:75]
    v_mfma_f32_16x16x32_bf16 v[76:79], v[212:215], v[184:187], v[76:79]
    v_mfma_f32_16x16x32_bf16 v[80:83], v[200:203], v[188:191], v[80:83]
    v_mfma_f32_16x16x32_bf16 v[84:87], v[204:207], v[188:191], v[84:87]
    v_mfma_f32_16x16x32_bf16 v[88:91], v[208:211], v[188:191], v[88:91]
    v_mfma_f32_16x16x32_bf16 v[92:95], v[212:215], v[188:191], v[92:95]
    v_mfma_f32_16x16x32_bf16 v[96:99], v[200:203], v[192:195], v[96:99]
    v_mfma_f32_16x16x32_bf16 v[100:103], v[204:207], v[192:195], v[100:103]
    v_mfma_f32_16x16x32_bf16 v[104:107], v[208:211], v[192:195], v[104:107]
    v_mfma_f32_16x16x32_bf16 v[108:111], v[212:215], v[192:195], v[108:111]
    v_mfma_f32_16x16x32_bf16 v[112:115], v[200:203], v[196:199], v[112:115]
    v_mfma_f32_16x16x32_bf16 v[116:119], v[204:207], v[196:199], v[116:119]
    v_mfma_f32_16x16x32_bf16 v[120:123], v[208:211], v[196:199], v[120:123]
    v_mfma_f32_16x16x32_bf16 v[124:127], v[212:215], v[196:199], v[124:127]
    global_load_dwordx4 v[172:175], v6, s[6:7] offset:3072
    global_load_dwordx4 v[176:179], v7, s[6:7] offset:3072
    global_load_dwordx4 v[180:183], v8, s[6:7] offset:3072
    global_load_dwordx4 v[184:187], v9, s[6:7] offset:3072
    global_load_dwordx4 v[188:191], v10, s[6:7] offset:3072
    global_load_dwordx4 v[192:195], v11, s[6:7] offset:3072
    global_load_dwordx4 v[196:199], v12, s[6:7] offset:3072
    global_load_dwordx4 v[200:203], v216, s[6:7] offset:3072
    global_load_dwordx4 v[204:207], v217, s[6:7] offset:3072
    global_load_dwordx4 v[208:211], v218, s[6:7] offset:3072
    global_load_dwordx4 v[212:215], v219, s[6:7] offset:3072
    v_add_u32 v6, 4096, v6
    v_add_u32 v7, 4096, v7
    v_add_u32 v8, 4096, v8
    v_add_u32 v9, 4096, v9
    v_add_u32 v10, 4096, v10
    v_add_u32 v11, 4096, v11
    v_add_u32 v12, 4096, v12
    v_add_u32 v216, 4096, v216
    v_add_u32 v217, 4096, v217
    v_add_u32 v218, 4096, v218
    v_add_u32 v219, 4096, v219
    s_waitcnt vmcnt(11)
    v_mfma_f32_16x16x32_bf16 v[16:19], v[156:159], v[128:131], v[16:19]
    v_mfma_f32_16x16x32_bf16 v[20:23], v[160:163], v[128:131], v[20:23]
    v_mfma_f32_16x16x32_bf16 v[24:27], v[164:167], v[128:131], v[24:27]
    v_mfma_f32_16x16x32_bf16 v[28:31], v[168:171], v[128:131], v[28:31]
    v_mfma_f32_16x16x32_bf16 v[32:35], v[156:159], v[132:135], v[32:35]
    v_mfma_f32_16x16x32_bf16 v[36:39], v[160:163], v[132:135], v[36:39]
    v_mfma_f32_16x16x32_bf16 v[40:43], v[164:167], v[132:135], v[40:43]
    v_mfma_f32_16x16x32_bf16 v[44:47], v[168:171], v[132:135], v[44:47]
    v_mfma_f32_16x16x32_bf16 v[48:51], v[156:159], v[136:139], v[48:51]
    v_mfma_f32_16x16x32_bf16 v[52:55], v[160:163], v[136:139], v[52:55]
    v_mfma_f32_16x16x32_bf16 v[56:59], v[164:167], v[136:139], v[56:59]
    v_mfma_f32_16x16x32_bf16 v[60:63], v[168:171], v[136:139], v[60:63]
    v_mfma_f32_16x16x32_bf16 v[64:67], v[156:159], v[140:143], v[64:67]
    v_mfma_f32_16x16x32_bf16 v[68:71], v[160:163], v[140:143], v[68:71]
    v_mfma_f32_16x16x32_bf16 v[72:75], v[164:167], v[140:143], v[72:75]
    v_mfma_f32_16x16x32_bf16 v[76:79], v[168:171], v[140:143], v[76:79]
    v_mfma_f32_16x16x32_bf16 v[80:83], v[156:159], v[144:147], v[80:83]
    v_mfma_f32_16x16x32_bf16 v[84:87], v[160:163], v[144:147], v[84:87]
    v_mfma_f32_16x16x32_bf16 v[88:91], v[164:167], v[144:147], v[88:91]
    v_mfma_f32_16x16x32_bf16 v[92:95], v[168:171], v[144:147], v[92:95]
    v_mfma_f32_16x16x32_bf16 v[96:99], v[156:159], v[148:151], v[96:99]
    v_mfma_f32_16x16x32_bf16 v[100:103], v[160:163], v[148:151], v[100:103]
    v_mfma_f32_16x16x32_bf16 v[104:107], v[164:167], v[148:151], v[104:107]
    v_mfma_f32_16x16x32_bf16 v[108:111], v[168:171], v[148:151], v[108:111]
    v_mfma_f32_16x16x32_bf16 v[112:115], v[156:159], v[152:155], v[112:115]
    v_mfma_f32_16x16x32_bf16 v[116:119], v[160:163], v[152:155], v[116:119]
    v_mfma_f32_16x16x32_bf16 v[120:123], v[164:167], v[152:155], v[120:123]
    v_mfma_f32_16x16x32_bf16 v[124:127], v[168:171], v[152:155], v[124:127]
    global_load_dwordx4 v[128:131], v6, s[6:7] offset:0
    global_load_dwordx4 v[132:135], v7, s[6:7] offset:0
    global_load_dwordx4 v[136:139], v8, s[6:7] offset:0
    global_load_dwordx4 v[140:143], v9, s[6:7] offset:0
    global_load_dwordx4 v[144:147], v10, s[6:7] offset:0
    global_load_dwordx4 v[148:151], v11, s[6:7] offset:0
    global_load_dwordx4 v[152:155], v12, s[6:7] offset:0
    global_load_dwordx4 v[156:159], v216, s[6:7] offset:0
    global_load_dwordx4 v[160:163], v217, s[6:7] offset:0
    global_load_dwordx4 v[164:167], v218, s[6:7] offset:0
    global_load_dwordx4 v[168:171], v219, s[6:7] offset:0
    s_waitcnt vmcnt(11)
    v_mfma_f32_16x16x32_bf16 v[16:19], v[200:203], v[172:175], v[16:19]
    v_mfma_f32_16x16x32_bf16 v[20:23], v[204:207], v[172:175], v[20:23]
    v_mfma_f32_16x16x32_bf16 v[24:27], v[208:211], v[172:175], v[24:27]
    v_mfma_f32_16x16x32_bf16 v[28:31], v[212:215], v[172:175], v[28:31]
    v_mfma_f32_16x16x32_bf16 v[32:35], v[200:203], v[176:179], v[32:35]
    v_mfma_f32_16x16x32_bf16 v[36:39], v[204:207], v[176:179], v[36:39]
    v_mfma_f32_16x16x32_bf16 v[40:43], v[208:211], v[176:179], v[40:43]
    v_mfma_f32_16x16x32_bf16 v[44:47], v[212:215], v[176:179], v[44:47]
    v_mfma_f32_16x16x32_bf16 v[48:51], v[200:203], v[180:183], v[48:51]
    v_mfma_f32_16x16x32_bf16 v[52:55], v[204:207], v[180:183], v[52:55]
    v_mfma_f32_16x16x32_bf16 v[56:59], v[208:211], v[180:183], v[56:59]
    v_mfma_f32_16x16x32_bf16 v[60:63], v[212:215], v[180:183], v[60:63]
    v_mfma_f32_16x16x32_bf16 v[64:67], v[200:203], v[184:187], v[64:67]
    v_mfma_f32_16x16x32_bf16 v[68:71], v[204:207], v[184:187], v[68:71]
    v_mfma_f32_16x16x32_bf16 v[72:75], v[208:211], v[184:187], v[72:75]
    v_mfma_f32_16x16x32_bf16 v[76:79], v[212:215], v[184:187], v[76:79]
    v_mfma_f32_16x16x32_bf16 v[80:83], v[200:203], v[188:191], v[80:83]
    v_mfma_f32_16x16x32_bf16 v[84:87], v[204:207], v[188:191], v[84:87]
    v_mfma_f32_16x16x32_bf16 v[88:91], v[208:211], v[188:191], v[88:91]
    v_mfma_f32_16x16x32_bf16 v[92:95], v[212:215], v[188:191], v[92:95]
    v_mfma_f32_16x16x32_bf16 v[96:99], v[200:203], v[192:195], v[96:99]
    v_mfma_f32_16x16x32_bf16 v[100:103], v[204:207], v[192:195], v[100:103]
    v_mfma_f32_16x16x32_bf16 v[104:107], v[208:211], v[192:195], v[104:107]
    v_mfma_f32_16x16x32_bf16 v[108:111], v[212:215], v[192:195], v[108:111]
    v_mfma_f32_16x16x32_bf16 v[112:115], v[200:203], v[196:199], v[112:115]
    v_mfma_f32_16x16x32_bf16 v[116:119], v[204:207], v[196:199], v[116:119]
    v_mfma_f32_16x16x32_bf16 v[120:123], v[208:211], v[196:199], v[120:123]
    v_mfma_f32_16x16x32_bf16 v[124:127], v[212:215], v[196:199], v[124:127]
    global_load_dwordx4 v[172:175], v6, s[6:7] offset:1024
    global_load_dwordx4 v[176:179], v7, s[6:7] offset:1024
    global_load_dwordx4 v[180:183], v8, s[6:7] offset:1024
    global_load_dwordx4 v[184:187], v9, s[6:7] offset:1024
    global_load_dwordx4 v[188:191], v10, s[6:7] offset:1024
    global_load_dwordx4 v[192:195], v11, s[6:7] offset:1024
    global_load_dwordx4 v[196:199], v12, s[6:7] offset:1024
    global_load_dwordx4 v[200:203], v216, s[6:7] offset:1024
    global_load_dwordx4 v[204:207], v217, s[6:7] offset:1024
    global_load_dwordx4 v[208:211], v218, s[6:7] offset:1024
    global_load_dwordx4 v[212:215], v219, s[6:7] offset:1024
    s_waitcnt vmcnt(11)
    v_mfma_f32_16x16x32_bf16 v[16:19], v[156:159], v[128:131], v[16:19]
    v_mfma_f32_16x16x32_bf16 v[20:23], v[160:163], v[128:131], v[20:23]
    v_mfma_f32_16x16x32_bf16 v[24:27], v[164:167], v[128:131], v[24:27]
    v_mfma_f32_16x16x32_bf16 v[28:31], v[168:171], v[128:131], v[28:31]
    v_mfma_f32_16x16x32_bf16 v[32:35], v[156:159], v[132:135], v[32:35]
    v_mfma_f32_16x16x32_bf16 v[36:39], v[160:163], v[132:135], v[36:39]
    v_mfma_f32_16x16x32_bf16 v[40:43], v[164:167], v[132:135], v[40:43]
    v_mfma_f32_16x16x32_bf16 v[44:47], v[168:171], v[132:135], v[44:47]
    v_mfma_f32_16x16x32_bf16 v[48:51], v[156:159], v[136:139], v[48:51]
    v_mfma_f32_16x16x32_bf16 v[52:55], v[160:163], v[136:139], v[52:55]
    v_mfma_f32_16x16x32_bf16 v[56:59], v[164:167], v[136:139], v[56:59]
    v_mfma_f32_16x16x32_bf16 v[60:63], v[168:171], v[136:139], v[60:63]
    v_mfma_f32_16x16x32_bf16 v[64:67], v[156:159], v[140:143], v[64:67]
    v_mfma_f32_16x16x32_bf16 v[68:71], v[160:163], v[140:143], v[68:71]
    v_mfma_f32_16x16x32_bf16 v[72:75], v[164:167], v[140:143], v[72:75]
    v_mfma_f32_16x16x32_bf16 v[76:79], v[168:171], v[140:143], v[76:79]
    v_mfma_f32_16x16x32_bf16 v[80:83], v[156:159], v[144:147], v[80:83]
    v_mfma_f32_16x16x32_bf16 v[84:87], v[160:163], v[144:147], v[84:87]
    v_mfma_f32_16x16x32_bf16 v[88:91], v[164:167], v[144:147], v[88:91]
    v_mfma_f32_16x16x32_bf16 v[92:95], v[168:171], v[144:147], v[92:95]
    v_mfma_f32_16x16x32_bf16 v[96:99], v[156:159], v[148:151], v[96:99]
    v_mfma_f32_16x16x32_bf16 v[100:103], v[160:163], v[148:151], v[100:103]
    v_mfma_f32_16x16x32_bf16 v[104:107], v[164:167], v[148:151], v[104:107]
    v_mfma_f32_16x16x32_bf16 v[108:111], v[168:171], v[148:151], v[108:111]
    v_mfma_f32_16x16x32_bf16 v[112:115], v[156:159], v[152:155], v[112:115]
    v_mfma_f32_16x16x32_bf16 v[116:119], v[160:163], v[152:155], v[116:119]
    v_mfma_f32_16x16x32_bf16 v[120:123], v[164:167], v[152:155], v[120:123]
    v_mfma_f32_16x16x32_bf16 v[124:127], v[168:171], v[152:155], v[124:127]
    s_waitcnt vmcnt(0)
    v_mfma_f32_16x16x32_bf16 v[16:19], v[200:203], v[172:175], v[16:19]
    v_mfma_f32_16x16x32_bf16 v[20:23], v[204:207], v[172:175], v[20:23]
    v_mfma_f32_16x16x32_bf16 v[24:27], v[208:211], v[172:175], v[24:27]
    v_mfma_f32_16x16x32_bf16 v[28:31], v[212:215], v[172:175], v[28:31]
    v_mfma_f32_16x16x32_bf16 v[32:35], v[200:203], v[176:179], v[32:35]
    v_mfma_f32_16x16x32_bf16 v[36:39], v[204:207], v[176:179], v[36:39]
    v_mfma_f32_16x16x32_bf16 v[40:43], v[208:211], v[176:179], v[40:43]
    v_mfma_f32_16x16x32_bf16 v[44:47], v[212:215], v[176:179], v[44:47]
    v_mfma_f32_16x16x32_bf16 v[48:51], v[200:203], v[180:183], v[48:51]
    v_mfma_f32_16x16x32_bf16 v[52:55], v[204:207], v[180:183], v[52:55]
    v_mfma_f32_16x16x32_bf16 v[56:59], v[208:211], v[180:183], v[56:59]
    v_mfma_f32_16x16x32_bf16 v[60:63], v[212:215], v[180:183], v[60:63]
    v_mfma_f32_16x16x32_bf16 v[64:67], v[200:203], v[184:187], v[64:67]
    v_mfma_f32_16x16x32_bf16 v[68:71], v[204:207], v[184:187], v[68:71]
    v_mfma_f32_16x16x32_bf16 v[72:75], v[208:211], v[184:187], v[72:75]
    v_mfma_f32_16x16x32_bf16 v[76:79], v[212:215], v[184:187], v[76:79]
    v_mfma_f32_16x16x32_bf16 v[80:83], v[200:203], v[188:191], v[80:83]
    v_mfma_f32_16x16x32_bf16 v[84:87], v[204:207], v[188:191], v[84:87]
    v_mfma_f32_16x16x32_bf16 v[88:91], v[208:211], v[188:191], v[88:91]
    v_mfma_f32_16x16x32_bf16 v[92:95], v[212:215], v[188:191], v[92:95]
    v_mfma_f32_16x16x32_bf16 v[96:99], v[200:203], v[192:195], v[96:99]
    v_mfma_f32_16x16x32_bf16 v[100:103], v[204:207], v[192:195], v[100:103]
    v_mfma_f32_16x16x32_bf16 v[104:107], v[208:211], v[192:195], v[104:107]
    v_mfma_f32_16x16x32_bf16 v[108:111], v[212:215], v[192:195], v[108:111]
    v_mfma_f32_16x16x32_bf16 v[112:115], v[200:203], v[196:199], v[112:115]
    v_mfma_f32_16x16x32_bf16 v[116:119], v[204:207], v[196:199], v[116:119]
    v_mfma_f32_16x16x32_bf16 v[120:123], v[208:211], v[196:199], v[120:123]
    v_mfma_f32_16x16x32_bf16 v[124:127], v[212:215], v[196:199], v[124:127]
    s_nop 7
    s_nop 1
    s_lshl_b32 s23, s21, 5
    s_add_u32 s23, s23, s22
    s_mul_i32 s23, s23, 28
    s_add_u32 s23, s23, s25
    s_lshl_b32 s23, s23, 10
    s_add_u32 s23, s23, 0x5e00000
    v_add_u32 v5, s23, v4
    v_add_u32 v13, 4096, v5
    v_cvt_pk_bf16_f32 v128, v16, v17
    v_cvt_pk_bf16_f32 v129, v18, v19
    v_cvt_pk_bf16_f32 v130, v20, v21
    v_cvt_pk_bf16_f32 v131, v22, v23
    global_store_dwordx4 v5, v[128:131], s[6:7] offset:0 sc1
    v_cvt_pk_bf16_f32 v132, v32, v33
    v_cvt_pk_bf16_f32 v133, v34, v35
    v_cvt_pk_bf16_f32 v134, v36, v37
    v_cvt_pk_bf16_f32 v135, v38, v39
    global_store_dwordx4 v5, v[132:135], s[6:7] offset:1024 sc1
    v_cvt_pk_bf16_f32 v136, v48, v49
    v_cvt_pk_bf16_f32 v137, v50, v51
    v_cvt_pk_bf16_f32 v138, v52, v53
    v_cvt_pk_bf16_f32 v139, v54, v55
    global_store_dwordx4 v5, v[136:139], s[6:7] offset:2048 sc1
    v_cvt_pk_bf16_f32 v140, v64, v65
    v_cvt_pk_bf16_f32 v141, v66, v67
    v_cvt_pk_bf16_f32 v142, v68, v69
    v_cvt_pk_bf16_f32 v143, v70, v71
    global_store_dwordx4 v5, v[140:143], s[6:7] offset:3072 sc1
    v_cvt_pk_bf16_f32 v144, v80, v81
    v_cvt_pk_bf16_f32 v145, v82, v83
    v_cvt_pk_bf16_f32 v146, v84, v85
    v_cvt_pk_bf16_f32 v147, v86, v87
    global_store_dwordx4 v13, v[144:147], s[6:7] offset:0 sc1
    v_cvt_pk_bf16_f32 v148, v96, v97
    v_cvt_pk_bf16_f32 v149, v98, v99
    v_cvt_pk_bf16_f32 v150, v100, v101
    v_cvt_pk_bf16_f32 v151, v102, v103
    global_store_dwordx4 v13, v[148:151], s[6:7] offset:1024 sc1
    v_cvt_pk_bf16_f32 v152, v112, v113
    v_cvt_pk_bf16_f32 v153, v114, v115
    v_cvt_pk_bf16_f32 v154, v116, v117
    v_cvt_pk_bf16_f32 v155, v118, v119
    global_store_dwordx4 v13, v[152:155], s[6:7] offset:2048 sc1
    v_add_u32 v5, 458752, v5
    v_add_u32 v13, 4096, v5
    v_cvt_pk_bf16_f32 v156, v24, v25
    v_cvt_pk_bf16_f32 v157, v26, v27
    v_cvt_pk_bf16_f32 v158, v28, v29
    v_cvt_pk_bf16_f32 v159, v30, v31
    global_store_dwordx4 v5, v[156:159], s[6:7] offset:0 sc1
    v_cvt_pk_bf16_f32 v160, v40, v41
    v_cvt_pk_bf16_f32 v161, v42, v43
    v_cvt_pk_bf16_f32 v162, v44, v45
    v_cvt_pk_bf16_f32 v163, v46, v47
    global_store_dwordx4 v5, v[160:163], s[6:7] offset:1024 sc1
    v_cvt_pk_bf16_f32 v164, v56, v57
    v_cvt_pk_bf16_f32 v165, v58, v59
    v_cvt_pk_bf16_f32 v166, v60, v61
    v_cvt_pk_bf16_f32 v167, v62, v63
    global_store_dwordx4 v5, v[164:167], s[6:7] offset:2048 sc1
    v_cvt_pk_bf16_f32 v168, v72, v73
    v_cvt_pk_bf16_f32 v169, v74, v75
    v_cvt_pk_bf16_f32 v170, v76, v77
    v_cvt_pk_bf16_f32 v171, v78, v79
    global_store_dwordx4 v5, v[168:171], s[6:7] offset:3072 sc1
    v_cvt_pk_bf16_f32 v172, v88, v89
    v_cvt_pk_bf16_f32 v173, v90, v91
    v_cvt_pk_bf16_f32 v174, v92, v93
    v_cvt_pk_bf16_f32 v175, v94, v95
    global_store_dwordx4 v13, v[172:175], s[6:7] offset:0 sc1
    v_cvt_pk_bf16_f32 v176, v104, v105
    v_cvt_pk_bf16_f32 v177, v106, v107
    v_cvt_pk_bf16_f32 v178, v108, v109
    v_cvt_pk_bf16_f32 v179, v110, v111
    global_store_dwordx4 v13, v[176:179], s[6:7] offset:1024 sc1
    v_cvt_pk_bf16_f32 v180, v120, v121
    v_cvt_pk_bf16_f32 v181, v122, v123
    v_cvt_pk_bf16_f32 v182, v124, v125
    v_cvt_pk_bf16_f32 v183, v126, v127
    global_store_dwordx4 v13, v[180:183], s[6:7] offset:2048 sc1
    s_lshl_b32 s23, s21, 2
    s_add_u32 s23, s23, 0x8000
    s_waitcnt vmcnt(0)
    s_barrier
    s_cmp_lg_u32 s8, 0
    s_cbranch_scc1 .sg_53
    s_mov_b64 exec, 1
    v_mov_b32 v4, s23
    v_mov_b32 v5, 1
    global_atomic_add v4, v5, s[6:7]
    v_mov_b32 v6, 0x84b0
    global_atomic_add v6, v5, s[6:7]
    s_mov_b64 exec, -1
.sg_53:
    s_branch .wk_loop_41
.wk_43:
    s_add_u32 s24, s24, 0x600000
    v_add_u32 v6, s24, v4
    v_add_u32 v7, 14336, v6
    v_add_u32 v8, 28672, v6
    v_add_u32 v9, 43008, v6
    v_add_u32 v10, 57344, v6
    v_add_u32 v11, 71680, v6
    v_add_u32 v12, 86016, v6
    v_add_u32 v216, 0, v5
    v_add_u32 v217, 14336, v5
    v_add_u32 v218, 28672, v5
    v_add_u32 v219, 43008, v5
    global_load_dwordx4 v[128:131], v6, s[6:7] offset:0
    global_load_dwordx4 v[132:135], v7, s[6:7] offset:0
    global_load_dwordx4 v[136:139], v8, s[6:7] offset:0
    global_load_dwordx4 v[140:143], v9, s[6:7] offset:0
    global_load_dwordx4 v[144:147], v10, s[6:7] offset:0
    global_load_dwordx4 v[148:151], v11, s[6:7] offset:0
    global_load_dwordx4 v[152:155], v12, s[6:7] offset:0
    global_load_dwordx4 v[156:159], v216, s[6:7] offset:0
    global_load_dwordx4 v[160:163], v217, s[6:7] offset:0
    global_load_dwordx4 v[164:167], v218, s[6:7] offset:0
    global_load_dwordx4 v[168:171], v219, s[6:7] offset:0
    global_load_dwordx4 v[172:175], v6, s[6:7] offset:1024
    global_load_dwordx4 v[176:179], v7, s[6:7] offset:1024
    global_load_dwordx4 v[180:183], v8, s[6:7] offset:1024
    global_load_dwordx4 v[184:187], v9, s[6:7] offset:1024
    global_load_dwordx4 v[188:191], v10, s[6:7] offset:1024
    global_load_dwordx4 v[192:195], v11, s[6:7] offset:1024
    global_load_dwordx4 v[196:199], v12, s[6:7] offset:1024
    global_load_dwordx4 v[200:203], v216, s[6:7] offset:1024
    global_load_dwordx4 v[204:207], v217, s[6:7] offset:1024
    global_load_dwordx4 v[208:211], v218, s[6:7] offset:1024
    global_load_dwordx4 v[212:215], v219, s[6:7] offset:1024
    s_waitcnt vmcnt(11)
    v_mfma_f32_16x16x32_bf16 v[16:19], v[128:131], v[156:159], 0
    v_mfma_f32_16x16x32_bf16 v[20:23], v[128:131], v[160:163], 0
    v_mfma_f32_16x16x32_bf16 v[24:27], v[128:131], v[164:167], 0
    v_mfma_f32_16x16x32_bf16 v[28:31], v[128:131], v[168:171], 0
    v_mfma_f32_16x16x32_bf16 v[32:35], v[132:135], v[156:159], 0
    v_mfma_f32_16x16x32_bf16 v[36:39], v[132:135], v[160:163], 0
    v_mfma_f32_16x16x32_bf16 v[40:43], v[132:135], v[164:167], 0
    v_mfma_f32_16x16x32_bf16 v[44:47], v[132:135], v[168:171], 0
    v_mfma_f32_16x16x32_bf16 v[48:51], v[136:139], v[156:159], 0
    v_mfma_f32_16x16x32_bf16 v[52:55], v[136:139], v[160:163], 0
    v_mfma_f32_16x16x32_bf16 v[56:59], v[136:139], v[164:167], 0
    v_mfma_f32_16x16x32_bf16 v[60:63], v[136:139], v[168:171], 0
    v_mfma_f32_16x16x32_bf16 v[64:67], v[140:143], v[156:159], 0
    v_mfma_f32_16x16x32_bf16 v[68:71], v[140:143], v[160:163], 0
    v_mfma_f32_16x16x32_bf16 v[72:75], v[140:143], v[164:167], 0
    v_mfma_f32_16x16x32_bf16 v[76:79], v[140:143], v[168:171], 0
    v_mfma_f32_16x16x32_bf16 v[80:83], v[144:147], v[156:159], 0
    v_mfma_f32_16x16x32_bf16 v[84:87], v[144:147], v[160:163], 0
    v_mfma_f32_16x16x32_bf16 v[88:91], v[144:147], v[164:167], 0
    v_mfma_f32_16x16x32_bf16 v[92:95], v[144:147], v[168:171], 0
    v_mfma_f32_16x16x32_bf16 v[96:99], v[148:151], v[156:159], 0
    v_mfma_f32_16x16x32_bf16 v[100:103], v[148:151], v[160:163], 0
    v_mfma_f32_16x16x32_bf16 v[104:107], v[148:151], v[164:167], 0
    v_mfma_f32_16x16x32_bf16 v[108:111], v[148:151], v[168:171], 0
    v_mfma_f32_16x16x32_bf16 v[112:115], v[152:155], v[156:159], 0
    v_mfma_f32_16x16x32_bf16 v[116:119], v[152:155], v[160:163], 0
    v_mfma_f32_16x16x32_bf16 v[120:123], v[152:155], v[164:167], 0
    v_mfma_f32_16x16x32_bf16 v[124:127], v[152:155], v[168:171], 0
    global_load_dwordx4 v[128:131], v6, s[6:7] offset:2048
    global_load_dwordx4 v[132:135], v7, s[6:7] offset:2048
    global_load_dwordx4 v[136:139], v8, s[6:7] offset:2048
    global_load_dwordx4 v[140:143], v9, s[6:7] offset:2048
    global_load_dwordx4 v[144:147], v10, s[6:7] offset:2048
    global_load_dwordx4 v[148:151], v11, s[6:7] offset:2048
    global_load_dwordx4 v[152:155], v12, s[6:7] offset:2048
    global_load_dwordx4 v[156:159], v216, s[6:7] offset:2048
    global_load_dwordx4 v[160:163], v217, s[6:7] offset:2048
    global_load_dwordx4 v[164:167], v218, s[6:7] offset:2048
    global_load_dwordx4 v[168:171], v219, s[6:7] offset:2048
    s_waitcnt vmcnt(11)
    v_mfma_f32_16x16x32_bf16 v[16:19], v[172:175], v[200:203], v[16:19]
    v_mfma_f32_16x16x32_bf16 v[20:23], v[172:175], v[204:207], v[20:23]
    v_mfma_f32_16x16x32_bf16 v[24:27], v[172:175], v[208:211], v[24:27]
    v_mfma_f32_16x16x32_bf16 v[28:31], v[172:175], v[212:215], v[28:31]
    v_mfma_f32_16x16x32_bf16 v[32:35], v[176:179], v[200:203], v[32:35]
    v_mfma_f32_16x16x32_bf16 v[36:39], v[176:179], v[204:207], v[36:39]
    v_mfma_f32_16x16x32_bf16 v[40:43], v[176:179], v[208:211], v[40:43]
    v_mfma_f32_16x16x32_bf16 v[44:47], v[176:179], v[212:215], v[44:47]
    v_mfma_f32_16x16x32_bf16 v[48:51], v[180:183], v[200:203], v[48:51]
    v_mfma_f32_16x16x32_bf16 v[52:55], v[180:183], v[204:207], v[52:55]
    v_mfma_f32_16x16x32_bf16 v[56:59], v[180:183], v[208:211], v[56:59]
    v_mfma_f32_16x16x32_bf16 v[60:63], v[180:183], v[212:215], v[60:63]
    v_mfma_f32_16x16x32_bf16 v[64:67], v[184:187], v[200:203], v[64:67]
    v_mfma_f32_16x16x32_bf16 v[68:71], v[184:187], v[204:207], v[68:71]
    v_mfma_f32_16x16x32_bf16 v[72:75], v[184:187], v[208:211], v[72:75]
    v_mfma_f32_16x16x32_bf16 v[76:79], v[184:187], v[212:215], v[76:79]
    v_mfma_f32_16x16x32_bf16 v[80:83], v[188:191], v[200:203], v[80:83]
    v_mfma_f32_16x16x32_bf16 v[84:87], v[188:191], v[204:207], v[84:87]
    v_mfma_f32_16x16x32_bf16 v[88:91], v[188:191], v[208:211], v[88:91]
    v_mfma_f32_16x16x32_bf16 v[92:95], v[188:191], v[212:215], v[92:95]
    v_mfma_f32_16x16x32_bf16 v[96:99], v[192:195], v[200:203], v[96:99]
    v_mfma_f32_16x16x32_bf16 v[100:103], v[192:195], v[204:207], v[100:103]
    v_mfma_f32_16x16x32_bf16 v[104:107], v[192:195], v[208:211], v[104:107]
    v_mfma_f32_16x16x32_bf16 v[108:111], v[192:195], v[212:215], v[108:111]
    v_mfma_f32_16x16x32_bf16 v[112:115], v[196:199], v[200:203], v[112:115]
    v_mfma_f32_16x16x32_bf16 v[116:119], v[196:199], v[204:207], v[116:119]
    v_mfma_f32_16x16x32_bf16 v[120:123], v[196:199], v[208:211], v[120:123]
    v_mfma_f32_16x16x32_bf16 v[124:127], v[196:199], v[212:215], v[124:127]
    global_load_dwordx4 v[172:175], v6, s[6:7] offset:3072
    global_load_dwordx4 v[176:179], v7, s[6:7] offset:3072
    global_load_dwordx4 v[180:183], v8, s[6:7] offset:3072
    global_load_dwordx4 v[184:187], v9, s[6:7] offset:3072
    global_load_dwordx4 v[188:191], v10, s[6:7] offset:3072
    global_load_dwordx4 v[192:195], v11, s[6:7] offset:3072
    global_load_dwordx4 v[196:199], v12, s[6:7] offset:3072
    global_load_dwordx4 v[200:203], v216, s[6:7] offset:3072
    global_load_dwordx4 v[204:207], v217, s[6:7] offset:3072
    global_load_dwordx4 v[208:211], v218, s[6:7] offset:3072
    global_load_dwordx4 v[212:215], v219, s[6:7] offset:3072
    v_add_u32 v6, 4096, v6
    v_add_u32 v7, 4096, v7
    v_add_u32 v8, 4096, v8
    v_add_u32 v9, 4096, v9
    v_add_u32 v10, 4096, v10
    v_add_u32 v11, 4096, v11
    v_add_u32 v12, 4096, v12
    v_add_u32 v216, 4096, v216
    v_add_u32 v217, 4096, v217
    v_add_u32 v218, 4096, v218
    v_add_u32 v219, 4096, v219
    s_waitcnt vmcnt(11)
    v_mfma_f32_16x16x32_bf16 v[16:19], v[128:131], v[156:159], v[16:19]
    v_mfma_f32_16x16x32_bf16 v[20:23], v[128:131], v[160:163], v[20:23]
    v_mfma_f32_16x16x32_bf16 v[24:27], v[128:131], v[164:167], v[24:27]
    v_mfma_f32_16x16x32_bf16 v[28:31], v[128:131], v[168:171], v[28:31]
    v_mfma_f32_16x16x32_bf16 v[32:35], v[132:135], v[156:159], v[32:35]
    v_mfma_f32_16x16x32_bf16 v[36:39], v[132:135], v[160:163], v[36:39]
    v_mfma_f32_16x16x32_bf16 v[40:43], v[132:135], v[164:167], v[40:43]
    v_mfma_f32_16x16x32_bf16 v[44:47], v[132:135], v[168:171], v[44:47]
    v_mfma_f32_16x16x32_bf16 v[48:51], v[136:139], v[156:159], v[48:51]
    v_mfma_f32_16x16x32_bf16 v[52:55], v[136:139], v[160:163], v[52:55]
    v_mfma_f32_16x16x32_bf16 v[56:59], v[136:139], v[164:167], v[56:59]
    v_mfma_f32_16x16x32_bf16 v[60:63], v[136:139], v[168:171], v[60:63]
    v_mfma_f32_16x16x32_bf16 v[64:67], v[140:143], v[156:159], v[64:67]
    v_mfma_f32_16x16x32_bf16 v[68:71], v[140:143], v[160:163], v[68:71]
    v_mfma_f32_16x16x32_bf16 v[72:75], v[140:143], v[164:167], v[72:75]
    v_mfma_f32_16x16x32_bf16 v[76:79], v[140:143], v[168:171], v[76:79]
    v_mfma_f32_16x16x32_bf16 v[80:83], v[144:147], v[156:159], v[80:83]
    v_mfma_f32_16x16x32_bf16 v[84:87], v[144:147], v[160:163], v[84:87]
    v_mfma_f32_16x16x32_bf16 v[88:91], v[144:147], v[164:167], v[88:91]
    v_mfma_f32_16x16x32_bf16 v[92:95], v[144:147], v[168:171], v[92:95]
    v_mfma_f32_16x16x32_bf16 v[96:99], v[148:151], v[156:159], v[96:99]
    v_mfma_f32_16x16x32_bf16 v[100:103], v[148:151], v[160:163], v[100:103]
    v_mfma_f32_16x16x32_bf16 v[104:107], v[148:151], v[164:167], v[104:107]
    v_mfma_f32_16x16x32_bf16 v[108:111], v[148:151], v[168:171], v[108:111]
    v_mfma_f32_16x16x32_bf16 v[112:115], v[152:155], v[156:159], v[112:115]
    v_mfma_f32_16x16x32_bf16 v[116:119], v[152:155], v[160:163], v[116:119]
    v_mfma_f32_16x16x32_bf16 v[120:123], v[152:155], v[164:167], v[120:123]
    v_mfma_f32_16x16x32_bf16 v[124:127], v[152:155], v[168:171], v[124:127]
    global_load_dwordx4 v[128:131], v6, s[6:7] offset:0
    global_load_dwordx4 v[132:135], v7, s[6:7] offset:0
    global_load_dwordx4 v[136:139], v8, s[6:7] offset:0
    global_load_dwordx4 v[140:143], v9, s[6:7] offset:0
    global_load_dwordx4 v[144:147], v10, s[6:7] offset:0
    global_load_dwordx4 v[148:151], v11, s[6:7] offset:0
    global_load_dwordx4 v[152:155], v12, s[6:7] offset:0
    global_load_dwordx4 v[156:159], v216, s[6:7] offset:0
    global_load_dwordx4 v[160:163], v217, s[6:7] offset:0
    global_load_dwordx4 v[164:167], v218, s[6:7] offset:0
    global_load_dwordx4 v[168:171], v219, s[6:7] offset:0
    s_waitcnt vmcnt(11)
    v_mfma_f32_16x16x32_bf16 v[16:19], v[172:175], v[200:203], v[16:19]
    v_mfma_f32_16x16x32_bf16 v[20:23], v[172:175], v[204:207], v[20:23]
    v_mfma_f32_16x16x32_bf16 v[24:27], v[172:175], v[208:211], v[24:27]
    v_mfma_f32_16x16x32_bf16 v[28:31], v[172:175], v[212:215], v[28:31]
    v_mfma_f32_16x16x32_bf16 v[32:35], v[176:179], v[200:203], v[32:35]
    v_mfma_f32_16x16x32_bf16 v[36:39], v[176:179], v[204:207], v[36:39]
    v_mfma_f32_16x16x32_bf16 v[40:43], v[176:179], v[208:211], v[40:43]
    v_mfma_f32_16x16x32_bf16 v[44:47], v[176:179], v[212:215], v[44:47]
    v_mfma_f32_16x16x32_bf16 v[48:51], v[180:183], v[200:203], v[48:51]
    v_mfma_f32_16x16x32_bf16 v[52:55], v[180:183], v[204:207], v[52:55]
    v_mfma_f32_16x16x32_bf16 v[56:59], v[180:183], v[208:211], v[56:59]
    v_mfma_f32_16x16x32_bf16 v[60:63], v[180:183], v[212:215], v[60:63]
    v_mfma_f32_16x16x32_bf16 v[64:67], v[184:187], v[200:203], v[64:67]
    v_mfma_f32_16x16x32_bf16 v[68:71], v[184:187], v[204:207], v[68:71]
    v_mfma_f32_16x16x32_bf16 v[72:75], v[184:187], v[208:211], v[72:75]
    v_mfma_f32_16x16x32_bf16 v[76:79], v[184:187], v[212:215], v[76:79]
    v_mfma_f32_16x16x32_bf16 v[80:83], v[188:191], v[200:203], v[80:83]
    v_mfma_f32_16x16x32_bf16 v[84:87], v[188:191], v[204:207], v[84:87]
    v_mfma_f32_16x16x32_bf16 v[88:91], v[188:191], v[208:211], v[88:91]
    v_mfma_f32_16x16x32_bf16 v[92:95], v[188:191], v[212:215], v[92:95]
    v_mfma_f32_16x16x32_bf16 v[96:99], v[192:195], v[200:203], v[96:99]
    v_mfma_f32_16x16x32_bf16 v[100:103], v[192:195], v[204:207], v[100:103]
    v_mfma_f32_16x16x32_bf16 v[104:107], v[192:195], v[208:211], v[104:107]
    v_mfma_f32_16x16x32_bf16 v[108:111], v[192:195], v[212:215], v[108:111]
    v_mfma_f32_16x16x32_bf16 v[112:115], v[196:199], v[200:203], v[112:115]
    v_mfma_f32_16x16x32_bf16 v[116:119], v[196:199], v[204:207], v[116:119]
    v_mfma_f32_16x16x32_bf16 v[120:123], v[196:199], v[208:211], v[120:123]
    v_mfma_f32_16x16x32_bf16 v[124:127], v[196:199], v[212:215], v[124:127]
    global_load_dwordx4 v[172:175], v6, s[6:7] offset:1024
    global_load_dwordx4 v[176:179], v7, s[6:7] offset:1024
    global_load_dwordx4 v[180:183], v8, s[6:7] offset:1024
    global_load_dwordx4 v[184:187], v9, s[6:7] offset:1024
    global_load_dwordx4 v[188:191], v10, s[6:7] offset:1024
    global_load_dwordx4 v[192:195], v11, s[6:7] offset:1024
    global_load_dwordx4 v[196:199], v12, s[6:7] offset:1024
    global_load_dwordx4 v[200:203], v216, s[6:7] offset:1024
    global_load_dwordx4 v[204:207], v217, s[6:7] offset:1024
    global_load_dwordx4 v[208:211], v218, s[6:7] offset:1024
    global_load_dwordx4 v[212:215], v219, s[6:7] offset:1024
    s_waitcnt vmcnt(11)
    v_mfma_f32_16x16x32_bf16 v[16:19], v[128:131], v[156:159], v[16:19]
    v_mfma_f32_16x16x32_bf16 v[20:23], v[128:131], v[160:163], v[20:23]
    v_mfma_f32_16x16x32_bf16 v[24:27], v[128:131], v[164:167], v[24:27]
    v_mfma_f32_16x16x32_bf16 v[28:31], v[128:131], v[168:171], v[28:31]
    v_mfma_f32_16x16x32_bf16 v[32:35], v[132:135], v[156:159], v[32:35]
    v_mfma_f32_16x16x32_bf16 v[36:39], v[132:135], v[160:163], v[36:39]
    v_mfma_f32_16x16x32_bf16 v[40:43], v[132:135], v[164:167], v[40:43]
    v_mfma_f32_16x16x32_bf16 v[44:47], v[132:135], v[168:171], v[44:47]
    v_mfma_f32_16x16x32_bf16 v[48:51], v[136:139], v[156:159], v[48:51]
    v_mfma_f32_16x16x32_bf16 v[52:55], v[136:139], v[160:163], v[52:55]
    v_mfma_f32_16x16x32_bf16 v[56:59], v[136:139], v[164:167], v[56:59]
    v_mfma_f32_16x16x32_bf16 v[60:63], v[136:139], v[168:171], v[60:63]
    v_mfma_f32_16x16x32_bf16 v[64:67], v[140:143], v[156:159], v[64:67]
    v_mfma_f32_16x16x32_bf16 v[68:71], v[140:143], v[160:163], v[68:71]
    v_mfma_f32_16x16x32_bf16 v[72:75], v[140:143], v[164:167], v[72:75]
    v_mfma_f32_16x16x32_bf16 v[76:79], v[140:143], v[168:171], v[76:79]
    v_mfma_f32_16x16x32_bf16 v[80:83], v[144:147], v[156:159], v[80:83]
    v_mfma_f32_16x16x32_bf16 v[84:87], v[144:147], v[160:163], v[84:87]
    v_mfma_f32_16x16x32_bf16 v[88:91], v[144:147], v[164:167], v[88:91]
    v_mfma_f32_16x16x32_bf16 v[92:95], v[144:147], v[168:171], v[92:95]
    v_mfma_f32_16x16x32_bf16 v[96:99], v[148:151], v[156:159], v[96:99]
    v_mfma_f32_16x16x32_bf16 v[100:103], v[148:151], v[160:163], v[100:103]
    v_mfma_f32_16x16x32_bf16 v[104:107], v[148:151], v[164:167], v[104:107]
    v_mfma_f32_16x16x32_bf16 v[108:111], v[148:151], v[168:171], v[108:111]
    v_mfma_f32_16x16x32_bf16 v[112:115], v[152:155], v[156:159], v[112:115]
    v_mfma_f32_16x16x32_bf16 v[116:119], v[152:155], v[160:163], v[116:119]
    v_mfma_f32_16x16x32_bf16 v[120:123], v[152:155], v[164:167], v[120:123]
    v_mfma_f32_16x16x32_bf16 v[124:127], v[152:155], v[168:171], v[124:127]
    global_load_dwordx4 v[128:131], v6, s[6:7] offset:2048
    global_load_dwordx4 v[132:135], v7, s[6:7] offset:2048
    global_load_dwordx4 v[136:139], v8, s[6:7] offset:2048
    global_load_dwordx4 v[140:143], v9, s[6:7] offset:2048
    global_load_dwordx4 v[144:147], v10, s[6:7] offset:2048
    global_load_dwordx4 v[148:151], v11, s[6:7] offset:2048
    global_load_dwordx4 v[152:155], v12, s[6:7] offset:2048
    global_load_dwordx4 v[156:159], v216, s[6:7] offset:2048
    global_load_dwordx4 v[160:163], v217, s[6:7] offset:2048
    global_load_dwordx4 v[164:167], v218, s[6:7] offset:2048
    global_load_dwordx4 v[168:171], v219, s[6:7] offset:2048
    s_waitcnt vmcnt(11)
    v_mfma_f32_16x16x32_bf16 v[16:19], v[172:175], v[200:203], v[16:19]
    v_mfma_f32_16x16x32_bf16 v[20:23], v[172:175], v[204:207], v[20:23]
    v_mfma_f32_16x16x32_bf16 v[24:27], v[172:175], v[208:211], v[24:27]
    v_mfma_f32_16x16x32_bf16 v[28:31], v[172:175], v[212:215], v[28:31]
    v_mfma_f32_16x16x32_bf16 v[32:35], v[176:179], v[200:203], v[32:35]
    v_mfma_f32_16x16x32_bf16 v[36:39], v[176:179], v[204:207], v[36:39]
    v_mfma_f32_16x16x32_bf16 v[40:43], v[176:179], v[208:211], v[40:43]
    v_mfma_f32_16x16x32_bf16 v[44:47], v[176:179], v[212:215], v[44:47]
    v_mfma_f32_16x16x32_bf16 v[48:51], v[180:183], v[200:203], v[48:51]
    v_mfma_f32_16x16x32_bf16 v[52:55], v[180:183], v[204:207], v[52:55]
    v_mfma_f32_16x16x32_bf16 v[56:59], v[180:183], v[208:211], v[56:59]
    v_mfma_f32_16x16x32_bf16 v[60:63], v[180:183], v[212:215], v[60:63]
    v_mfma_f32_16x16x32_bf16 v[64:67], v[184:187], v[200:203], v[64:67]
    v_mfma_f32_16x16x32_bf16 v[68:71], v[184:187], v[204:207], v[68:71]
    v_mfma_f32_16x16x32_bf16 v[72:75], v[184:187], v[208:211], v[72:75]
    v_mfma_f32_16x16x32_bf16 v[76:79], v[184:187], v[212:215], v[76:79]
    v_mfma_f32_16x16x32_bf16 v[80:83], v[188:191], v[200:203], v[80:83]
    v_mfma_f32_16x16x32_bf16 v[84:87], v[188:191], v[204:207], v[84:87]
    v_mfma_f32_16x16x32_bf16 v[88:91], v[188:191], v[208:211], v[88:91]
    v_mfma_f32_16x16x32_bf16 v[92:95], v[188:191], v[212:215], v[92:95]
    v_mfma_f32_16x16x32_bf16 v[96:99], v[192:195], v[200:203], v[96:99]
    v_mfma_f32_16x16x32_bf16 v[100:103], v[192:195], v[204:207], v[100:103]
    v_mfma_f32_16x16x32_bf16 v[104:107], v[192:195], v[208:211], v[104:107]
    v_mfma_f32_16x16x32_bf16 v[108:111], v[192:195], v[212:215], v[108:111]
    v_mfma_f32_16x16x32_bf16 v[112:115], v[196:199], v[200:203], v[112:115]
    v_mfma_f32_16x16x32_bf16 v[116:119], v[196:199], v[204:207], v[116:119]
    v_mfma_f32_16x16x32_bf16 v[120:123], v[196:199], v[208:211], v[120:123]
    v_mfma_f32_16x16x32_bf16 v[124:127], v[196:199], v[212:215], v[124:127]
    global_load_dwordx4 v[172:175], v6, s[6:7] offset:3072
    global_load_dwordx4 v[176:179], v7, s[6:7] offset:3072
    global_load_dwordx4 v[180:183], v8, s[6:7] offset:3072
    global_load_dwordx4 v[184:187], v9, s[6:7] offset:3072
    global_load_dwordx4 v[188:191], v10, s[6:7] offset:3072
    global_load_dwordx4 v[192:195], v11, s[6:7] offset:3072
    global_load_dwordx4 v[196:199], v12, s[6:7] offset:3072
    global_load_dwordx4 v[200:203], v216, s[6:7] offset:3072
    global_load_dwordx4 v[204:207], v217, s[6:7] offset:3072
    global_load_dwordx4 v[208:211], v218, s[6:7] offset:3072
    global_load_dwordx4 v[212:215], v219, s[6:7] offset:3072
    v_add_u32 v6, 4096, v6
    v_add_u32 v7, 4096, v7
    v_add_u32 v8, 4096, v8
    v_add_u32 v9, 4096, v9
    v_add_u32 v10, 4096, v10
    v_add_u32 v11, 4096, v11
    v_add_u32 v12, 4096, v12
    v_add_u32 v216, 4096, v216
    v_add_u32 v217, 4096, v217
    v_add_u32 v218, 4096, v218
    v_add_u32 v219, 4096, v219
    s_waitcnt vmcnt(11)
    v_mfma_f32_16x16x32_bf16 v[16:19], v[128:131], v[156:159], v[16:19]
    v_mfma_f32_16x16x32_bf16 v[20:23], v[128:131], v[160:163], v[20:23]
    v_mfma_f32_16x16x32_bf16 v[24:27], v[128:131], v[164:167], v[24:27]
    v_mfma_f32_16x16x32_bf16 v[28:31], v[128:131], v[168:171], v[28:31]
    v_mfma_f32_16x16x32_bf16 v[32:35], v[132:135], v[156:159], v[32:35]
    v_mfma_f32_16x16x32_bf16 v[36:39], v[132:135], v[160:163], v[36:39]
    v_mfma_f32_16x16x32_bf16 v[40:43], v[132:135], v[164:167], v[40:43]
    v_mfma_f32_16x16x32_bf16 v[44:47], v[132:135], v[168:171], v[44:47]
    v_mfma_f32_16x16x32_bf16 v[48:51], v[136:139], v[156:159], v[48:51]
    v_mfma_f32_16x16x32_bf16 v[52:55], v[136:139], v[160:163], v[52:55]
    v_mfma_f32_16x16x32_bf16 v[56:59], v[136:139], v[164:167], v[56:59]
    v_mfma_f32_16x16x32_bf16 v[60:63], v[136:139], v[168:171], v[60:63]
    v_mfma_f32_16x16x32_bf16 v[64:67], v[140:143], v[156:159], v[64:67]
    v_mfma_f32_16x16x32_bf16 v[68:71], v[140:143], v[160:163], v[68:71]
    v_mfma_f32_16x16x32_bf16 v[72:75], v[140:143], v[164:167], v[72:75]
    v_mfma_f32_16x16x32_bf16 v[76:79], v[140:143], v[168:171], v[76:79]
    v_mfma_f32_16x16x32_bf16 v[80:83], v[144:147], v[156:159], v[80:83]
    v_mfma_f32_16x16x32_bf16 v[84:87], v[144:147], v[160:163], v[84:87]
    v_mfma_f32_16x16x32_bf16 v[88:91], v[144:147], v[164:167], v[88:91]
    v_mfma_f32_16x16x32_bf16 v[92:95], v[144:147], v[168:171], v[92:95]
    v_mfma_f32_16x16x32_bf16 v[96:99], v[148:151], v[156:159], v[96:99]
    v_mfma_f32_16x16x32_bf16 v[100:103], v[148:151], v[160:163], v[100:103]
    v_mfma_f32_16x16x32_bf16 v[104:107], v[148:151], v[164:167], v[104:107]
    v_mfma_f32_16x16x32_bf16 v[108:111], v[148:151], v[168:171], v[108:111]
    v_mfma_f32_16x16x32_bf16 v[112:115], v[152:155], v[156:159], v[112:115]
    v_mfma_f32_16x16x32_bf16 v[116:119], v[152:155], v[160:163], v[116:119]
    v_mfma_f32_16x16x32_bf16 v[120:123], v[152:155], v[164:167], v[120:123]
    v_mfma_f32_16x16x32_bf16 v[124:127], v[152:155], v[168:171], v[124:127]
    global_load_dwordx4 v[128:131], v6, s[6:7] offset:0
    global_load_dwordx4 v[132:135], v7, s[6:7] offset:0
    global_load_dwordx4 v[136:139], v8, s[6:7] offset:0
    global_load_dwordx4 v[140:143], v9, s[6:7] offset:0
    global_load_dwordx4 v[144:147], v10, s[6:7] offset:0
    global_load_dwordx4 v[148:151], v11, s[6:7] offset:0
    global_load_dwordx4 v[152:155], v12, s[6:7] offset:0
    global_load_dwordx4 v[156:159], v216, s[6:7] offset:0
    global_load_dwordx4 v[160:163], v217, s[6:7] offset:0
    global_load_dwordx4 v[164:167], v218, s[6:7] offset:0
    global_load_dwordx4 v[168:171], v219, s[6:7] offset:0
    s_waitcnt vmcnt(11)
    v_mfma_f32_16x16x32_bf16 v[16:19], v[172:175], v[200:203], v[16:19]
    v_mfma_f32_16x16x32_bf16 v[20:23], v[172:175], v[204:207], v[20:23]
    v_mfma_f32_16x16x32_bf16 v[24:27], v[172:175], v[208:211], v[24:27]
    v_mfma_f32_16x16x32_bf16 v[28:31], v[172:175], v[212:215], v[28:31]
    v_mfma_f32_16x16x32_bf16 v[32:35], v[176:179], v[200:203], v[32:35]
    v_mfma_f32_16x16x32_bf16 v[36:39], v[176:179], v[204:207], v[36:39]
    v_mfma_f32_16x16x32_bf16 v[40:43], v[176:179], v[208:211], v[40:43]
    v_mfma_f32_16x16x32_bf16 v[44:47], v[176:179], v[212:215], v[44:47]
    v_mfma_f32_16x16x32_bf16 v[48:51], v[180:183], v[200:203], v[48:51]
    v_mfma_f32_16x16x32_bf16 v[52:55], v[180:183], v[204:207], v[52:55]
    v_mfma_f32_16x16x32_bf16 v[56:59], v[180:183], v[208:211], v[56:59]
    v_mfma_f32_16x16x32_bf16 v[60:63], v[180:183], v[212:215], v[60:63]
    v_mfma_f32_16x16x32_bf16 v[64:67], v[184:187], v[200:203], v[64:67]
    v_mfma_f32_16x16x32_bf16 v[68:71], v[184:187], v[204:207], v[68:71]
    v_mfma_f32_16x16x32_bf16 v[72:75], v[184:187], v[208:211], v[72:75]
    v_mfma_f32_16x16x32_bf16 v[76:79], v[184:187], v[212:215], v[76:79]
    v_mfma_f32_16x16x32_bf16 v[80:83], v[188:191], v[200:203], v[80:83]
    v_mfma_f32_16x16x32_bf16 v[84:87], v[188:191], v[204:207], v[84:87]
    v_mfma_f32_16x16x32_bf16 v[88:91], v[188:191], v[208:211], v[88:91]
    v_mfma_f32_16x16x32_bf16 v[92:95], v[188:191], v[212:215], v[92:95]
    v_mfma_f32_16x16x32_bf16 v[96:99], v[192:195], v[200:203], v[96:99]
    v_mfma_f32_16x16x32_bf16 v[100:103], v[192:195], v[204:207], v[100:103]
    v_mfma_f32_16x16x32_bf16 v[104:107], v[192:195], v[208:211], v[104:107]
    v_mfma_f32_16x16x32_bf16 v[108:111], v[192:195], v[212:215], v[108:111]
    v_mfma_f32_16x16x32_bf16 v[112:115], v[196:199], v[200:203], v[112:115]
    v_mfma_f32_16x16x32_bf16 v[116:119], v[196:199], v[204:207], v[116:119]
    v_mfma_f32_16x16x32_bf16 v[120:123], v[196:199], v[208:211], v[120:123]
    v_mfma_f32_16x16x32_bf16 v[124:127], v[196:199], v[212:215], v[124:127]
    global_load_dwordx4 v[172:175], v6, s[6:7] offset:1024
    global_load_dwordx4 v[176:179], v7, s[6:7] offset:1024
    global_load_dwordx4 v[180:183], v8, s[6:7] offset:1024
    global_load_dwordx4 v[184:187], v9, s[6:7] offset:1024
    global_load_dwordx4 v[188:191], v10, s[6:7] offset:1024
    global_load_dwordx4 v[192:195], v11, s[6:7] offset:1024
    global_load_dwordx4 v[196:199], v12, s[6:7] offset:1024
    global_load_dwordx4 v[200:203], v216, s[6:7] offset:1024
    global_load_dwordx4 v[204:207], v217, s[6:7] offset:1024
    global_load_dwordx4 v[208:211], v218, s[6:7] offset:1024
    global_load_dwordx4 v[212:215], v219, s[6:7] offset:1024
    s_waitcnt vmcnt(11)
    v_mfma_f32_16x16x32_bf16 v[16:19], v[128:131], v[156:159], v[16:19]
    v_mfma_f32_16x16x32_bf16 v[20:23], v[128:131], v[160:163], v[20:23]
    v_mfma_f32_16x16x32_bf16 v[24:27], v[128:131], v[164:167], v[24:27]
    v_mfma_f32_16x16x32_bf16 v[28:31], v[128:131], v[168:171], v[28:31]
    v_mfma_f32_16x16x32_bf16 v[32:35], v[132:135], v[156:159], v[32:35]
    v_mfma_f32_16x16x32_bf16 v[36:39], v[132:135], v[160:163], v[36:39]
    v_mfma_f32_16x16x32_bf16 v[40:43], v[132:135], v[164:167], v[40:43]
    v_mfma_f32_16x16x32_bf16 v[44:47], v[132:135], v[168:171], v[44:47]
    v_mfma_f32_16x16x32_bf16 v[48:51], v[136:139], v[156:159], v[48:51]
    v_mfma_f32_16x16x32_bf16 v[52:55], v[136:139], v[160:163], v[52:55]
    v_mfma_f32_16x16x32_bf16 v[56:59], v[136:139], v[164:167], v[56:59]
    v_mfma_f32_16x16x32_bf16 v[60:63], v[136:139], v[168:171], v[60:63]
    v_mfma_f32_16x16x32_bf16 v[64:67], v[140:143], v[156:159], v[64:67]
    v_mfma_f32_16x16x32_bf16 v[68:71], v[140:143], v[160:163], v[68:71]
    v_mfma_f32_16x16x32_bf16 v[72:75], v[140:143], v[164:167], v[72:75]
    v_mfma_f32_16x16x32_bf16 v[76:79], v[140:143], v[168:171], v[76:79]
    v_mfma_f32_16x16x32_bf16 v[80:83], v[144:147], v[156:159], v[80:83]
    v_mfma_f32_16x16x32_bf16 v[84:87], v[144:147], v[160:163], v[84:87]
    v_mfma_f32_16x16x32_bf16 v[88:91], v[144:147], v[164:167], v[88:91]
    v_mfma_f32_16x16x32_bf16 v[92:95], v[144:147], v[168:171], v[92:95]
    v_mfma_f32_16x16x32_bf16 v[96:99], v[148:151], v[156:159], v[96:99]
    v_mfma_f32_16x16x32_bf16 v[100:103], v[148:151], v[160:163], v[100:103]
    v_mfma_f32_16x16x32_bf16 v[104:107], v[148:151], v[164:167], v[104:107]
    v_mfma_f32_16x16x32_bf16 v[108:111], v[148:151], v[168:171], v[108:111]
    v_mfma_f32_16x16x32_bf16 v[112:115], v[152:155], v[156:159], v[112:115]
    v_mfma_f32_16x16x32_bf16 v[116:119], v[152:155], v[160:163], v[116:119]
    v_mfma_f32_16x16x32_bf16 v[120:123], v[152:155], v[164:167], v[120:123]
    v_mfma_f32_16x16x32_bf16 v[124:127], v[152:155], v[168:171], v[124:127]
    global_load_dwordx4 v[128:131], v6, s[6:7] offset:2048
    global_load_dwordx4 v[132:135], v7, s[6:7] offset:2048
    global_load_dwordx4 v[136:139], v8, s[6:7] offset:2048
    global_load_dwordx4 v[140:143], v9, s[6:7] offset:2048
    global_load_dwordx4 v[144:147], v10, s[6:7] offset:2048
    global_load_dwordx4 v[148:151], v11, s[6:7] offset:2048
    global_load_dwordx4 v[152:155], v12, s[6:7] offset:2048
    global_load_dwordx4 v[156:159], v216, s[6:7] offset:2048
    global_load_dwordx4 v[160:163], v217, s[6:7] offset:2048
    global_load_dwordx4 v[164:167], v218, s[6:7] offset:2048
    global_load_dwordx4 v[168:171], v219, s[6:7] offset:2048
    s_waitcnt vmcnt(11)
    v_mfma_f32_16x16x32_bf16 v[16:19], v[172:175], v[200:203], v[16:19]
    v_mfma_f32_16x16x32_bf16 v[20:23], v[172:175], v[204:207], v[20:23]
    v_mfma_f32_16x16x32_bf16 v[24:27], v[172:175], v[208:211], v[24:27]
    v_mfma_f32_16x16x32_bf16 v[28:31], v[172:175], v[212:215], v[28:31]
    v_mfma_f32_16x16x32_bf16 v[32:35], v[176:179], v[200:203], v[32:35]
    v_mfma_f32_16x16x32_bf16 v[36:39], v[176:179], v[204:207], v[36:39]
    v_mfma_f32_16x16x32_bf16 v[40:43], v[176:179], v[208:211], v[40:43]
    v_mfma_f32_16x16x32_bf16 v[44:47], v[176:179], v[212:215], v[44:47]
    v_mfma_f32_16x16x32_bf16 v[48:51], v[180:183], v[200:203], v[48:51]
    v_mfma_f32_16x16x32_bf16 v[52:55], v[180:183], v[204:207], v[52:55]
    v_mfma_f32_16x16x32_bf16 v[56:59], v[180:183], v[208:211], v[56:59]
    v_mfma_f32_16x16x32_bf16 v[60:63], v[180:183], v[212:215], v[60:63]
    v_mfma_f32_16x16x32_bf16 v[64:67], v[184:187], v[200:203], v[64:67]
    v_mfma_f32_16x16x32_bf16 v[68:71], v[184:187], v[204:207], v[68:71]
    v_mfma_f32_16x16x32_bf16 v[72:75], v[184:187], v[208:211], v[72:75]
    v_mfma_f32_16x16x32_bf16 v[76:79], v[184:187], v[212:215], v[76:79]
    v_mfma_f32_16x16x32_bf16 v[80:83], v[188:191], v[200:203], v[80:83]
    v_mfma_f32_16x16x32_bf16 v[84:87], v[188:191], v[204:207], v[84:87]
    v_mfma_f32_16x16x32_bf16 v[88:91], v[188:191], v[208:211], v[88:91]
    v_mfma_f32_16x16x32_bf16 v[92:95], v[188:191], v[212:215], v[92:95]
    v_mfma_f32_16x16x32_bf16 v[96:99], v[192:195], v[200:203], v[96:99]
    v_mfma_f32_16x16x32_bf16 v[100:103], v[192:195], v[204:207], v[100:103]
    v_mfma_f32_16x16x32_bf16 v[104:107], v[192:195], v[208:211], v[104:107]
    v_mfma_f32_16x16x32_bf16 v[108:111], v[192:195], v[212:215], v[108:111]
    v_mfma_f32_16x16x32_bf16 v[112:115], v[196:199], v[200:203], v[112:115]
    v_mfma_f32_16x16x32_bf16 v[116:119], v[196:199], v[204:207], v[116:119]
    v_mfma_f32_16x16x32_bf16 v[120:123], v[196:199], v[208:211], v[120:123]
    v_mfma_f32_16x16x32_bf16 v[124:127], v[196:199], v[212:215], v[124:127]
    global_load_dwordx4 v[172:175], v6, s[6:7] offset:3072
    global_load_dwordx4 v[176:179], v7, s[6:7] offset:3072
    global_load_dwordx4 v[180:183], v8, s[6:7] offset:3072
    global_load_dwordx4 v[184:187], v9, s[6:7] offset:3072
    global_load_dwordx4 v[188:191], v10, s[6:7] offset:3072
    global_load_dwordx4 v[192:195], v11, s[6:7] offset:3072
    global_load_dwordx4 v[196:199], v12, s[6:7] offset:3072
    global_load_dwordx4 v[200:203], v216, s[6:7] offset:3072
    global_load_dwordx4 v[204:207], v217, s[6:7] offset:3072
    global_load_dwordx4 v[208:211], v218, s[6:7] offset:3072
    global_load_dwordx4 v[212:215], v219, s[6:7] offset:3072
    v_add_u32 v6, 4096, v6
    v_add_u32 v7, 4096, v7
    v_add_u32 v8, 4096, v8
    v_add_u32 v9, 4096, v9
    v_add_u32 v10, 4096, v10
    v_add_u32 v11, 4096, v11
    v_add_u32 v12, 4096, v12
    v_add_u32 v216, 4096, v216
    v_add_u32 v217, 4096, v217
    v_add_u32 v218, 4096, v218
    v_add_u32 v219, 4096, v219
    s_waitcnt vmcnt(11)
    v_mfma_f32_16x16x32_bf16 v[16:19], v[128:131], v[156:159], v[16:19]
    v_mfma_f32_16x16x32_bf16 v[20:23], v[128:131], v[160:163], v[20:23]
    v_mfma_f32_16x16x32_bf16 v[24:27], v[128:131], v[164:167], v[24:27]
    v_mfma_f32_16x16x32_bf16 v[28:31], v[128:131], v[168:171], v[28:31]
    v_mfma_f32_16x16x32_bf16 v[32:35], v[132:135], v[156:159], v[32:35]
    v_mfma_f32_16x16x32_bf16 v[36:39], v[132:135], v[160:163], v[36:39]
    v_mfma_f32_16x16x32_bf16 v[40:43], v[132:135], v[164:167], v[40:43]
    v_mfma_f32_16x16x32_bf16 v[44:47], v[132:135], v[168:171], v[44:47]
    v_mfma_f32_16x16x32_bf16 v[48:51], v[136:139], v[156:159], v[48:51]
    v_mfma_f32_16x16x32_bf16 v[52:55], v[136:139], v[160:163], v[52:55]
    v_mfma_f32_16x16x32_bf16 v[56:59], v[136:139], v[164:167], v[56:59]
    v_mfma_f32_16x16x32_bf16 v[60:63], v[136:139], v[168:171], v[60:63]
    v_mfma_f32_16x16x32_bf16 v[64:67], v[140:143], v[156:159], v[64:67]
    v_mfma_f32_16x16x32_bf16 v[68:71], v[140:143], v[160:163], v[68:71]
    v_mfma_f32_16x16x32_bf16 v[72:75], v[140:143], v[164:167], v[72:75]
    v_mfma_f32_16x16x32_bf16 v[76:79], v[140:143], v[168:171], v[76:79]
    v_mfma_f32_16x16x32_bf16 v[80:83], v[144:147], v[156:159], v[80:83]
    v_mfma_f32_16x16x32_bf16 v[84:87], v[144:147], v[160:163], v[84:87]
    v_mfma_f32_16x16x32_bf16 v[88:91], v[144:147], v[164:167], v[88:91]
    v_mfma_f32_16x16x32_bf16 v[92:95], v[144:147], v[168:171], v[92:95]
    v_mfma_f32_16x16x32_bf16 v[96:99], v[148:151], v[156:159], v[96:99]
    v_mfma_f32_16x16x32_bf16 v[100:103], v[148:151], v[160:163], v[100:103]
    v_mfma_f32_16x16x32_bf16 v[104:107], v[148:151], v[164:167], v[104:107]
    v_mfma_f32_16x16x32_bf16 v[108:111], v[148:151], v[168:171], v[108:111]
    v_mfma_f32_16x16x32_bf16 v[112:115], v[152:155], v[156:159], v[112:115]
    v_mfma_f32_16x16x32_bf16 v[116:119], v[152:155], v[160:163], v[116:119]
    v_mfma_f32_16x16x32_bf16 v[120:123], v[152:155], v[164:167], v[120:123]
    v_mfma_f32_16x16x32_bf16 v[124:127], v[152:155], v[168:171], v[124:127]
    global_load_dwordx4 v[128:131], v6, s[6:7] offset:0
    global_load_dwordx4 v[132:135], v7, s[6:7] offset:0
    global_load_dwordx4 v[136:139], v8, s[6:7] offset:0
    global_load_dwordx4 v[140:143], v9, s[6:7] offset:0
    global_load_dwordx4 v[144:147], v10, s[6:7] offset:0
    global_load_dwordx4 v[148:151], v11, s[6:7] offset:0
    global_load_dwordx4 v[152:155], v12, s[6:7] offset:0
    global_load_dwordx4 v[156:159], v216, s[6:7] offset:0
    global_load_dwordx4 v[160:163], v217, s[6:7] offset:0
    global_load_dwordx4 v[164:167], v218, s[6:7] offset:0
    global_load_dwordx4 v[168:171], v219, s[6:7] offset:0
    s_waitcnt vmcnt(11)
    v_mfma_f32_16x16x32_bf16 v[16:19], v[172:175], v[200:203], v[16:19]
    v_mfma_f32_16x16x32_bf16 v[20:23], v[172:175], v[204:207], v[20:23]
    v_mfma_f32_16x16x32_bf16 v[24:27], v[172:175], v[208:211], v[24:27]
    v_mfma_f32_16x16x32_bf16 v[28:31], v[172:175], v[212:215], v[28:31]
    v_mfma_f32_16x16x32_bf16 v[32:35], v[176:179], v[200:203], v[32:35]
    v_mfma_f32_16x16x32_bf16 v[36:39], v[176:179], v[204:207], v[36:39]
    v_mfma_f32_16x16x32_bf16 v[40:43], v[176:179], v[208:211], v[40:43]
    v_mfma_f32_16x16x32_bf16 v[44:47], v[176:179], v[212:215], v[44:47]
    v_mfma_f32_16x16x32_bf16 v[48:51], v[180:183], v[200:203], v[48:51]
    v_mfma_f32_16x16x32_bf16 v[52:55], v[180:183], v[204:207], v[52:55]
    v_mfma_f32_16x16x32_bf16 v[56:59], v[180:183], v[208:211], v[56:59]
    v_mfma_f32_16x16x32_bf16 v[60:63], v[180:183], v[212:215], v[60:63]
    v_mfma_f32_16x16x32_bf16 v[64:67], v[184:187], v[200:203], v[64:67]
    v_mfma_f32_16x16x32_bf16 v[68:71], v[184:187], v[204:207], v[68:71]
    v_mfma_f32_16x16x32_bf16 v[72:75], v[184:187], v[208:211], v[72:75]
    v_mfma_f32_16x16x32_bf16 v[76:79], v[184:187], v[212:215], v[76:79]
    v_mfma_f32_16x16x32_bf16 v[80:83], v[188:191], v[200:203], v[80:83]
    v_mfma_f32_16x16x32_bf16 v[84:87], v[188:191], v[204:207], v[84:87]
    v_mfma_f32_16x16x32_bf16 v[88:91], v[188:191], v[208:211], v[88:91]
    v_mfma_f32_16x16x32_bf16 v[92:95], v[188:191], v[212:215], v[92:95]
    v_mfma_f32_16x16x32_bf16 v[96:99], v[192:195], v[200:203], v[96:99]
    v_mfma_f32_16x16x32_bf16 v[100:103], v[192:195], v[204:207], v[100:103]
    v_mfma_f32_16x16x32_bf16 v[104:107], v[192:195], v[208:211], v[104:107]
    v_mfma_f32_16x16x32_bf16 v[108:111], v[192:195], v[212:215], v[108:111]
    v_mfma_f32_16x16x32_bf16 v[112:115], v[196:199], v[200:203], v[112:115]
    v_mfma_f32_16x16x32_bf16 v[116:119], v[196:199], v[204:207], v[116:119]
    v_mfma_f32_16x16x32_bf16 v[120:123], v[196:199], v[208:211], v[120:123]
    v_mfma_f32_16x16x32_bf16 v[124:127], v[196:199], v[212:215], v[124:127]
    global_load_dwordx4 v[172:175], v6, s[6:7] offset:1024
    global_load_dwordx4 v[176:179], v7, s[6:7] offset:1024
    global_load_dwordx4 v[180:183], v8, s[6:7] offset:1024
    global_load_dwordx4 v[184:187], v9, s[6:7] offset:1024
    global_load_dwordx4 v[188:191], v10, s[6:7] offset:1024
    global_load_dwordx4 v[192:195], v11, s[6:7] offset:1024
    global_load_dwordx4 v[196:199], v12, s[6:7] offset:1024
    global_load_dwordx4 v[200:203], v216, s[6:7] offset:1024
    global_load_dwordx4 v[204:207], v217, s[6:7] offset:1024
    global_load_dwordx4 v[208:211], v218, s[6:7] offset:1024
    global_load_dwordx4 v[212:215], v219, s[6:7] offset:1024
    s_waitcnt vmcnt(11)
    v_mfma_f32_16x16x32_bf16 v[16:19], v[128:131], v[156:159], v[16:19]
    v_mfma_f32_16x16x32_bf16 v[20:23], v[128:131], v[160:163], v[20:23]
    v_mfma_f32_16x16x32_bf16 v[24:27], v[128:131], v[164:167], v[24:27]
    v_mfma_f32_16x16x32_bf16 v[28:31], v[128:131], v[168:171], v[28:31]
    v_mfma_f32_16x16x32_bf16 v[32:35], v[132:135], v[156:159], v[32:35]
    v_mfma_f32_16x16x32_bf16 v[36:39], v[132:135], v[160:163], v[36:39]
    v_mfma_f32_16x16x32_bf16 v[40:43], v[132:135], v[164:167], v[40:43]
    v_mfma_f32_16x16x32_bf16 v[44:47], v[132:135], v[168:171], v[44:47]
    v_mfma_f32_16x16x32_bf16 v[48:51], v[136:139], v[156:159], v[48:51]
    v_mfma_f32_16x16x32_bf16 v[52:55], v[136:139], v[160:163], v[52:55]
    v_mfma_f32_16x16x32_bf16 v[56:59], v[136:139], v[164:167], v[56:59]
    v_mfma_f32_16x16x32_bf16 v[60:63], v[136:139], v[168:171], v[60:63]
    v_mfma_f32_16x16x32_bf16 v[64:67], v[140:143], v[156:159], v[64:67]
    v_mfma_f32_16x16x32_bf16 v[68:71], v[140:143], v[160:163], v[68:71]
    v_mfma_f32_16x16x32_bf16 v[72:75], v[140:143], v[164:167], v[72:75]
    v_mfma_f32_16x16x32_bf16 v[76:79], v[140:143], v[168:171], v[76:79]
    v_mfma_f32_16x16x32_bf16 v[80:83], v[144:147], v[156:159], v[80:83]
    v_mfma_f32_16x16x32_bf16 v[84:87], v[144:147], v[160:163], v[84:87]
    v_mfma_f32_16x16x32_bf16 v[88:91], v[144:147], v[164:167], v[88:91]
    v_mfma_f32_16x16x32_bf16 v[92:95], v[144:147], v[168:171], v[92:95]
    v_mfma_f32_16x16x32_bf16 v[96:99], v[148:151], v[156:159], v[96:99]
    v_mfma_f32_16x16x32_bf16 v[100:103], v[148:151], v[160:163], v[100:103]
    v_mfma_f32_16x16x32_bf16 v[104:107], v[148:151], v[164:167], v[104:107]
    v_mfma_f32_16x16x32_bf16 v[108:111], v[148:151], v[168:171], v[108:111]
    v_mfma_f32_16x16x32_bf16 v[112:115], v[152:155], v[156:159], v[112:115]
    v_mfma_f32_16x16x32_bf16 v[116:119], v[152:155], v[160:163], v[116:119]
    v_mfma_f32_16x16x32_bf16 v[120:123], v[152:155], v[164:167], v[120:123]
    v_mfma_f32_16x16x32_bf16 v[124:127], v[152:155], v[168:171], v[124:127]
    s_waitcnt vmcnt(0)
    v_mfma_f32_16x16x32_bf16 v[16:19], v[172:175], v[200:203], v[16:19]
    v_mfma_f32_16x16x32_bf16 v[20:23], v[172:175], v[204:207], v[20:23]
    v_mfma_f32_16x16x32_bf16 v[24:27], v[172:175], v[208:211], v[24:27]
    v_mfma_f32_16x16x32_bf16 v[28:31], v[172:175], v[212:215], v[28:31]
    v_mfma_f32_16x16x32_bf16 v[32:35], v[176:179], v[200:203], v[32:35]
    v_mfma_f32_16x16x32_bf16 v[36:39], v[176:179], v[204:207], v[36:39]
    v_mfma_f32_16x16x32_bf16 v[40:43], v[176:179], v[208:211], v[40:43]
    v_mfma_f32_16x16x32_bf16 v[44:47], v[176:179], v[212:215], v[44:47]
    v_mfma_f32_16x16x32_bf16 v[48:51], v[180:183], v[200:203], v[48:51]
    v_mfma_f32_16x16x32_bf16 v[52:55], v[180:183], v[204:207], v[52:55]
    v_mfma_f32_16x16x32_bf16 v[56:59], v[180:183], v[208:211], v[56:59]
    v_mfma_f32_16x16x32_bf16 v[60:63], v[180:183], v[212:215], v[60:63]
    v_mfma_f32_16x16x32_bf16 v[64:67], v[184:187], v[200:203], v[64:67]
    v_mfma_f32_16x16x32_bf16 v[68:71], v[184:187], v[204:207], v[68:71]
    v_mfma_f32_16x16x32_bf16 v[72:75], v[184:187], v[208:211], v[72:75]
    v_mfma_f32_16x16x32_bf16 v[76:79], v[184:187], v[212:215], v[76:79]
    v_mfma_f32_16x16x32_bf16 v[80:83], v[188:191], v[200:203], v[80:83]
    v_mfma_f32_16x16x32_bf16 v[84:87], v[188:191], v[204:207], v[84:87]
    v_mfma_f32_16x16x32_bf16 v[88:91], v[188:191], v[208:211], v[88:91]
    v_mfma_f32_16x16x32_bf16 v[92:95], v[188:191], v[212:215], v[92:95]
    v_mfma_f32_16x16x32_bf16 v[96:99], v[192:195], v[200:203], v[96:99]
    v_mfma_f32_16x16x32_bf16 v[100:103], v[192:195], v[204:207], v[100:103]
    v_mfma_f32_16x16x32_bf16 v[104:107], v[192:195], v[208:211], v[104:107]
    v_mfma_f32_16x16x32_bf16 v[108:111], v[192:195], v[212:215], v[108:111]
    v_mfma_f32_16x16x32_bf16 v[112:115], v[196:199], v[200:203], v[112:115]
    v_mfma_f32_16x16x32_bf16 v[116:119], v[196:199], v[204:207], v[116:119]
    v_mfma_f32_16x16x32_bf16 v[120:123], v[196:199], v[208:211], v[120:123]
    v_mfma_f32_16x16x32_bf16 v[124:127], v[196:199], v[212:215], v[124:127]
    s_nop 7
    s_nop 1
    s_mul_i32 s23, s22, 1835008
    s_mul_i32 s26, s21, 57344
    s_add_u32 s23, s23, s26
    s_mul_i32 s26, s8, 3584
    s_add_u32 s23, s23, s26
    s_add_u32 s23, s23, 0x4200000
    v_add_u32 v5, s23, v4
    v_lshrrev_b32 v13, 1, v4
    v_add_u32 v13, s23, v13
    v_cvt_pk_bf16_f32 v128, v16, v17
    v_cvt_pk_bf16_f32 v129, v18, v19
    v_cvt_pk_bf16_f32 v130, v32, v33
    v_cvt_pk_bf16_f32 v131, v34, v35
    global_store_dwordx4 v5, v[128:131], s[6:7] offset:0 sc1
    v_cvt_pk_bf16_f32 v132, v48, v49
    v_cvt_pk_bf16_f32 v133, v50, v51
    v_cvt_pk_bf16_f32 v134, v64, v65
    v_cvt_pk_bf16_f32 v135, v66, v67
    global_store_dwordx4 v5, v[132:135], s[6:7] offset:1024 sc1
    v_cvt_pk_bf16_f32 v136, v80, v81
    v_cvt_pk_bf16_f32 v137, v82, v83
    v_cvt_pk_bf16_f32 v138, v96, v97
    v_cvt_pk_bf16_f32 v139, v98, v99
    global_store_dwordx4 v5, v[136:139], s[6:7] offset:2048 sc1
    v_cvt_pk_bf16_f32 v140, v112, v113
    v_cvt_pk_bf16_f32 v141, v114, v115
    global_store_dwordx2 v13, v[140:141], s[6:7] offset:3072 sc1
    v_add_u32 v5, 14336, v5
    v_add_u32 v13, 14336, v13
    v_cvt_pk_bf16_f32 v144, v20, v21
    v_cvt_pk_bf16_f32 v145, v22, v23
    v_cvt_pk_bf16_f32 v146, v36, v37
    v_cvt_pk_bf16_f32 v147, v38, v39
    global_store_dwordx4 v5, v[144:147], s[6:7] offset:0 sc1
    v_cvt_pk_bf16_f32 v148, v52, v53
    v_cvt_pk_bf16_f32 v149, v54, v55
    v_cvt_pk_bf16_f32 v150, v68, v69
    v_cvt_pk_bf16_f32 v151, v70, v71
    global_store_dwordx4 v5, v[148:151], s[6:7] offset:1024 sc1
    v_cvt_pk_bf16_f32 v152, v84, v85
    v_cvt_pk_bf16_f32 v153, v86, v87
    v_cvt_pk_bf16_f32 v154, v100, v101
    v_cvt_pk_bf16_f32 v155, v102, v103
    global_store_dwordx4 v5, v[152:155], s[6:7] offset:2048 sc1
    v_cvt_pk_bf16_f32 v156, v116, v117
    v_cvt_pk_bf16_f32 v157, v118, v119
    global_store_dwordx2 v13, v[156:157], s[6:7] offset:3072 sc1
    v_add_u32 v5, 14336, v5
    v_add_u32 v13, 14336, v13
    v_cvt_pk_bf16_f32 v160, v24, v25
    v_cvt_pk_bf16_f32 v161, v26, v27
    v_cvt_pk_bf16_f32 v162, v40, v41
    v_cvt_pk_bf16_f32 v163, v42, v43
    global_store_dwordx4 v5, v[160:163], s[6:7] offset:0 sc1
    v_cvt_pk_bf16_f32 v164, v56, v57
    v_cvt_pk_bf16_f32 v165, v58, v59
    v_cvt_pk_bf16_f32 v166, v72, v73
    v_cvt_pk_bf16_f32 v167, v74, v75
    global_store_dwordx4 v5, v[164:167], s[6:7] offset:1024 sc1
    v_cvt_pk_bf16_f32 v168, v88, v89
    v_cvt_pk_bf16_f32 v169, v90, v91
    v_cvt_pk_bf16_f32 v170, v104, v105
    v_cvt_pk_bf16_f32 v171, v106, v107
    global_store_dwordx4 v5, v[168:171], s[6:7] offset:2048 sc1
    v_cvt_pk_bf16_f32 v172, v120, v121
    v_cvt_pk_bf16_f32 v173, v122, v123
    global_store_dwordx2 v13, v[172:173], s[6:7] offset:3072 sc1
    v_add_u32 v5, 14336, v5
    v_add_u32 v13, 14336, v13
    v_cvt_pk_bf16_f32 v176, v28, v29
    v_cvt_pk_bf16_f32 v177, v30, v31
    v_cvt_pk_bf16_f32 v178, v44, v45
    v_cvt_pk_bf16_f32 v179, v46, v47
    global_store_dwordx4 v5, v[176:179], s[6:7] offset:0 sc1
    v_cvt_pk_bf16_f32 v180, v60, v61
    v_cvt_pk_bf16_f32 v181, v62, v63
    v_cvt_pk_bf16_f32 v182, v76, v77
    v_cvt_pk_bf16_f32 v183, v78, v79
    global_store_dwordx4 v5, v[180:183], s[6:7] offset:1024 sc1
    v_cvt_pk_bf16_f32 v184, v92, v93
    v_cvt_pk_bf16_f32 v185, v94, v95
    v_cvt_pk_bf16_f32 v186, v108, v109
    v_cvt_pk_bf16_f32 v187, v110, v111
    global_store_dwordx4 v5, v[184:187], s[6:7] offset:2048 sc1
    v_cvt_pk_bf16_f32 v188, v124, v125
    v_cvt_pk_bf16_f32 v189, v126, v127
    global_store_dwordx2 v13, v[188:189], s[6:7] offset:3072 sc1
    s_lshl_b32 s23, s21, 2
    s_add_u32 s23, s23, 0x8080
    s_waitcnt vmcnt(0)
    s_barrier
    s_cmp_lg_u32 s8, 0
    s_cbranch_scc1 .sg_54
    s_mov_b64 exec, 1
    v_mov_b32 v4, s23
    v_mov_b32 v5, 1
    global_atomic_add v4, v5, s[6:7]
    s_mov_b64 exec, -1
.sg_54:
    s_branch .wk_loop_41
.wk_44:
    s_mov_b32 s10, s22
    s_lshl_b32 s23, s21, 2
    s_add_u32 s24, s23, 0x8080
    s_add_u32 s23, s23, 0x8000
    s_cmp_lg_u32 s8, 0
    s_cbranch_scc1 .wf_55
    v_mov_b32 v4, s23
    v_mov_b32 v5, s24
.wf_56:
    global_load_dword v8, v4, s[6:7] sc1
    global_load_dword v9, v5, s[6:7] sc1
    s_sub_u32 s12, s12, 1
    s_cmp_eq_u32 s12, 0
    s_cbranch_scc1 .mg_end_12
    s_waitcnt vmcnt(0)
    v_readfirstlane_b32 s13, v8
    s_nop 3
    s_cmp_lt_u32 s13, 16
    s_cbranch_scc1 .wf_57
    v_readfirstlane_b32 s13, v9
    s_nop 3
    s_cmp_lt_u32 s13, 16
    s_cbranch_scc1 .wf_57
    s_branch .wf_58
.wf_57:
    s_sleep 8
    s_branch .wf_56
.wf_58:
.wf_55:
    s_barrier
    v_lshlrev_b32 v4, 4, v1
    v_lshlrev_b32 v5, 3, v1
    s_mul_i32 s11, s9, 28672
    s_add_u32 s14, s11, 0x400000
    v_add_u32 v8, s14, v4
    v_add_u32 v9, s14, v5
    v_add_u32 v10, 14336, v8
    v_add_u32 v11, 14336, v9
    s_lshl_b32 s13, s10, 2
    s_add_u32 s13, s13, s8
    s_mul_i32 s13, s13, 1835008
    s_add_u32 s13, s13, s11
    s_add_u32 s13, s13, 0x4200000
    v_add_u32 v12, s13, v4
    v_add_u32 v13, s13, v5
    v_add_u32 v14, 14336, v12
    v_add_u32 v15, 14336, v13
    global_load_dwordx4 v[144:147], v8, s[6:7] offset:0
    global_load_dwordx4 v[148:151], v8, s[6:7] offset:1024
    global_load_dwordx4 v[152:155], v8, s[6:7] offset:2048
    global_load_dwordx2 v[156:157], v9, s[6:7] offset:3072
    global_load_dwordx4 v[158:161], v10, s[6:7] offset:0
    global_load_dwordx4 v[162:165], v10, s[6:7] offset:1024
    global_load_dwordx4 v[166:169], v10, s[6:7] offset:2048
    global_load_dwordx2 v[170:171], v11, s[6:7] offset:3072
    global_load_dwordx4 v[32:35], v12, s[6:7] offset:0 sc1
    global_load_dwordx4 v[36:39], v12, s[6:7] offset:1024 sc1
    global_load_dwordx4 v[40:43], v12, s[6:7] offset:2048 sc1
    global_load_dwordx2 v[44:45], v13, s[6:7] offset:3072 sc1
    global_load_dwordx4 v[46:49], v14, s[6:7] offset:0 sc1
    global_load_dwordx4 v[50:53], v14, s[6:7] offset:1024 sc1
    global_load_dwordx4 v[54:57], v14, s[6:7] offset:2048 sc1
    global_load_dwordx2 v[58:59], v15, s[6:7] offset:3072 sc1
    v_add_u32 v8, 3584, v8
    v_add_u32 v9, 3584, v9
    v_add_u32 v10, 3584, v10
    v_add_u32 v11, 3584, v11
    v_add_u32 v12, 3584, v12
    v_add_u32 v13, 3584, v13
    v_add_u32 v14, 3584, v14
    v_add_u32 v15, 3584, v15
    global_load_dwordx4 v[172:175], v8, s[6:7] offset:0
    global_load_dwordx4 v[176:179], v8, s[6:7] offset:1024
    global_load_dwordx4 v[180:183], v8, s[6:7] offset:2048
    global_load_dwordx2 v[184:185], v9, s[6:7] offset:3072
    global_load_dwordx4 v[186:189], v10, s[6:7] offset:0
    global_load_dwordx4 v[190:193], v10, s[6:7] offset:1024
    global_load_dwordx4 v[194:197], v10, s[6:7] offset:2048
    global_load_dwordx2 v[198:199], v11, s[6:7] offset:3072
    global_load_dwordx4 v[60:63], v12, s[6:7] offset:0 sc1
    global_load_dwordx4 v[64:67], v12, s[6:7] offset:1024 sc1
    global_load_dwordx4 v[68:71], v12, s[6:7] offset:2048 sc1
    global_load_dwordx2 v[72:73], v13, s[6:7] offset:3072 sc1
    global_load_dwordx4 v[74:77], v14, s[6:7] offset:0 sc1
    global_load_dwordx4 v[78:81], v14, s[6:7] offset:1024 sc1
    global_load_dwordx4 v[82:85], v14, s[6:7] offset:2048 sc1
    global_load_dwordx2 v[86:87], v15, s[6:7] offset:3072 sc1
    v_add_u32 v8, 3584, v8
    v_add_u32 v9, 3584, v9
    v_add_u32 v10, 3584, v10
    v_add_u32 v11, 3584, v11
    v_add_u32 v12, 3584, v12
    v_add_u32 v13, 3584, v13
    v_add_u32 v14, 3584, v14
    v_add_u32 v15, 3584, v15
    s_waitcnt vmcnt(16)
    v_mfma_f32_16x16x32_bf16 v[200:203], v[144:147], v[32:35], 0
    v_mfma_f32_16x16x32_bf16 v[204:207], v[144:147], v[46:49], 0
    v_mfma_f32_16x16x32_bf16 v[208:211], v[158:161], v[46:49], 0
    v_mfma_f32_16x16x32_bf16 v[200:203], v[148:151], v[36:39], v[200:203]
    v_mfma_f32_16x16x32_bf16 v[204:207], v[148:151], v[50:53], v[204:207]
    v_mfma_f32_16x16x32_bf16 v[208:211], v[162:165], v[50:53], v[208:211]
    v_mfma_f32_16x16x32_bf16 v[200:203], v[152:155], v[40:43], v[200:203]
    v_mfma_f32_16x16x32_bf16 v[204:207], v[152:155], v[54:57], v[204:207]
    v_mfma_f32_16x16x32_bf16 v[208:211], v[166:169], v[54:57], v[208:211]
    v_mfma_f32_16x16x16_bf16 v[200:203], v[156:157], v[44:45], v[200:203]
    v_mfma_f32_16x16x16_bf16 v[204:207], v[156:157], v[58:59], v[204:207]
    v_mfma_f32_16x16x16_bf16 v[208:211], v[170:171], v[58:59], v[208:211]
    global_load_dwordx4 v[144:147], v8, s[6:7] offset:0
    global_load_dwordx4 v[148:151], v8, s[6:7] offset:1024
    global_load_dwordx4 v[152:155], v8, s[6:7] offset:2048
    global_load_dwordx2 v[156:157], v9, s[6:7] offset:3072
    global_load_dwordx4 v[158:161], v10, s[6:7] offset:0
    global_load_dwordx4 v[162:165], v10, s[6:7] offset:1024
    global_load_dwordx4 v[166:169], v10, s[6:7] offset:2048
    global_load_dwordx2 v[170:171], v11, s[6:7] offset:3072
    global_load_dwordx4 v[88:91], v12, s[6:7] offset:0 sc1
    global_load_dwordx4 v[92:95], v12, s[6:7] offset:1024 sc1
    global_load_dwordx4 v[96:99], v12, s[6:7] offset:2048 sc1
    global_load_dwordx2 v[100:101], v13, s[6:7] offset:3072 sc1
    global_load_dwordx4 v[102:105], v14, s[6:7] offset:0 sc1
    global_load_dwordx4 v[106:109], v14, s[6:7] offset:1024 sc1
    global_load_dwordx4 v[110:113], v14, s[6:7] offset:2048 sc1
    global_load_dwordx2 v[114:115], v15, s[6:7] offset:3072 sc1
    v_add_u32 v8, 3584, v8
    v_add_u32 v9, 3584, v9
    v_add_u32 v10, 3584, v10
    v_add_u32 v11, 3584, v11
    v_add_u32 v12, 3584, v12
    v_add_u32 v13, 3584, v13
    v_add_u32 v14, 3584, v14
    v_add_u32 v15, 3584, v15
    s_waitcnt vmcnt(16)
    v_mfma_f32_16x16x32_bf16 v[200:203], v[172:175], v[60:63], v[200:203]
    v_mfma_f32_16x16x32_bf16 v[204:207], v[172:175], v[74:77], v[204:207]
    v_mfma_f32_16x16x32_bf16 v[208:211], v[186:189], v[74:77], v[208:211]
    v_mfma_f32_16x16x32_bf16 v[200:203], v[176:179], v[64:67], v[200:203]
    v_mfma_f32_16x16x32_bf16 v[204:207], v[176:179], v[78:81], v[204:207]
    v_mfma_f32_16x16x32_bf16 v[208:211], v[190:193], v[78:81], v[208:211]
    v_mfma_f32_16x16x32_bf16 v[200:203], v[180:183], v[68:71], v[200:203]
    v_mfma_f32_16x16x32_bf16 v[204:207], v[180:183], v[82:85], v[204:207]
    v_mfma_f32_16x16x32_bf16 v[208:211], v[194:197], v[82:85], v[208:211]
    v_mfma_f32_16x16x16_bf16 v[200:203], v[184:185], v[72:73], v[200:203]
    v_mfma_f32_16x16x16_bf16 v[204:207], v[184:185], v[86:87], v[204:207]
    v_mfma_f32_16x16x16_bf16 v[208:211], v[198:199], v[86:87], v[208:211]
    global_load_dwordx4 v[172:175], v8, s[6:7] offset:0
    global_load_dwordx4 v[176:179], v8, s[6:7] offset:1024
    global_load_dwordx4 v[180:183], v8, s[6:7] offset:2048
    global_load_dwordx2 v[184:185], v9, s[6:7] offset:3072
    global_load_dwordx4 v[186:189], v10, s[6:7] offset:0
    global_load_dwordx4 v[190:193], v10, s[6:7] offset:1024
    global_load_dwordx4 v[194:197], v10, s[6:7] offset:2048
    global_load_dwordx2 v[198:199], v11, s[6:7] offset:3072
    global_load_dwordx4 v[116:119], v12, s[6:7] offset:0 sc1
    global_load_dwordx4 v[120:123], v12, s[6:7] offset:1024 sc1
    global_load_dwordx4 v[124:127], v12, s[6:7] offset:2048 sc1
    global_load_dwordx2 v[128:129], v13, s[6:7] offset:3072 sc1
    global_load_dwordx4 v[130:133], v14, s[6:7] offset:0 sc1
    global_load_dwordx4 v[134:137], v14, s[6:7] offset:1024 sc1
    global_load_dwordx4 v[138:141], v14, s[6:7] offset:2048 sc1
    global_load_dwordx2 v[142:143], v15, s[6:7] offset:3072 sc1
    v_add_u32 v8, 3584, v8
    v_add_u32 v9, 3584, v9
    v_add_u32 v10, 3584, v10
    v_add_u32 v11, 3584, v11
    v_add_u32 v12, 3584, v12
    v_add_u32 v13, 3584, v13
    v_add_u32 v14, 3584, v14
    v_add_u32 v15, 3584, v15
    s_waitcnt vmcnt(16)
    v_mfma_f32_16x16x32_bf16 v[200:203], v[144:147], v[88:91], v[200:203]
    v_mfma_f32_16x16x32_bf16 v[204:207], v[144:147], v[102:105], v[204:207]
    v_mfma_f32_16x16x32_bf16 v[208:211], v[158:161], v[102:105], v[208:211]
    v_mfma_f32_16x16x32_bf16 v[200:203], v[148:151], v[92:95], v[200:203]
    v_mfma_f32_16x16x32_bf16 v[204:207], v[148:151], v[106:109], v[204:207]
    v_mfma_f32_16x16x32_bf16 v[208:211], v[162:165], v[106:109], v[208:211]
    v_mfma_f32_16x16x32_bf16 v[200:203], v[152:155], v[96:99], v[200:203]
    v_mfma_f32_16x16x32_bf16 v[204:207], v[152:155], v[110:113], v[204:207]
    v_mfma_f32_16x16x32_bf16 v[208:211], v[166:169], v[110:113], v[208:211]
    v_mfma_f32_16x16x16_bf16 v[200:203], v[156:157], v[100:101], v[200:203]
    v_mfma_f32_16x16x16_bf16 v[204:207], v[156:157], v[114:115], v[204:207]
    v_mfma_f32_16x16x16_bf16 v[208:211], v[170:171], v[114:115], v[208:211]
    s_waitcnt vmcnt(0)
    v_mfma_f32_16x16x32_bf16 v[200:203], v[172:175], v[116:119], v[200:203]
    v_mfma_f32_16x16x32_bf16 v[204:207], v[172:175], v[130:133], v[204:207]
    v_mfma_f32_16x16x32_bf16 v[208:211], v[186:189], v[130:133], v[208:211]
    v_mfma_f32_16x16x32_bf16 v[200:203], v[176:179], v[120:123], v[200:203]
    v_mfma_f32_16x16x32_bf16 v[204:207], v[176:179], v[134:137], v[204:207]
    v_mfma_f32_16x16x32_bf16 v[208:211], v[190:193], v[134:137], v[208:211]
    v_mfma_f32_16x16x32_bf16 v[200:203], v[180:183], v[124:127], v[200:203]
    v_mfma_f32_16x16x32_bf16 v[204:207], v[180:183], v[138:141], v[204:207]
    v_mfma_f32_16x16x32_bf16 v[208:211], v[194:197], v[138:141], v[208:211]
    v_mfma_f32_16x16x16_bf16 v[200:203], v[184:185], v[128:129], v[200:203]
    v_mfma_f32_16x16x16_bf16 v[204:207], v[184:185], v[142:143], v[204:207]
    v_mfma_f32_16x16x16_bf16 v[208:211], v[198:199], v[142:143], v[208:211]
    s_lshl_b32 s11, s9, 4
    s_lshl_b32 s14, s10, 2
    s_add_u32 s11, s11, s14
    s_mul_i32 s11, s11, 28
    s_mul_i32 s14, s8, 7
    s_add_u32 s11, s11, s14
    s_lshl_b32 s11, s11, 10
    s_add_u32 s11, s11, 0x5e00000
    v_add_u32 v6, s11, v4
    v_add_u32 v7, 4096, v6
    global_load_dwordx4 a[0:3], v6, s[6:7] offset:0 sc1
    global_load_dwordx4 a[4:7], v6, s[6:7] offset:1024 sc1
    global_load_dwordx4 a[8:11], v6, s[6:7] offset:2048 sc1
    global_load_dwordx4 a[12:15], v6, s[6:7] offset:3072 sc1
    global_load_dwordx4 a[16:19], v7, s[6:7] offset:0 sc1
    global_load_dwordx4 a[20:23], v7, s[6:7] offset:1024 sc1
    global_load_dwordx4 a[24:27], v7, s[6:7] offset:2048 sc1
    s_add_u32 s11, s11, 28672
    v_add_u32 v6, s11, v4
    v_add_u32 v7, 4096, v6
    global_load_dwordx4 a[28:31], v6, s[6:7] offset:0 sc1
    global_load_dwordx4 a[32:35], v6, s[6:7] offset:1024 sc1
    global_load_dwordx4 a[36:39], v6, s[6:7] offset:2048 sc1
    global_load_dwordx4 a[40:43], v6, s[6:7] offset:3072 sc1
    global_load_dwordx4 a[44:47], v7, s[6:7] offset:0 sc1
    global_load_dwordx4 a[48:51], v7, s[6:7] offset:1024 sc1
    global_load_dwordx4 a[52:55], v7, s[6:7] offset:2048 sc1
    s_add_u32 s11, s11, 28672
    v_add_u32 v6, s11, v4
    v_add_u32 v7, 4096, v6
    global_load_dwordx4 a[56:59], v6, s[6:7] offset:0 sc1
    global_load_dwordx4 a[60:63], v6, s[6:7] offset:1024 sc1
    global_load_dwordx4 a[64:67], v6, s[6:7] offset:2048 sc1
    global_load_dwordx4 a[68:71], v6, s[6:7] offset:3072 sc1
    global_load_dwordx4 a[72:75], v7, s[6:7] offset:0 sc1
    global_load_dwordx4 a[76:79], v7, s[6:7] offset:1024 sc1
    global_load_dwordx4 a[80:83], v7, s[6:7] offset:2048 sc1
    s_add_u32 s11, s11, 28672
    v_add_u32 v6, s11, v4
    v_add_u32 v7, 4096, v6
    global_load_dwordx4 a[84:87], v6, s[6:7] offset:0 sc1
    global_load_dwordx4 a[88:91], v6, s[6:7] offset:1024 sc1
    global_load_dwordx4 a[92:95], v6, s[6:7] offset:2048 sc1
    global_load_dwordx4 a[96:99], v6, s[6:7] offset:3072 sc1
    global_load_dwordx4 a[100:103], v7, s[6:7] offset:0 sc1
    global_load_dwordx4 a[104:107], v7, s[6:7] offset:1024 sc1
    global_load_dwordx4 a[108:111], v7, s[6:7] offset:2048 sc1
    s_add_u32 s11, s11, 28672
    v_min_u32 v244, 55, v1
    v_lshlrev_b32 v245, 5, v244
    v_add_u32 v7, 3584, v245
    global_load_dwordx4 a[168:171], v7, s[6:7] offset:0
    global_load_dwordx4 a[172:175], v7, s[6:7] offset:16
    global_load_dwordx4 a[176:179], v7, s[6:7] offset:1792
    global_load_dwordx4 a[180:183], v7, s[6:7] offset:1808
    global_load_dwordx4 a[184:187], v7, s[6:7] offset:3584
    global_load_dwordx4 a[188:191], v7, s[6:7] offset:3600
    s_lshl_b32 s26, s9, 5
    s_lshl_b32 s13, s10, 3
    s_add_u32 s26, s26, s13
    s_lshl_b32 s13, s8, 1
    s_add_u32 s26, s26, s13
    s_mul_i32 s13, s26, 896
    v_lshl_add_u32 v7, v244, 4, s13
    global_load_dwordx4 a[192:195], v7, s[30:31] offset:0
    global_load_dwordx4 a[196:199], v7, s[30:31] offset:896
    s_lshl_b32 s11, s9, 3
    s_lshl_b32 s13, s10, 1
    s_add_u32 s11, s11, s13
    s_mul_i32 s11, s11, 28
    s_add_u32 s11, s11, s14
    s_lshl_b32 s11, s11, 10
    s_add_u32 s11, s11, 0x2600000
    v_add_u32 v246, s11, v4
    s_mul_i32 s13, s9, 7168
    s_add_u32 s13, s13, 0x130e00
    v_lshrrev_b32 v16, 1, v3
    v_lshlrev_b32 v16, 7, v16
    v_and_b32 v17, 7, v2
    v_lshl_add_u32 v16, v17, 4, v16
    v_and_b32 v17, 1, v3
    v_lshl_add_u32 v16, v17, 3, v16
    v_add_u32 v247, s13, v16
    s_lshl_b32 s25, s9, 2
    s_add_u32 s25, s25, 0x8508
    s_waitcnt vmcnt(0)
    s_cmp_lg_u32 s8, 0
    s_cbranch_scc1 .wf_59
    v_mov_b32 v4, s25
.wf_60:
    global_load_dword v8, v4, s[6:7] sc1
    s_sub_u32 s12, s12, 1
    s_cmp_eq_u32 s12, 0
    s_cbranch_scc1 .mg_end_12
    s_waitcnt vmcnt(0)
    v_readfirstlane_b32 s13, v8
    s_nop 3
    s_cmp_lt_u32 s13, 56
    s_cbranch_scc1 .wf_61
    s_branch .wf_62
.wf_61:
    s_sleep 8
    s_branch .wf_60
.wf_62:
.wf_59:
    s_barrier
    v_lshlrev_b32 v4, 4, v1
    global_load_dwordx2 v[144:145], v247, s[6:7] offset:-3584 sc1
    global_load_dwordx2 v[146:147], v247, s[6:7] offset:-3328 sc1
    global_load_dwordx2 v[148:149], v247, s[6:7] offset:-3072 sc1
    global_load_dwordx2 v[150:151], v247, s[6:7] offset:-2816 sc1
    global_load_dwordx2 v[152:153], v247, s[6:7] offset:-2560 sc1
    global_load_dwordx2 v[154:155], v247, s[6:7] offset:-2304 sc1
    global_load_dwordx2 v[156:157], v247, s[6:7] offset:-2048 sc1
    global_load_dwordx2 v[158:159], v247, s[6:7] offset:-1792 sc1
    global_load_dwordx2 v[160:161], v247, s[6:7] offset:-1536 sc1
    global_load_dwordx2 v[162:163], v247, s[6:7] offset:-1280 sc1
    global_load_dwordx2 v[164:165], v247, s[6:7] offset:-1024 sc1
    global_load_dwordx2 v[166:167], v247, s[6:7] offset:-768 sc1
    global_load_dwordx2 v[168:169], v247, s[6:7] offset:-512 sc1
    global_load_dwordx2 v[170:171], v247, s[6:7] offset:-256 sc1
    global_load_dwordx2 v[172:173], v247, s[6:7] offset:0 sc1
    global_load_dwordx2 v[174:175], v247, s[6:7] offset:256 sc1
    global_load_dwordx2 v[176:177], v247, s[6:7] offset:512 sc1
    global_load_dwordx2 v[178:179], v247, s[6:7] offset:768 sc1
    global_load_dwordx2 v[180:181], v247, s[6:7] offset:1024 sc1
    global_load_dwordx2 v[182:183], v247, s[6:7] offset:1280 sc1
    global_load_dwordx2 v[184:185], v247, s[6:7] offset:1536 sc1
    global_load_dwordx2 v[186:187], v247, s[6:7] offset:1792 sc1
    global_load_dwordx2 v[188:189], v247, s[6:7] offset:2048 sc1
    global_load_dwordx2 v[190:191], v247, s[6:7] offset:2304 sc1
    global_load_dwordx2 v[192:193], v247, s[6:7] offset:2560 sc1
    global_load_dwordx2 v[194:195], v247, s[6:7] offset:2816 sc1
    global_load_dwordx2 v[196:197], v247, s[6:7] offset:3072 sc1
    global_load_dwordx2 v[198:199], v247, s[6:7] offset:3328 sc1
    v_add_u32 v7, 4096, v246
    global_load_dwordx4 a[112:115], v246, s[6:7] offset:0 sc1
    global_load_dwordx4 a[116:119], v246, s[6:7] offset:1024 sc1
    global_load_dwordx4 a[120:123], v246, s[6:7] offset:2048 sc1
    global_load_dwordx4 a[124:127], v246, s[6:7] offset:3072 sc1
    global_load_dwordx4 a[128:131], v7, s[6:7] offset:0 sc1
    global_load_dwordx4 a[132:135], v7, s[6:7] offset:1024 sc1
    global_load_dwordx4 a[136:139], v7, s[6:7] offset:2048 sc1
    v_add_u32 v246, 28672, v246
    v_add_u32 v7, 4096, v246
    global_load_dwordx4 a[140:143], v246, s[6:7] offset:0 sc1
    global_load_dwordx4 a[144:147], v246, s[6:7] offset:1024 sc1
    global_load_dwordx4 a[148:151], v246, s[6:7] offset:2048 sc1
    global_load_dwordx4 a[152:155], v246, s[6:7] offset:3072 sc1
    global_load_dwordx4 a[156:159], v7, s[6:7] offset:0 sc1
    global_load_dwordx4 a[160:163], v7, s[6:7] offset:1024 sc1
    global_load_dwordx4 a[164:167], v7, s[6:7] offset:2048 sc1
    v_add_u32 v246, 28672, v246
    v_mov_b32 v20, 0xff800000
    v_lshlrev_b32 v21, 2, v3
    v_add_u32 v22, 0, v21
    v_cmp_gt_u32 vcc, v22, v2
    s_nop 1
    v_cndmask_b32 v200, v200, v20, vcc
    v_cndmask_b32 v208, v208, v20, vcc
    v_add_u32 v22, 1, v21
    v_cmp_gt_u32 vcc, v22, v2
    s_nop 1
    v_cndmask_b32 v201, v201, v20, vcc
    v_cndmask_b32 v209, v209, v20, vcc
    v_add_u32 v22, 2, v21
    v_cmp_gt_u32 vcc, v22, v2
    s_nop 1
    v_cndmask_b32 v202, v202, v20, vcc
    v_cndmask_b32 v210, v210, v20, vcc
    v_add_u32 v22, 3, v21
    v_cmp_gt_u32 vcc, v22, v2
    s_nop 1
    v_cndmask_b32 v203, v203, v20, vcc
    v_cndmask_b32 v211, v211, v20, vcc
    v_mov_b32 v23, 0x3fb8aa3b
    s_lshl_b32 s11, s8, 11
    v_add_u32 v24, s11, v4
    s_lshr_b32 s11, s8, 1
    s_lshl_b32 s11, s11, 11
    s_and_b32 s14, s8, 1
    s_lshl_b32 s14, s14, 3
    s_add_u32 s11, s11, s14
    s_add_u32 s11, s11, 8192
    v_add_u32 v25, s11, v4
    s_waitcnt vmcnt(14)
    v_mfma_f32_16x16x32_bf16 v[212:215], v[144:147], v[32:35], 0
    v_mfma_f32_16x16x32_bf16 v[216:219], v[144:147], v[46:49], 0
    v_mfma_f32_16x16x32_bf16 v[212:215], v[148:151], v[36:39], v[212:215]
    v_mfma_f32_16x16x32_bf16 v[216:219], v[148:151], v[50:53], v[216:219]
    v_mfma_f32_16x16x32_bf16 v[212:215], v[152:155], v[40:43], v[212:215]
    v_mfma_f32_16x16x32_bf16 v[216:219], v[152:155], v[54:57], v[216:219]
    v_mfma_f32_16x16x16_bf16 v[212:215], v[156:157], v[44:45], v[212:215]
    v_mfma_f32_16x16x16_bf16 v[216:219], v[156:157], v[58:59], v[216:219]
    v_mfma_f32_16x16x32_bf16 v[212:215], v[158:161], v[60:63], v[212:215]
    v_mfma_f32_16x16x32_bf16 v[216:219], v[158:161], v[74:77], v[216:219]
    v_mfma_f32_16x16x32_bf16 v[212:215], v[162:165], v[64:67], v[212:215]
    v_mfma_f32_16x16x32_bf16 v[216:219], v[162:165], v[78:81], v[216:219]
    v_mfma_f32_16x16x32_bf16 v[212:215], v[166:169], v[68:71], v[212:215]
    v_mfma_f32_16x16x32_bf16 v[216:219], v[166:169], v[82:85], v[216:219]
    v_mfma_f32_16x16x16_bf16 v[212:215], v[170:171], v[72:73], v[212:215]
    v_mfma_f32_16x16x16_bf16 v[216:219], v[170:171], v[86:87], v[216:219]
    v_mfma_f32_16x16x32_bf16 v[212:215], v[172:175], v[88:91], v[212:215]
    v_mfma_f32_16x16x32_bf16 v[216:219], v[172:175], v[102:105], v[216:219]
    v_mfma_f32_16x16x32_bf16 v[212:215], v[176:179], v[92:95], v[212:215]
    v_mfma_f32_16x16x32_bf16 v[216:219], v[176:179], v[106:109], v[216:219]
    v_mfma_f32_16x16x32_bf16 v[212:215], v[180:183], v[96:99], v[212:215]
    v_mfma_f32_16x16x32_bf16 v[216:219], v[180:183], v[110:113], v[216:219]
    v_mfma_f32_16x16x16_bf16 v[212:215], v[184:185], v[100:101], v[212:215]
    v_mfma_f32_16x16x16_bf16 v[216:219], v[184:185], v[114:115], v[216:219]
    v_mfma_f32_16x16x32_bf16 v[212:215], v[186:189], v[116:119], v[212:215]
    v_mfma_f32_16x16x32_bf16 v[216:219], v[186:189], v[130:133], v[216:219]
    v_mfma_f32_16x16x32_bf16 v[212:215], v[190:193], v[120:123], v[212:215]
    v_mfma_f32_16x16x32_bf16 v[216:219], v[190:193], v[134:137], v[216:219]
    v_mfma_f32_16x16x32_bf16 v[212:215], v[194:197], v[124:127], v[212:215]
    v_mfma_f32_16x16x32_bf16 v[216:219], v[194:197], v[138:141], v[216:219]
    v_mfma_f32_16x16x16_bf16 v[212:215], v[198:199], v[128:129], v[212:215]
    v_mfma_f32_16x16x16_bf16 v[216:219], v[198:199], v[142:143], v[216:219]
    v_cmp_le_u32 vcc, 2, v3
    s_nop 7
    v_cndmask_b32 v212, v212, v20, vcc
    v_cndmask_b32 v213, v213, v20, vcc
    v_cndmask_b32 v214, v214, v20, vcc
    v_cndmask_b32 v215, v215, v20, vcc
    v_cndmask_b32 v216, v216, v20, vcc
    v_cndmask_b32 v217, v217, v20, vcc
    v_cndmask_b32 v218, v218, v20, vcc
    v_cndmask_b32 v219, v219, v20, vcc
    v_max3_f32 v26, v200, v201, v202
    v_max3_f32 v26, v26, v203, v212
    v_max3_f32 v26, v26, v213, v214
    v_max_f32 v26, v26, v215
    v_mov_b32 v27, v26
    s_nop 1
    v_permlane32_swap_b32 v26, v27
    s_nop 1
    v_max_f32 v26, v26, v27
    v_mov_b32 v27, v26
    s_nop 1
    v_permlane16_swap_b32 v26, v27
    s_nop 1
    v_max_f32 v26, v26, v27
    v_mul_f32 v26, v26, v23
    v_fma_f32 v200, v200, v23, -v26
    v_fma_f32 v201, v201, v23, -v26
    v_fma_f32 v202, v202, v23, -v26
    v_fma_f32 v203, v203, v23, -v26
    v_fma_f32 v212, v212, v23, -v26
    v_fma_f32 v213, v213, v23, -v26
    v_fma_f32 v214, v214, v23, -v26
    v_fma_f32 v215, v215, v23, -v26
    v_exp_f32 v200, v200
    v_exp_f32 v201, v201
    v_exp_f32 v202, v202
    v_exp_f32 v203, v203
    v_exp_f32 v212, v212
    v_exp_f32 v213, v213
    v_exp_f32 v214, v214
    v_exp_f32 v215, v215
    s_nop 0
    v_add_f32 v28, v200, v201
    v_add_f32 v28, v28, v202
    v_add_f32 v28, v28, v203
    v_add_f32 v28, v28, v212
    v_add_f32 v28, v28, v213
    v_add_f32 v28, v28, v214
    v_add_f32 v28, v28, v215
    v_mov_b32 v27, v28
    s_nop 1
    v_permlane32_swap_b32 v28, v27
    s_nop 1
    v_add_f32 v28, v28, v27
    v_mov_b32 v27, v28
    s_nop 1
    v_permlane16_swap_b32 v28, v27
    s_nop 1
    v_add_f32 v28, v28, v27
    v_rcp_f32 v28, v28
    s_nop 0
    v_mul_f32 v200, v200, v28
    v_mul_f32 v201, v201, v28
    v_mul_f32 v202, v202, v28
    v_mul_f32 v203, v203, v28
    v_mul_f32 v212, v212, v28
    v_mul_f32 v213, v213, v28
    v_mul_f32 v214, v214, v28
    v_mul_f32 v215, v215, v28
    v_cvt_pk_bf16_f32 v32, v200, v201
    v_cvt_pk_bf16_f32 v33, v202, v203
    v_mov_b32 v34, 0
    v_mov_b32 v35, 0
    v_cvt_pk_bf16_f32 v36, v212, v213
    v_cvt_pk_bf16_f32 v37, v214, v215
    ds_write_b128 v24, v[32:35] offset:0
    ds_write_b64 v25, v[36:37] offset:0
    v_max3_f32 v26, v204, v205, v206
    v_max3_f32 v26, v26, v207, v208
    v_max3_f32 v26, v26, v209, v210
    v_max3_f32 v26, v26, v211, v216
    v_max3_f32 v26, v26, v217, v218
    v_max_f32 v26, v26, v219
    v_mov_b32 v27, v26
    s_nop 1
    v_permlane32_swap_b32 v26, v27
    s_nop 1
    v_max_f32 v26, v26, v27
    v_mov_b32 v27, v26
    s_nop 1
    v_permlane16_swap_b32 v26, v27
    s_nop 1
    v_max_f32 v26, v26, v27
    v_mul_f32 v26, v26, v23
    v_fma_f32 v204, v204, v23, -v26
    v_fma_f32 v205, v205, v23, -v26
    v_fma_f32 v206, v206, v23, -v26
    v_fma_f32 v207, v207, v23, -v26
    v_fma_f32 v208, v208, v23, -v26
    v_fma_f32 v209, v209, v23, -v26
    v_fma_f32 v210, v210, v23, -v26
    v_fma_f32 v211, v211, v23, -v26
    v_fma_f32 v216, v216, v23, -v26
    v_fma_f32 v217, v217, v23, -v26
    v_fma_f32 v218, v218, v23, -v26
    v_fma_f32 v219, v219, v23, -v26
    v_exp_f32 v204, v204
    v_exp_f32 v205, v205
    v_exp_f32 v206, v206
    v_exp_f32 v207, v207
    v_exp_f32 v208, v208
    v_exp_f32 v209, v209
    v_exp_f32 v210, v210
    v_exp_f32 v211, v211
    v_exp_f32 v216, v216
    v_exp_f32 v217, v217
    v_exp_f32 v218, v218
    v_exp_f32 v219, v219
    s_nop 0
    v_add_f32 v28, v204, v205
    v_add_f32 v28, v28, v206
    v_add_f32 v28, v28, v207
    v_add_f32 v28, v28, v208
    v_add_f32 v28, v28, v209
    v_add_f32 v28, v28, v210
    v_add_f32 v28, v28, v211
    v_add_f32 v28, v28, v216
    v_add_f32 v28, v28, v217
    v_add_f32 v28, v28, v218
    v_add_f32 v28, v28, v219
    v_mov_b32 v27, v28
    s_nop 1
    v_permlane32_swap_b32 v28, v27
    s_nop 1
    v_add_f32 v28, v28, v27
    v_mov_b32 v27, v28
    s_nop 1
    v_permlane16_swap_b32 v28, v27
    s_nop 1
    v_add_f32 v28, v28, v27
    v_rcp_f32 v28, v28
    s_nop 0
    v_mul_f32 v204, v204, v28
    v_mul_f32 v205, v205, v28
    v_mul_f32 v206, v206, v28
    v_mul_f32 v207, v207, v28
    v_mul_f32 v208, v208, v28
    v_mul_f32 v209, v209, v28
    v_mul_f32 v210, v210, v28
    v_mul_f32 v211, v211, v28
    v_mul_f32 v216, v216, v28
    v_mul_f32 v217, v217, v28
    v_mul_f32 v218, v218, v28
    v_mul_f32 v219, v219, v28
    v_cvt_pk_bf16_f32 v40, v204, v205
    v_cvt_pk_bf16_f32 v41, v206, v207
    v_cvt_pk_bf16_f32 v42, v208, v209
    v_cvt_pk_bf16_f32 v43, v210, v211
    v_cvt_pk_bf16_f32 v44, v216, v217
    v_cvt_pk_bf16_f32 v45, v218, v219
    ds_write_b128 v24, v[40:43] offset:1024
    ds_write_b64 v25, v[44:45] offset:1024
    s_waitcnt lgkmcnt(0)
    s_barrier
    ds_read_b128 v[32:35], v4 offset:0
    ds_read_b128 v[36:39], v4 offset:1024
    ds_read_b128 v[40:43], v4 offset:2048
    ds_read_b128 v[44:47], v4 offset:3072
    ds_read_b128 v[48:51], v4 offset:4096
    ds_read_b128 v[52:55], v4 offset:5120
    ds_read_b128 v[56:59], v4 offset:6144
    ds_read_b128 v[60:63], v4 offset:7168
    ds_read_b128 v[64:67], v4 offset:8192
    ds_read_b128 v[68:71], v4 offset:9216
    ds_read_b128 v[72:75], v4 offset:10240
    ds_read_b128 v[76:79], v4 offset:11264
    s_mul_i32 s11, s10, 3670016
    s_mul_i32 s14, s9, 57344
    s_add_u32 s11, s11, s14
    s_mul_i32 s14, s8, 448
    s_add_u32 s11, s11, s14
    s_add_u32 s11, s11, 0x3400000
    s_mov_b32 s14, 7168
    v_mul_lo_u32 v6, v3, s14
    v_lshl_add_u32 v6, v2, 2, v6
    v_add_u32 v6, s11, v6
    s_waitcnt vmcnt(0) lgkmcnt(0)
    v_mfma_f32_16x16x32_bf16 v[80:83], v[32:35], a[0:3], 0
    v_mfma_f32_16x16x32_bf16 v[84:87], v[32:35], a[4:7], 0
    v_mfma_f32_16x16x32_bf16 v[88:91], v[32:35], a[8:11], 0
    v_mfma_f32_16x16x32_bf16 v[92:95], v[32:35], a[12:15], 0
    v_mfma_f32_16x16x32_bf16 v[96:99], v[32:35], a[16:19], 0
    v_mfma_f32_16x16x32_bf16 v[100:103], v[32:35], a[20:23], 0
    v_mfma_f32_16x16x32_bf16 v[104:107], v[32:35], a[24:27], 0
    v_mfma_f32_16x16x32_bf16 v[80:83], v[40:43], a[28:31], v[80:83]
    v_mfma_f32_16x16x32_bf16 v[84:87], v[40:43], a[32:35], v[84:87]
    v_mfma_f32_16x16x32_bf16 v[88:91], v[40:43], a[36:39], v[88:91]
    v_mfma_f32_16x16x32_bf16 v[92:95], v[40:43], a[40:43], v[92:95]
    v_mfma_f32_16x16x32_bf16 v[96:99], v[40:43], a[44:47], v[96:99]
    v_mfma_f32_16x16x32_bf16 v[100:103], v[40:43], a[48:51], v[100:103]
    v_mfma_f32_16x16x32_bf16 v[104:107], v[40:43], a[52:55], v[104:107]
    v_mfma_f32_16x16x32_bf16 v[80:83], v[48:51], a[56:59], v[80:83]
    v_mfma_f32_16x16x32_bf16 v[84:87], v[48:51], a[60:63], v[84:87]
    v_mfma_f32_16x16x32_bf16 v[88:91], v[48:51], a[64:67], v[88:91]
    v_mfma_f32_16x16x32_bf16 v[92:95], v[48:51], a[68:71], v[92:95]
    v_mfma_f32_16x16x32_bf16 v[96:99], v[48:51], a[72:75], v[96:99]
    v_mfma_f32_16x16x32_bf16 v[100:103], v[48:51], a[76:79], v[100:103]
    v_mfma_f32_16x16x32_bf16 v[104:107], v[48:51], a[80:83], v[104:107]
    v_mfma_f32_16x16x32_bf16 v[80:83], v[56:59], a[84:87], v[80:83]
    v_mfma_f32_16x16x32_bf16 v[84:87], v[56:59], a[88:91], v[84:87]
    v_mfma_f32_16x16x32_bf16 v[88:91], v[56:59], a[92:95], v[88:91]
    v_mfma_f32_16x16x32_bf16 v[92:95], v[56:59], a[96:99], v[92:95]
    v_mfma_f32_16x16x32_bf16 v[96:99], v[56:59], a[100:103], v[96:99]
    v_mfma_f32_16x16x32_bf16 v[100:103], v[56:59], a[104:107], v[100:103]
    v_mfma_f32_16x16x32_bf16 v[104:107], v[56:59], a[108:111], v[104:107]
    v_mfma_f32_16x16x32_bf16 v[80:83], v[64:67], a[112:115], v[80:83]
    v_mfma_f32_16x16x32_bf16 v[84:87], v[64:67], a[116:119], v[84:87]
    v_mfma_f32_16x16x32_bf16 v[88:91], v[64:67], a[120:123], v[88:91]
    v_mfma_f32_16x16x32_bf16 v[92:95], v[64:67], a[124:127], v[92:95]
    v_mfma_f32_16x16x32_bf16 v[96:99], v[64:67], a[128:131], v[96:99]
    v_mfma_f32_16x16x32_bf16 v[100:103], v[64:67], a[132:135], v[100:103]
    v_mfma_f32_16x16x32_bf16 v[104:107], v[64:67], a[136:139], v[104:107]
    v_mfma_f32_16x16x32_bf16 v[80:83], v[72:75], a[140:143], v[80:83]
    v_mfma_f32_16x16x32_bf16 v[84:87], v[72:75], a[144:147], v[84:87]
    v_mfma_f32_16x16x32_bf16 v[88:91], v[72:75], a[148:151], v[88:91]
    v_mfma_f32_16x16x32_bf16 v[92:95], v[72:75], a[152:155], v[92:95]
    v_mfma_f32_16x16x32_bf16 v[96:99], v[72:75], a[156:159], v[96:99]
    v_mfma_f32_16x16x32_bf16 v[100:103], v[72:75], a[160:163], v[100:103]
    v_mfma_f32_16x16x32_bf16 v[104:107], v[72:75], a[164:167], v[104:107]
    v_mfma_f32_16x16x32_bf16 v[108:111], v[36:39], a[0:3], 0
    v_mfma_f32_16x16x32_bf16 v[112:115], v[36:39], a[4:7], 0
    v_mfma_f32_16x16x32_bf16 v[116:119], v[36:39], a[8:11], 0
    v_mfma_f32_16x16x32_bf16 v[120:123], v[36:39], a[12:15], 0
    v_mfma_f32_16x16x32_bf16 v[124:127], v[36:39], a[16:19], 0
    v_mfma_f32_16x16x32_bf16 v[128:131], v[36:39], a[20:23], 0
    v_mfma_f32_16x16x32_bf16 v[132:135], v[36:39], a[24:27], 0
    v_mfma_f32_16x16x32_bf16 v[108:111], v[44:47], a[28:31], v[108:111]
    v_mfma_f32_16x16x32_bf16 v[112:115], v[44:47], a[32:35], v[112:115]
    v_mfma_f32_16x16x32_bf16 v[116:119], v[44:47], a[36:39], v[116:119]
    v_mfma_f32_16x16x32_bf16 v[120:123], v[44:47], a[40:43], v[120:123]
    v_mfma_f32_16x16x32_bf16 v[124:127], v[44:47], a[44:47], v[124:127]
    v_mfma_f32_16x16x32_bf16 v[128:131], v[44:47], a[48:51], v[128:131]
    v_mfma_f32_16x16x32_bf16 v[132:135], v[44:47], a[52:55], v[132:135]
    v_add_u32 v7, 0, v6
    global_store_dword v7, v80, s[6:7] offset:0 sc1
    global_store_dword v7, v84, s[6:7] offset:64 sc1
    global_store_dword v7, v88, s[6:7] offset:128 sc1
    global_store_dword v7, v92, s[6:7] offset:192 sc1
    global_store_dword v7, v96, s[6:7] offset:256 sc1
    global_store_dword v7, v100, s[6:7] offset:320 sc1
    global_store_dword v7, v104, s[6:7] offset:384 sc1
    v_mfma_f32_16x16x32_bf16 v[108:111], v[52:55], a[56:59], v[108:111]
    v_mfma_f32_16x16x32_bf16 v[112:115], v[52:55], a[60:63], v[112:115]
    v_mfma_f32_16x16x32_bf16 v[116:119], v[52:55], a[64:67], v[116:119]
    v_mfma_f32_16x16x32_bf16 v[120:123], v[52:55], a[68:71], v[120:123]
    v_mfma_f32_16x16x32_bf16 v[124:127], v[52:55], a[72:75], v[124:127]
    v_mfma_f32_16x16x32_bf16 v[128:131], v[52:55], a[76:79], v[128:131]
    v_mfma_f32_16x16x32_bf16 v[132:135], v[52:55], a[80:83], v[132:135]
    v_add_u32 v7, 1792, v6
    global_store_dword v7, v81, s[6:7] offset:0 sc1
    global_store_dword v7, v85, s[6:7] offset:64 sc1
    global_store_dword v7, v89, s[6:7] offset:128 sc1
    global_store_dword v7, v93, s[6:7] offset:192 sc1
    global_store_dword v7, v97, s[6:7] offset:256 sc1
    global_store_dword v7, v101, s[6:7] offset:320 sc1
    global_store_dword v7, v105, s[6:7] offset:384 sc1
    v_mfma_f32_16x16x32_bf16 v[108:111], v[60:63], a[84:87], v[108:111]
    v_mfma_f32_16x16x32_bf16 v[112:115], v[60:63], a[88:91], v[112:115]
    v_mfma_f32_16x16x32_bf16 v[116:119], v[60:63], a[92:95], v[116:119]
    v_mfma_f32_16x16x32_bf16 v[120:123], v[60:63], a[96:99], v[120:123]
    v_mfma_f32_16x16x32_bf16 v[124:127], v[60:63], a[100:103], v[124:127]
    v_mfma_f32_16x16x32_bf16 v[128:131], v[60:63], a[104:107], v[128:131]
    v_mfma_f32_16x16x32_bf16 v[132:135], v[60:63], a[108:111], v[132:135]
    v_add_u32 v7, 3584, v6
    global_store_dword v7, v82, s[6:7] offset:0 sc1
    global_store_dword v7, v86, s[6:7] offset:64 sc1
    global_store_dword v7, v90, s[6:7] offset:128 sc1
    global_store_dword v7, v94, s[6:7] offset:192 sc1
    global_store_dword v7, v98, s[6:7] offset:256 sc1
    global_store_dword v7, v102, s[6:7] offset:320 sc1
    global_store_dword v7, v106, s[6:7] offset:384 sc1
    v_mfma_f32_16x16x32_bf16 v[108:111], v[68:71], a[112:115], v[108:111]
    v_mfma_f32_16x16x32_bf16 v[112:115], v[68:71], a[116:119], v[112:115]
    v_mfma_f32_16x16x32_bf16 v[116:119], v[68:71], a[120:123], v[116:119]
    v_mfma_f32_16x16x32_bf16 v[120:123], v[68:71], a[124:127], v[120:123]
    v_mfma_f32_16x16x32_bf16 v[124:127], v[68:71], a[128:131], v[124:127]
    v_mfma_f32_16x16x32_bf16 v[128:131], v[68:71], a[132:135], v[128:131]
    v_mfma_f32_16x16x32_bf16 v[132:135], v[68:71], a[136:139], v[132:135]
    v_add_u32 v7, 5376, v6
    global_store_dword v7, v83, s[6:7] offset:0 sc1
    global_store_dword v7, v87, s[6:7] offset:64 sc1
    global_store_dword v7, v91, s[6:7] offset:128 sc1
    global_store_dword v7, v95, s[6:7] offset:192 sc1
    global_store_dword v7, v99, s[6:7] offset:256 sc1
    global_store_dword v7, v103, s[6:7] offset:320 sc1
    global_store_dword v7, v107, s[6:7] offset:384 sc1
    v_mfma_f32_16x16x32_bf16 v[108:111], v[76:79], a[140:143], v[108:111]
    v_mfma_f32_16x16x32_bf16 v[112:115], v[76:79], a[144:147], v[112:115]
    v_mfma_f32_16x16x32_bf16 v[116:119], v[76:79], a[148:151], v[116:119]
    v_mfma_f32_16x16x32_bf16 v[120:123], v[76:79], a[152:155], v[120:123]
    v_mfma_f32_16x16x32_bf16 v[124:127], v[76:79], a[156:159], v[124:127]
    v_mfma_f32_16x16x32_bf16 v[128:131], v[76:79], a[160:163], v[128:131]
    v_mfma_f32_16x16x32_bf16 v[132:135], v[76:79], a[164:167], v[132:135]
    s_nop 7
    v_add_u32 v7, 28672, v6
    global_store_dword v7, v108, s[6:7] offset:0 sc1
    global_store_dword v7, v112, s[6:7] offset:64 sc1
    global_store_dword v7, v116, s[6:7] offset:128 sc1
    global_store_dword v7, v120, s[6:7] offset:192 sc1
    global_store_dword v7, v124, s[6:7] offset:256 sc1
    global_store_dword v7, v128, s[6:7] offset:320 sc1
    global_store_dword v7, v132, s[6:7] offset:384 sc1
    v_add_u32 v7, 30464, v6
    global_store_dword v7, v109, s[6:7] offset:0 sc1
    global_store_dword v7, v113, s[6:7] offset:64 sc1
    global_store_dword v7, v117, s[6:7] offset:128 sc1
    global_store_dword v7, v121, s[6:7] offset:192 sc1
    global_store_dword v7, v125, s[6:7] offset:256 sc1
    global_store_dword v7, v129, s[6:7] offset:320 sc1
    global_store_dword v7, v133, s[6:7] offset:384 sc1
    v_add_u32 v7, 32256, v6
    global_store_dword v7, v110, s[6:7] offset:0 sc1
    global_store_dword v7, v114, s[6:7] offset:64 sc1
    global_store_dword v7, v118, s[6:7] offset:128 sc1
    global_store_dword v7, v122, s[6:7] offset:192 sc1
    global_store_dword v7, v126, s[6:7] offset:256 sc1
    global_store_dword v7, v130, s[6:7] offset:320 sc1
    global_store_dword v7, v134, s[6:7] offset:384 sc1
    v_add_u32 v7, 34048, v6
    global_store_dword v7, v111, s[6:7] offset:0 sc1
    global_store_dword v7, v115, s[6:7] offset:64 sc1
    global_store_dword v7, v119, s[6:7] offset:128 sc1
    global_store_dword v7, v123, s[6:7] offset:192 sc1
    global_store_dword v7, v127, s[6:7] offset:256 sc1
    global_store_dword v7, v131, s[6:7] offset:320 sc1
    global_store_dword v7, v135, s[6:7] offset:384 sc1
    s_lshl_b32 s23, s9, 2
    s_add_u32 s23, s23, 0x8200
    s_waitcnt vmcnt(0)
    s_barrier
    s_cmp_lg_u32 s8, 0
    s_cbranch_scc1 .sg_63
    s_mov_b64 exec, 1
    v_mov_b32 v4, s23
    v_mov_b32 v5, 1
    global_atomic_add v4, v5, s[6:7]
    s_mov_b64 exec, -1
.sg_63:
    v_accvgpr_read_b32 v208, a168
    v_accvgpr_read_b32 v209, a169
    v_accvgpr_read_b32 v210, a170
    v_accvgpr_read_b32 v211, a171
    v_accvgpr_read_b32 v212, a172
    v_accvgpr_read_b32 v213, a173
    v_accvgpr_read_b32 v214, a174
    v_accvgpr_read_b32 v215, a175
    v_accvgpr_read_b32 v216, a176
    v_accvgpr_read_b32 v217, a177
    v_accvgpr_read_b32 v218, a178
    v_accvgpr_read_b32 v219, a179
    v_accvgpr_read_b32 v220, a180
    v_accvgpr_read_b32 v221, a181
    v_accvgpr_read_b32 v222, a182
    v_accvgpr_read_b32 v223, a183
    v_accvgpr_read_b32 v224, a184
    v_accvgpr_read_b32 v225, a185
    v_accvgpr_read_b32 v226, a186
    v_accvgpr_read_b32 v227, a187
    v_accvgpr_read_b32 v228, a188
    v_accvgpr_read_b32 v229, a189
    v_accvgpr_read_b32 v230, a190
    v_accvgpr_read_b32 v231, a191
    v_accvgpr_read_b32 v232, a192
    v_accvgpr_read_b32 v233, a193
    v_accvgpr_read_b32 v234, a194
    v_accvgpr_read_b32 v235, a195
    v_accvgpr_read_b32 v236, a196
    v_accvgpr_read_b32 v237, a197
    v_accvgpr_read_b32 v238, a198
    v_accvgpr_read_b32 v239, a199
    s_cmp_lg_u32 s8, 0
    s_cbranch_scc1 .wf_64
    v_mov_b32 v4, s23
.wf_65:
    global_load_dword v8, v4, s[6:7] sc1
    s_sub_u32 s12, s12, 1
    s_cmp_eq_u32 s12, 0
    s_cbranch_scc1 .mg_end_12
    s_waitcnt vmcnt(0)
    v_readfirstlane_b32 s13, v8
    s_nop 3
    s_cmp_lt_u32 s13, 4
    s_cbranch_scc1 .wf_66
    s_branch .wf_67
.wf_66:
    s_sleep 8
    s_branch .wf_65
.wf_67:
.wf_64:
    s_barrier
    v_cmp_gt_u32 s[22:23], 56, v1
    s_mul_i32 s14, s26, 1792
    s_add_u32 s14, s14, 0x3400000
    v_add_u32 v7, s14, v245
    global_load_dwordx4 v[40:43], v7, s[6:7] offset:0 sc1
    global_load_dwordx4 v[44:47], v7, s[6:7] offset:16 sc1
    global_load_dwordx4 v[72:75], v7, s[6:7] offset:1792 sc1
    global_load_dwordx4 v[76:79], v7, s[6:7] offset:1808 sc1
    v_add_u32 v7, 0x380000, v7
    global_load_dwordx4 v[48:51], v7, s[6:7] offset:0 sc1
    global_load_dwordx4 v[52:55], v7, s[6:7] offset:16 sc1
    global_load_dwordx4 v[80:83], v7, s[6:7] offset:1792 sc1
    global_load_dwordx4 v[84:87], v7, s[6:7] offset:1808 sc1
    v_add_u32 v7, 0x380000, v7
    global_load_dwordx4 v[56:59], v7, s[6:7] offset:0 sc1
    global_load_dwordx4 v[60:63], v7, s[6:7] offset:16 sc1
    global_load_dwordx4 v[88:91], v7, s[6:7] offset:1792 sc1
    global_load_dwordx4 v[92:95], v7, s[6:7] offset:1808 sc1
    v_add_u32 v7, 0x380000, v7
    global_load_dwordx4 v[64:67], v7, s[6:7] offset:0 sc1
    global_load_dwordx4 v[68:71], v7, s[6:7] offset:16 sc1
    global_load_dwordx4 v[96:99], v7, s[6:7] offset:1792 sc1
    global_load_dwordx4 v[100:103], v7, s[6:7] offset:1808 sc1
    v_lshlrev_b32 v104, 16, v232
    v_and_b32 v105, 0xffff0000, v232
    v_lshlrev_b32 v106, 16, v233
    v_and_b32 v107, 0xffff0000, v233
    v_lshlrev_b32 v108, 16, v234
    v_and_b32 v109, 0xffff0000, v234
    v_lshlrev_b32 v110, 16, v235
    v_and_b32 v111, 0xffff0000, v235
    v_lshlrev_b32 v112, 16, v236
    v_and_b32 v113, 0xffff0000, v236
    v_lshlrev_b32 v114, 16, v237
    v_and_b32 v115, 0xffff0000, v237
    v_lshlrev_b32 v116, 16, v238
    v_and_b32 v117, 0xffff0000, v238
    v_lshlrev_b32 v118, 16, v239
    v_and_b32 v119, 0xffff0000, v239
    s_waitcnt vmcnt(0)
    v_pk_add_f32 v[40:41], v[40:41], v[48:49]
    v_pk_add_f32 v[56:57], v[56:57], v[64:65]
    v_pk_add_f32 v[42:43], v[42:43], v[50:51]
    v_pk_add_f32 v[58:59], v[58:59], v[66:67]
    v_pk_add_f32 v[44:45], v[44:45], v[52:53]
    v_pk_add_f32 v[60:61], v[60:61], v[68:69]
    v_pk_add_f32 v[46:47], v[46:47], v[54:55]
    v_pk_add_f32 v[62:63], v[62:63], v[70:71]
    v_pk_add_f32 v[40:41], v[40:41], v[56:57]
    v_pk_add_f32 v[42:43], v[42:43], v[58:59]
    v_pk_add_f32 v[44:45], v[44:45], v[60:61]
    v_pk_add_f32 v[46:47], v[46:47], v[62:63]
    v_fma_f32 v48, v208, v40, v104
    v_fma_f32 v49, v209, v41, v105
    v_fma_f32 v50, v210, v42, v106
    v_fma_f32 v51, v211, v43, v107
    v_fma_f32 v52, v212, v44, v108
    v_fma_f32 v53, v213, v45, v109
    v_fma_f32 v54, v214, v46, v110
    v_fma_f32 v55, v215, v47, v111
    v_cvt_pk_bf16_f32 v56, v48, v49
    v_cvt_pk_bf16_f32 v57, v50, v51
    v_cvt_pk_bf16_f32 v58, v52, v53
    v_cvt_pk_bf16_f32 v59, v54, v55
    v_lshlrev_b32 v48, 16, v56
    v_and_b32 v49, 0xffff0000, v56
    v_lshlrev_b32 v50, 16, v57
    v_and_b32 v51, 0xffff0000, v57
    v_lshlrev_b32 v52, 16, v58
    v_and_b32 v53, 0xffff0000, v58
    v_lshlrev_b32 v54, 16, v59
    v_and_b32 v55, 0xffff0000, v59
    s_add_u32 s13, s26, 0
    s_mul_i32 s14, s13, 896
    s_add_u32 s14, s14, 0x1a00000
    v_lshl_add_u32 v5, v244, 4, s14
    s_mov_b64 exec, s[22:23]
    global_store_dwordx4 v5, v[56:59], s[6:7] sc1
    s_mov_b64 exec, -1
    v_add_f32 v40, v48, v49
    v_add_f32 v40, v40, v50
    v_add_f32 v40, v40, v51
    v_add_f32 v40, v40, v52
    v_add_f32 v40, v40, v53
    v_add_f32 v40, v40, v54
    v_add_f32 v40, v40, v55
    v_cndmask_b32 v40, 0, v40, s[22:23]
    v_pk_add_f32 v[72:73], v[72:73], v[80:81]
    v_pk_add_f32 v[88:89], v[88:89], v[96:97]
    v_pk_add_f32 v[74:75], v[74:75], v[82:83]
    v_pk_add_f32 v[90:91], v[90:91], v[98:99]
    v_pk_add_f32 v[76:77], v[76:77], v[84:85]
    v_pk_add_f32 v[92:93], v[92:93], v[100:101]
    v_pk_add_f32 v[78:79], v[78:79], v[86:87]
    v_pk_add_f32 v[94:95], v[94:95], v[102:103]
    v_pk_add_f32 v[72:73], v[72:73], v[88:89]
    v_pk_add_f32 v[74:75], v[74:75], v[90:91]
    v_pk_add_f32 v[76:77], v[76:77], v[92:93]
    v_pk_add_f32 v[78:79], v[78:79], v[94:95]
    v_fma_f32 v80, v208, v72, v112
    v_fma_f32 v81, v209, v73, v113
    v_fma_f32 v82, v210, v74, v114
    v_fma_f32 v83, v211, v75, v115
    v_fma_f32 v84, v212, v76, v116
    v_fma_f32 v85, v213, v77, v117
    v_fma_f32 v86, v214, v78, v118
    v_fma_f32 v87, v215, v79, v119
    v_cvt_pk_bf16_f32 v88, v80, v81
    v_cvt_pk_bf16_f32 v89, v82, v83
    v_cvt_pk_bf16_f32 v90, v84, v85
    v_cvt_pk_bf16_f32 v91, v86, v87
    v_lshlrev_b32 v80, 16, v88
    v_and_b32 v81, 0xffff0000, v88
    v_lshlrev_b32 v82, 16, v89
    v_and_b32 v83, 0xffff0000, v89
    v_lshlrev_b32 v84, 16, v90
    v_and_b32 v85, 0xffff0000, v90
    v_lshlrev_b32 v86, 16, v91
    v_and_b32 v87, 0xffff0000, v91
    s_add_u32 s13, s26, 1
    s_mul_i32 s14, s13, 896
    s_add_u32 s14, s14, 0x1a00000
    v_lshl_add_u32 v5, v244, 4, s14
    s_mov_b64 exec, s[22:23]
    global_store_dwordx4 v5, v[88:91], s[6:7] sc1
    s_mov_b64 exec, -1
    v_add_f32 v72, v80, v81
    v_add_f32 v72, v72, v82
    v_add_f32 v72, v72, v83
    v_add_f32 v72, v72, v84
    v_add_f32 v72, v72, v85
    v_add_f32 v72, v72, v86
    v_add_f32 v72, v72, v87
    v_cndmask_b32 v72, 0, v72, s[22:23]
    s_nop 1
    v_add_f32_dpp v41, v40, v40 row_ror:1 row_mask:0xf bank_mask:0xf
    v_add_f32_dpp v73, v72, v72 row_ror:1 row_mask:0xf bank_mask:0xf
    v_mov_b32 v40, v41
    v_mov_b32 v72, v73
    s_nop 1
    v_add_f32_dpp v41, v40, v40 row_ror:2 row_mask:0xf bank_mask:0xf
    v_add_f32_dpp v73, v72, v72 row_ror:2 row_mask:0xf bank_mask:0xf
    v_mov_b32 v40, v41
    v_mov_b32 v72, v73
    s_nop 1
    v_add_f32_dpp v41, v40, v40 row_ror:4 row_mask:0xf bank_mask:0xf
    v_add_f32_dpp v73, v72, v72 row_ror:4 row_mask:0xf bank_mask:0xf
    v_mov_b32 v40, v41
    v_mov_b32 v72, v73
    s_nop 1
    v_add_f32_dpp v41, v40, v40 row_ror:8 row_mask:0xf bank_mask:0xf
    v_add_f32_dpp v73, v72, v72 row_ror:8 row_mask:0xf bank_mask:0xf
    v_mov_b32 v40, v41
    v_mov_b32 v72, v73
    v_mov_b32 v41, v40
    s_nop 1
    v_permlane32_swap_b32 v40, v41
    s_nop 1
    v_add_f32 v40, v40, v41
    v_mov_b32 v41, v40
    s_nop 1
    v_permlane16_swap_b32 v40, v41
    s_nop 1
    v_add_f32 v40, v40, v41
    v_mov_b32 v73, v72
    s_nop 1
    v_permlane32_swap_b32 v72, v73
    s_nop 1
    v_add_f32 v72, v72, v73
    v_mov_b32 v73, v72
    s_nop 1
    v_permlane16_swap_b32 v72, v73
    s_nop 1
    v_add_f32 v72, v72, v73
    v_mul_f32 v40, 0x3b124925, v40
    v_sub_f32 v48, v48, v40
    v_sub_f32 v49, v49, v40
    v_sub_f32 v50, v50, v40
    v_sub_f32 v51, v51, v40
    v_sub_f32 v52, v52, v40
    v_sub_f32 v53, v53, v40
    v_sub_f32 v54, v54, v40
    v_sub_f32 v55, v55, v40
    v_mul_f32 v42, v48, v48
    v_fmac_f32 v42, v49, v49
    v_fmac_f32 v42, v50, v50
    v_fmac_f32 v42, v51, v51
    v_fmac_f32 v42, v52, v52
    v_fmac_f32 v42, v53, v53
    v_fmac_f32 v42, v54, v54
    v_fmac_f32 v42, v55, v55
    v_cndmask_b32 v42, 0, v42, s[22:23]
    v_mul_f32 v72, 0x3b124925, v72
    v_sub_f32 v80, v80, v72
    v_sub_f32 v81, v81, v72
    v_sub_f32 v82, v82, v72
    v_sub_f32 v83, v83, v72
    v_sub_f32 v84, v84, v72
    v_sub_f32 v85, v85, v72
    v_sub_f32 v86, v86, v72
    v_sub_f32 v87, v87, v72
    v_mul_f32 v74, v80, v80
    v_fmac_f32 v74, v81, v81
    v_fmac_f32 v74, v82, v82
    v_fmac_f32 v74, v83, v83
    v_fmac_f32 v74, v84, v84
    v_fmac_f32 v74, v85, v85
    v_fmac_f32 v74, v86, v86
    v_fmac_f32 v74, v87, v87
    v_cndmask_b32 v74, 0, v74, s[22:23]
    s_nop 1
    v_add_f32_dpp v41, v42, v42 row_ror:1 row_mask:0xf bank_mask:0xf
    v_add_f32_dpp v73, v74, v74 row_ror:1 row_mask:0xf bank_mask:0xf
    v_mov_b32 v42, v41
    v_mov_b32 v74, v73
    s_nop 1
    v_add_f32_dpp v41, v42, v42 row_ror:2 row_mask:0xf bank_mask:0xf
    v_add_f32_dpp v73, v74, v74 row_ror:2 row_mask:0xf bank_mask:0xf
    v_mov_b32 v42, v41
    v_mov_b32 v74, v73
    s_nop 1
    v_add_f32_dpp v41, v42, v42 row_ror:4 row_mask:0xf bank_mask:0xf
    v_add_f32_dpp v73, v74, v74 row_ror:4 row_mask:0xf bank_mask:0xf
    v_mov_b32 v42, v41
    v_mov_b32 v74, v73
    s_nop 1
    v_add_f32_dpp v41, v42, v42 row_ror:8 row_mask:0xf bank_mask:0xf
    v_add_f32_dpp v73, v74, v74 row_ror:8 row_mask:0xf bank_mask:0xf
    v_mov_b32 v42, v41
    v_mov_b32 v74, v73
    v_mov_b32 v41, v42
    s_nop 1
    v_permlane32_swap_b32 v42, v41
    s_nop 1
    v_add_f32 v42, v42, v41
    v_mov_b32 v41, v42
    s_nop 1
    v_permlane16_swap_b32 v42, v41
    s_nop 1
    v_add_f32 v42, v42, v41
    v_mov_b32 v73, v74
    s_nop 1
    v_permlane32_swap_b32 v74, v73
    s_nop 1
    v_add_f32 v74, v74, v73
    v_mov_b32 v73, v74
    s_nop 1
    v_permlane16_swap_b32 v74, v73
    s_nop 1
    v_add_f32 v74, v74, v73
    v_mov_b32 v41, 0x3727c5ac
    v_fmac_f32 v41, 0x3b124925, v42
    v_rsq_f32 v41, v41
    s_nop 0
    v_mul_f32 v48, v48, v41
    v_fma_f32 v48, v48, v224, v216
    v_mul_f32 v49, v49, v41
    v_fma_f32 v49, v49, v225, v217
    v_mul_f32 v50, v50, v41
    v_fma_f32 v50, v50, v226, v218
    v_mul_f32 v51, v51, v41
    v_fma_f32 v51, v51, v227, v219
    v_mul_f32 v52, v52, v41
    v_fma_f32 v52, v52, v228, v220
    v_mul_f32 v53, v53, v41
    v_fma_f32 v53, v53, v229, v221
    v_mul_f32 v54, v54, v41
    v_fma_f32 v54, v54, v230, v222
    v_mul_f32 v55, v55, v41
    v_fma_f32 v55, v55, v231, v223
    v_cvt_pk_bf16_f32 v44, v48, v49
    v_cvt_pk_bf16_f32 v45, v50, v51
    v_cvt_pk_bf16_f32 v46, v52, v53
    v_cvt_pk_bf16_f32 v47, v54, v55
    s_add_u32 s13, s26, 0
    s_lshr_b32 s14, s13, 4
    s_and_b32 s13, s13, 15
    s_mul_i32 s14, s14, 14336
    s_lshl_b32 s13, s13, 4
    s_add_u32 s14, s14, s13
    s_add_u32 s14, s14, 0x1800000
    v_lshl_add_u32 v5, v244, 8, s14
    s_mov_b64 exec, s[22:23]
    global_store_dwordx4 v5, v[44:47], s[6:7] sc1
    s_mov_b64 exec, -1
    v_mov_b32 v73, 0x3727c5ac
    v_fmac_f32 v73, 0x3b124925, v74
    v_rsq_f32 v73, v73
    s_nop 0
    v_mul_f32 v80, v80, v73
    v_fma_f32 v80, v80, v224, v216
    v_mul_f32 v81, v81, v73
    v_fma_f32 v81, v81, v225, v217
    v_mul_f32 v82, v82, v73
    v_fma_f32 v82, v82, v226, v218
    v_mul_f32 v83, v83, v73
    v_fma_f32 v83, v83, v227, v219
    v_mul_f32 v84, v84, v73
    v_fma_f32 v84, v84, v228, v220
    v_mul_f32 v85, v85, v73
    v_fma_f32 v85, v85, v229, v221
    v_mul_f32 v86, v86, v73
    v_fma_f32 v86, v86, v230, v222
    v_mul_f32 v87, v87, v73
    v_fma_f32 v87, v87, v231, v223
    v_cvt_pk_bf16_f32 v76, v80, v81
    v_cvt_pk_bf16_f32 v77, v82, v83
    v_cvt_pk_bf16_f32 v78, v84, v85
    v_cvt_pk_bf16_f32 v79, v86, v87
    s_add_u32 s13, s26, 1
    s_lshr_b32 s14, s13, 4
    s_and_b32 s13, s13, 15
    s_mul_i32 s14, s14, 14336
    s_lshl_b32 s13, s13, 4
    s_add_u32 s14, s14, s13
    s_add_u32 s14, s14, 0x1800000
    v_lshl_add_u32 v5, v244, 8, s14
    s_mov_b64 exec, s[22:23]
    global_store_dwordx4 v5, v[76:79], s[6:7] sc1
    s_mov_b64 exec, -1
    s_lshl_b32 s23, s9, 2
    s_add_u32 s23, s23, 0x8300
    s_waitcnt vmcnt(0)
    s_barrier
    s_cmp_lg_u32 s8, 0
    s_cbranch_scc1 .sg_68
    s_mov_b64 exec, 1
    v_mov_b32 v4, s23
    v_mov_b32 v5, 1
    global_atomic_add v4, v5, s[6:7]
    s_mov_b64 exec, -1
.sg_68:
    s_branch .wk_loop_41
.wk_45:
    s_sub_u32 s10, s22, 4
    s_lshl_b32 s10, s10, 2
    s_add_u32 s10, s10, s8
    v_lshlrev_b32 v14, 4, v1
    s_mul_i32 s11, s10, 57344
    s_add_u32 s11, s11, 0x1400000
    v_add_u32 v15, s11, v14
    global_load_dwordx4 a[0:3], v15, s[6:7] offset:0
    global_load_dwordx4 a[4:7], v15, s[6:7] offset:1024
    global_load_dwordx4 a[8:11], v15, s[6:7] offset:2048
    global_load_dwordx4 a[12:15], v15, s[6:7] offset:3072
    v_add_u32 v15, 4096, v15
    global_load_dwordx4 a[16:19], v15, s[6:7] offset:0
    global_load_dwordx4 a[20:23], v15, s[6:7] offset:1024
    global_load_dwordx4 a[24:27], v15, s[6:7] offset:2048
    global_load_dwordx4 a[28:31], v15, s[6:7] offset:3072
    v_add_u32 v15, 4096, v15
    global_load_dwordx4 a[32:35], v15, s[6:7] offset:0
    global_load_dwordx4 a[36:39], v15, s[6:7] offset:1024
    global_load_dwordx4 a[40:43], v15, s[6:7] offset:2048
    global_load_dwordx4 a[44:47], v15, s[6:7] offset:3072
    v_add_u32 v15, 4096, v15
    global_load_dwordx4 a[48:51], v15, s[6:7] offset:0
    global_load_dwordx4 a[52:55], v15, s[6:7] offset:1024
    global_load_dwordx4 a[56:59], v15, s[6:7] offset:2048
    global_load_dwordx4 a[60:63], v15, s[6:7] offset:3072
    v_add_u32 v15, 4096, v15
    global_load_dwordx4 a[64:67], v15, s[6:7] offset:0
    global_load_dwordx4 a[68:71], v15, s[6:7] offset:1024
    global_load_dwordx4 a[72:75], v15, s[6:7] offset:2048
    global_load_dwordx4 a[76:79], v15, s[6:7] offset:3072
    v_add_u32 v15, 4096, v15
    global_load_dwordx4 a[80:83], v15, s[6:7] offset:0
    global_load_dwordx4 a[84:87], v15, s[6:7] offset:1024
    global_load_dwordx4 a[88:91], v15, s[6:7] offset:2048
    global_load_dwordx4 a[92:95], v15, s[6:7] offset:3072
    v_add_u32 v15, 4096, v15
    global_load_dwordx4 a[96:99], v15, s[6:7] offset:0
    global_load_dwordx4 a[100:103], v15, s[6:7] offset:1024
    global_load_dwordx4 a[104:107], v15, s[6:7] offset:2048
    global_load_dwordx4 a[108:111], v15, s[6:7] offset:3072
    v_add_u32 v15, 4096, v15
    global_load_dwordx4 a[112:115], v15, s[6:7] offset:0
    global_load_dwordx4 a[116:119], v15, s[6:7] offset:1024
    global_load_dwordx4 a[120:123], v15, s[6:7] offset:2048
    global_load_dwordx4 a[124:127], v15, s[6:7] offset:3072
    v_add_u32 v15, 4096, v15
    global_load_dwordx4 a[128:131], v15, s[6:7] offset:0
    global_load_dwordx4 a[132:135], v15, s[6:7] offset:1024
    global_load_dwordx4 a[136:139], v15, s[6:7] offset:2048
    global_load_dwordx4 a[140:143], v15, s[6:7] offset:3072
    v_add_u32 v15, 4096, v15
    global_load_dwordx4 a[144:147], v15, s[6:7] offset:0
    global_load_dwordx4 a[148:151], v15, s[6:7] offset:1024
    global_load_dwordx4 a[152:155], v15, s[6:7] offset:2048
    global_load_dwordx4 a[156:159], v15, s[6:7] offset:3072
    v_add_u32 v15, 4096, v15
    global_load_dwordx4 a[160:163], v15, s[6:7] offset:0
    global_load_dwordx4 a[164:167], v15, s[6:7] offset:1024
    global_load_dwordx4 a[168:171], v15, s[6:7] offset:2048
    global_load_dwordx4 a[172:175], v15, s[6:7] offset:3072
    v_add_u32 v15, 4096, v15
    global_load_dwordx4 a[176:179], v15, s[6:7] offset:0
    global_load_dwordx4 a[180:183], v15, s[6:7] offset:1024
    global_load_dwordx4 a[184:187], v15, s[6:7] offset:2048
    global_load_dwordx4 a[188:191], v15, s[6:7] offset:3072
    v_add_u32 v15, 4096, v15
    global_load_dwordx4 a[192:195], v15, s[6:7] offset:0
    global_load_dwordx4 a[196:199], v15, s[6:7] offset:1024
    global_load_dwordx4 a[200:203], v15, s[6:7] offset:2048
    global_load_dwordx4 a[204:207], v15, s[6:7] offset:3072
    v_add_u32 v15, 4096, v15
    global_load_dwordx4 a[208:211], v15, s[6:7] offset:0
    global_load_dwordx4 a[212:215], v15, s[6:7] offset:1024
    global_load_dwordx4 a[216:219], v15, s[6:7] offset:2048
    global_load_dwordx4 a[220:223], v15, s[6:7] offset:3072
    v_add_u32 v15, 4096, v15
    s_lshl_b32 s11, s10, 7
    v_lshlrev_b32 v5, 3, v3
    v_add_u32 v5, s11, v5
    global_load_dwordx2 v[240:241], v5, s[32:33] offset:0
    global_load_dwordx2 v[242:243], v5, s[32:33] offset:32
    global_load_dwordx2 v[244:245], v5, s[32:33] offset:64
    global_load_dwordx2 v[246:247], v5, s[32:33] offset:96
    s_lshl_b32 s23, s9, 2
    s_add_u32 s23, s23, 0x8300
    s_waitcnt vmcnt(0)
    s_cmp_lg_u32 s8, 0
    s_cbranch_scc1 .wf_69
    v_mov_b32 v4, s23
.wf_70:
    global_load_dword v8, v4, s[6:7] sc1
    s_sub_u32 s12, s12, 1
    s_cmp_eq_u32 s12, 0
    s_cbranch_scc1 .mg_end_12
    s_waitcnt vmcnt(0)
    v_readfirstlane_b32 s13, v8
    s_nop 3
    s_cmp_lt_u32 s13, 4
    s_cbranch_scc1 .wf_71
    s_branch .wf_72
.wf_71:
    s_sleep 8
    s_branch .wf_70
.wf_72:
.wf_69:
    s_barrier
    s_mul_i32 s14, s9, 28672
    s_add_u32 s14, s14, 0x1800000
    v_add_u32 v10, s14, v14
    s_add_u32 s14, s14, 14336
    v_add_u32 v11, s14, v14
    s_add_u32 s14, s14, 14336
    global_load_dwordx4 v[80:83], v10, s[6:7] offset:0 sc1
    global_load_dwordx4 v[84:87], v11, s[6:7] offset:0 sc1
    global_load_dwordx4 v[88:91], v10, s[6:7] offset:1024 sc1
    global_load_dwordx4 v[92:95], v11, s[6:7] offset:1024 sc1
    global_load_dwordx4 v[96:99], v10, s[6:7] offset:2048 sc1
    global_load_dwordx4 v[100:103], v11, s[6:7] offset:2048 sc1
    global_load_dwordx4 v[104:107], v10, s[6:7] offset:3072 sc1
    global_load_dwordx4 v[108:111], v11, s[6:7] offset:3072 sc1
    v_add_u32 v10, 4096, v10
    v_add_u32 v11, 4096, v11
    global_load_dwordx4 v[112:115], v10, s[6:7] offset:0 sc1
    global_load_dwordx4 v[116:119], v11, s[6:7] offset:0 sc1
    global_load_dwordx4 v[120:123], v10, s[6:7] offset:1024 sc1
    global_load_dwordx4 v[124:127], v11, s[6:7] offset:1024 sc1
    global_load_dwordx4 v[128:131], v10, s[6:7] offset:2048 sc1
    global_load_dwordx4 v[132:135], v11, s[6:7] offset:2048 sc1
    global_load_dwordx4 v[136:139], v10, s[6:7] offset:3072 sc1
    global_load_dwordx4 v[140:143], v11, s[6:7] offset:3072 sc1
    v_add_u32 v10, 4096, v10
    v_add_u32 v11, 4096, v11
    global_load_dwordx4 v[144:147], v10, s[6:7] offset:0 sc1
    global_load_dwordx4 v[148:151], v11, s[6:7] offset:0 sc1
    global_load_dwordx4 v[152:155], v10, s[6:7] offset:1024 sc1
    global_load_dwordx4 v[156:159], v11, s[6:7] offset:1024 sc1
    global_load_dwordx4 v[160:163], v10, s[6:7] offset:2048 sc1
    global_load_dwordx4 v[164:167], v11, s[6:7] offset:2048 sc1
    global_load_dwordx4 v[168:171], v10, s[6:7] offset:3072 sc1
    global_load_dwordx4 v[172:175], v11, s[6:7] offset:3072 sc1
    v_add_u32 v10, 4096, v10
    v_add_u32 v11, 4096, v11
    global_load_dwordx4 v[176:179], v10, s[6:7] offset:0 sc1
    global_load_dwordx4 v[180:183], v11, s[6:7] offset:0 sc1
    global_load_dwordx4 v[184:187], v10, s[6:7] offset:1024 sc1
    global_load_dwordx4 v[188:191], v11, s[6:7] offset:1024 sc1
    s_waitcnt vmcnt(26)
    v_mfma_f32_16x16x32_bf16 v[16:19], a[0:3], v[80:83], 0
    v_mfma_f32_16x16x32_bf16 v[20:23], a[0:3], v[84:87], 0
    v_mfma_f32_16x16x32_bf16 v[32:35], a[56:59], v[80:83], 0
    v_mfma_f32_16x16x32_bf16 v[36:39], a[56:59], v[84:87], 0
    v_mfma_f32_16x16x32_bf16 v[48:51], a[112:115], v[80:83], 0
    v_mfma_f32_16x16x32_bf16 v[52:55], a[112:115], v[84:87], 0
    v_mfma_f32_16x16x32_bf16 v[64:67], a[168:171], v[80:83], 0
    v_mfma_f32_16x16x32_bf16 v[68:71], a[168:171], v[84:87], 0
    s_waitcnt vmcnt(24)
    v_mfma_f32_16x16x32_bf16 v[16:19], a[4:7], v[88:91], v[16:19]
    v_mfma_f32_16x16x32_bf16 v[20:23], a[4:7], v[92:95], v[20:23]
    v_mfma_f32_16x16x32_bf16 v[32:35], a[60:63], v[88:91], v[32:35]
    v_mfma_f32_16x16x32_bf16 v[36:39], a[60:63], v[92:95], v[36:39]
    v_mfma_f32_16x16x32_bf16 v[48:51], a[116:119], v[88:91], v[48:51]
    v_mfma_f32_16x16x32_bf16 v[52:55], a[116:119], v[92:95], v[52:55]
    v_mfma_f32_16x16x32_bf16 v[64:67], a[172:175], v[88:91], v[64:67]
    v_mfma_f32_16x16x32_bf16 v[68:71], a[172:175], v[92:95], v[68:71]
    s_waitcnt vmcnt(22)
    v_mfma_f32_16x16x32_bf16 v[16:19], a[8:11], v[96:99], v[16:19]
    v_mfma_f32_16x16x32_bf16 v[20:23], a[8:11], v[100:103], v[20:23]
    v_mfma_f32_16x16x32_bf16 v[32:35], a[64:67], v[96:99], v[32:35]
    v_mfma_f32_16x16x32_bf16 v[36:39], a[64:67], v[100:103], v[36:39]
    v_mfma_f32_16x16x32_bf16 v[48:51], a[120:123], v[96:99], v[48:51]
    v_mfma_f32_16x16x32_bf16 v[52:55], a[120:123], v[100:103], v[52:55]
    v_mfma_f32_16x16x32_bf16 v[64:67], a[176:179], v[96:99], v[64:67]
    v_mfma_f32_16x16x32_bf16 v[68:71], a[176:179], v[100:103], v[68:71]
    s_waitcnt vmcnt(20)
    v_mfma_f32_16x16x32_bf16 v[16:19], a[12:15], v[104:107], v[16:19]
    v_mfma_f32_16x16x32_bf16 v[20:23], a[12:15], v[108:111], v[20:23]
    v_mfma_f32_16x16x32_bf16 v[32:35], a[68:71], v[104:107], v[32:35]
    v_mfma_f32_16x16x32_bf16 v[36:39], a[68:71], v[108:111], v[36:39]
    v_mfma_f32_16x16x32_bf16 v[48:51], a[124:127], v[104:107], v[48:51]
    v_mfma_f32_16x16x32_bf16 v[52:55], a[124:127], v[108:111], v[52:55]
    v_mfma_f32_16x16x32_bf16 v[64:67], a[180:183], v[104:107], v[64:67]
    v_mfma_f32_16x16x32_bf16 v[68:71], a[180:183], v[108:111], v[68:71]
    s_waitcnt vmcnt(18)
    v_mfma_f32_16x16x32_bf16 v[16:19], a[16:19], v[112:115], v[16:19]
    v_mfma_f32_16x16x32_bf16 v[20:23], a[16:19], v[116:119], v[20:23]
    v_mfma_f32_16x16x32_bf16 v[32:35], a[72:75], v[112:115], v[32:35]
    v_mfma_f32_16x16x32_bf16 v[36:39], a[72:75], v[116:119], v[36:39]
    v_mfma_f32_16x16x32_bf16 v[48:51], a[128:131], v[112:115], v[48:51]
    v_mfma_f32_16x16x32_bf16 v[52:55], a[128:131], v[116:119], v[52:55]
    v_mfma_f32_16x16x32_bf16 v[64:67], a[184:187], v[112:115], v[64:67]
    v_mfma_f32_16x16x32_bf16 v[68:71], a[184:187], v[116:119], v[68:71]
    s_waitcnt vmcnt(16)
    v_mfma_f32_16x16x32_bf16 v[16:19], a[20:23], v[120:123], v[16:19]
    v_mfma_f32_16x16x32_bf16 v[20:23], a[20:23], v[124:127], v[20:23]
    v_mfma_f32_16x16x32_bf16 v[32:35], a[76:79], v[120:123], v[32:35]
    v_mfma_f32_16x16x32_bf16 v[36:39], a[76:79], v[124:127], v[36:39]
    v_mfma_f32_16x16x32_bf16 v[48:51], a[132:135], v[120:123], v[48:51]
    v_mfma_f32_16x16x32_bf16 v[52:55], a[132:135], v[124:127], v[52:55]
    v_mfma_f32_16x16x32_bf16 v[64:67], a[188:191], v[120:123], v[64:67]
    v_mfma_f32_16x16x32_bf16 v[68:71], a[188:191], v[124:127], v[68:71]
    s_waitcnt vmcnt(14)
    v_mfma_f32_16x16x32_bf16 v[16:19], a[24:27], v[128:131], v[16:19]
    v_mfma_f32_16x16x32_bf16 v[20:23], a[24:27], v[132:135], v[20:23]
    v_mfma_f32_16x16x32_bf16 v[32:35], a[80:83], v[128:131], v[32:35]
    v_mfma_f32_16x16x32_bf16 v[36:39], a[80:83], v[132:135], v[36:39]
    v_mfma_f32_16x16x32_bf16 v[48:51], a[136:139], v[128:131], v[48:51]
    v_mfma_f32_16x16x32_bf16 v[52:55], a[136:139], v[132:135], v[52:55]
    v_mfma_f32_16x16x32_bf16 v[64:67], a[192:195], v[128:131], v[64:67]
    v_mfma_f32_16x16x32_bf16 v[68:71], a[192:195], v[132:135], v[68:71]
    s_waitcnt vmcnt(12)
    v_mfma_f32_16x16x32_bf16 v[16:19], a[28:31], v[136:139], v[16:19]
    v_mfma_f32_16x16x32_bf16 v[20:23], a[28:31], v[140:143], v[20:23]
    v_mfma_f32_16x16x32_bf16 v[32:35], a[84:87], v[136:139], v[32:35]
    v_mfma_f32_16x16x32_bf16 v[36:39], a[84:87], v[140:143], v[36:39]
    v_mfma_f32_16x16x32_bf16 v[48:51], a[140:143], v[136:139], v[48:51]
    v_mfma_f32_16x16x32_bf16 v[52:55], a[140:143], v[140:143], v[52:55]
    v_mfma_f32_16x16x32_bf16 v[64:67], a[196:199], v[136:139], v[64:67]
    v_mfma_f32_16x16x32_bf16 v[68:71], a[196:199], v[140:143], v[68:71]
    s_waitcnt vmcnt(10)
    v_mfma_f32_16x16x32_bf16 v[16:19], a[32:35], v[144:147], v[16:19]
    v_mfma_f32_16x16x32_bf16 v[20:23], a[32:35], v[148:151], v[20:23]
    v_mfma_f32_16x16x32_bf16 v[32:35], a[88:91], v[144:147], v[32:35]
    v_mfma_f32_16x16x32_bf16 v[36:39], a[88:91], v[148:151], v[36:39]
    v_mfma_f32_16x16x32_bf16 v[48:51], a[144:147], v[144:147], v[48:51]
    v_mfma_f32_16x16x32_bf16 v[52:55], a[144:147], v[148:151], v[52:55]
    v_mfma_f32_16x16x32_bf16 v[64:67], a[200:203], v[144:147], v[64:67]
    v_mfma_f32_16x16x32_bf16 v[68:71], a[200:203], v[148:151], v[68:71]
    s_waitcnt vmcnt(8)
    v_mfma_f32_16x16x32_bf16 v[16:19], a[36:39], v[152:155], v[16:19]
    v_mfma_f32_16x16x32_bf16 v[20:23], a[36:39], v[156:159], v[20:23]
    v_mfma_f32_16x16x32_bf16 v[32:35], a[92:95], v[152:155], v[32:35]
    v_mfma_f32_16x16x32_bf16 v[36:39], a[92:95], v[156:159], v[36:39]
    v_mfma_f32_16x16x32_bf16 v[48:51], a[148:151], v[152:155], v[48:51]
    v_mfma_f32_16x16x32_bf16 v[52:55], a[148:151], v[156:159], v[52:55]
    v_mfma_f32_16x16x32_bf16 v[64:67], a[204:207], v[152:155], v[64:67]
    v_mfma_f32_16x16x32_bf16 v[68:71], a[204:207], v[156:159], v[68:71]
    s_waitcnt vmcnt(6)
    v_mfma_f32_16x16x32_bf16 v[16:19], a[40:43], v[160:163], v[16:19]
    v_mfma_f32_16x16x32_bf16 v[20:23], a[40:43], v[164:167], v[20:23]
    v_mfma_f32_16x16x32_bf16 v[32:35], a[96:99], v[160:163], v[32:35]
    v_mfma_f32_16x16x32_bf16 v[36:39], a[96:99], v[164:167], v[36:39]
    v_mfma_f32_16x16x32_bf16 v[48:51], a[152:155], v[160:163], v[48:51]
    v_mfma_f32_16x16x32_bf16 v[52:55], a[152:155], v[164:167], v[52:55]
    v_mfma_f32_16x16x32_bf16 v[64:67], a[208:211], v[160:163], v[64:67]
    v_mfma_f32_16x16x32_bf16 v[68:71], a[208:211], v[164:167], v[68:71]
    s_waitcnt vmcnt(4)
    v_mfma_f32_16x16x32_bf16 v[16:19], a[44:47], v[168:171], v[16:19]
    v_mfma_f32_16x16x32_bf16 v[20:23], a[44:47], v[172:175], v[20:23]
    v_mfma_f32_16x16x32_bf16 v[32:35], a[100:103], v[168:171], v[32:35]
    v_mfma_f32_16x16x32_bf16 v[36:39], a[100:103], v[172:175], v[36:39]
    v_mfma_f32_16x16x32_bf16 v[48:51], a[156:159], v[168:171], v[48:51]
    v_mfma_f32_16x16x32_bf16 v[52:55], a[156:159], v[172:175], v[52:55]
    v_mfma_f32_16x16x32_bf16 v[64:67], a[212:215], v[168:171], v[64:67]
    v_mfma_f32_16x16x32_bf16 v[68:71], a[212:215], v[172:175], v[68:71]
    s_waitcnt vmcnt(2)
    v_mfma_f32_16x16x32_bf16 v[16:19], a[48:51], v[176:179], v[16:19]
    v_mfma_f32_16x16x32_bf16 v[20:23], a[48:51], v[180:183], v[20:23]
    v_mfma_f32_16x16x32_bf16 v[32:35], a[104:107], v[176:179], v[32:35]
    v_mfma_f32_16x16x32_bf16 v[36:39], a[104:107], v[180:183], v[36:39]
    v_mfma_f32_16x16x32_bf16 v[48:51], a[160:163], v[176:179], v[48:51]
    v_mfma_f32_16x16x32_bf16 v[52:55], a[160:163], v[180:183], v[52:55]
    v_mfma_f32_16x16x32_bf16 v[64:67], a[216:219], v[176:179], v[64:67]
    v_mfma_f32_16x16x32_bf16 v[68:71], a[216:219], v[180:183], v[68:71]
    s_waitcnt vmcnt(0)
    v_mfma_f32_16x16x32_bf16 v[16:19], a[52:55], v[184:187], v[16:19]
    v_mfma_f32_16x16x32_bf16 v[20:23], a[52:55], v[188:191], v[20:23]
    v_mfma_f32_16x16x32_bf16 v[32:35], a[108:111], v[184:187], v[32:35]
    v_mfma_f32_16x16x32_bf16 v[36:39], a[108:111], v[188:191], v[36:39]
    v_mfma_f32_16x16x32_bf16 v[48:51], a[164:167], v[184:187], v[48:51]
    v_mfma_f32_16x16x32_bf16 v[52:55], a[164:167], v[188:191], v[52:55]
    v_mfma_f32_16x16x32_bf16 v[64:67], a[220:223], v[184:187], v[64:67]
    v_mfma_f32_16x16x32_bf16 v[68:71], a[220:223], v[188:191], v[68:71]
    v_lshlrev_b32 v208, 16, v240
    v_and_b32 v209, 0xffff0000, v240
    v_lshlrev_b32 v210, 16, v241
    v_and_b32 v211, 0xffff0000, v241
    v_lshlrev_b32 v212, 16, v242
    v_and_b32 v213, 0xffff0000, v242
    v_lshlrev_b32 v214, 16, v243
    v_and_b32 v215, 0xffff0000, v243
    v_lshlrev_b32 v216, 16, v244
    v_and_b32 v217, 0xffff0000, v244
    v_lshlrev_b32 v218, 16, v245
    v_and_b32 v219, 0xffff0000, v245
    v_lshlrev_b32 v220, 16, v246
    v_and_b32 v221, 0xffff0000, v246
    v_lshlrev_b32 v222, 16, v247
    v_and_b32 v223, 0xffff0000, v247
    v_mov_b32 v6, 0xc0135761
    v_mov_b32 v7, 0xbdd2d3e8
    s_mul_i32 s11, s9, 112
    s_lshl_b32 s14, s10, 1
    s_add_u32 s11, s11, s14
    s_lshl_b32 s11, s11, 10
    s_add_u32 s11, s11, 0x1e00000
    v_add_u32 v5, s11, v14
    v_add_f32 v16, v16, v208
    v_add_f32 v17, v17, v209
    v_add_f32 v18, v18, v210
    v_add_f32 v19, v19, v211
    v_add_f32 v32, v32, v212
    v_add_f32 v33, v33, v213
    v_add_f32 v34, v34, v214
    v_add_f32 v35, v35, v215
    v_add_f32 v48, v48, v216
    v_add_f32 v49, v49, v217
    v_add_f32 v50, v50, v218
    v_add_f32 v51, v51, v219
    v_add_f32 v64, v64, v220
    v_add_f32 v65, v65, v221
    v_add_f32 v66, v66, v222
    v_add_f32 v67, v67, v223
    v_mul_f32 v224, v16, v16
    v_mul_f32 v225, v17, v17
    v_mul_f32 v226, v18, v18
    v_mul_f32 v227, v19, v19
    v_mul_f32 v228, v32, v32
    v_mul_f32 v229, v33, v33
    v_mul_f32 v230, v34, v34
    v_mul_f32 v231, v35, v35
    v_mul_f32 v232, v48, v48
    v_mul_f32 v233, v49, v49
    v_mul_f32 v234, v50, v50
    v_mul_f32 v235, v51, v51
    v_mul_f32 v236, v64, v64
    v_mul_f32 v237, v65, v65
    v_mul_f32 v238, v66, v66
    v_mul_f32 v239, v67, v67
    v_fma_f32 v224, v224, v7, v6
    v_fma_f32 v225, v225, v7, v6
    v_fma_f32 v226, v226, v7, v6
    v_fma_f32 v227, v227, v7, v6
    v_fma_f32 v228, v228, v7, v6
    v_fma_f32 v229, v229, v7, v6
    v_fma_f32 v230, v230, v7, v6
    v_fma_f32 v231, v231, v7, v6
    v_fma_f32 v232, v232, v7, v6
    v_fma_f32 v233, v233, v7, v6
    v_fma_f32 v234, v234, v7, v6
    v_fma_f32 v235, v235, v7, v6
    v_fma_f32 v236, v236, v7, v6
    v_fma_f32 v237, v237, v7, v6
    v_fma_f32 v238, v238, v7, v6
    v_fma_f32 v239, v239, v7, v6
    v_mul_f32 v224, v224, v16
    v_mul_f32 v225, v225, v17
    v_mul_f32 v226, v226, v18
    v_mul_f32 v227, v227, v19
    v_mul_f32 v228, v228, v32
    v_mul_f32 v229, v229, v33
    v_mul_f32 v230, v230, v34
    v_mul_f32 v231, v231, v35
    v_mul_f32 v232, v232, v48
    v_mul_f32 v233, v233, v49
    v_mul_f32 v234, v234, v50
    v_mul_f32 v235, v235, v51
    v_mul_f32 v236, v236, v64
    v_mul_f32 v237, v237, v65
    v_mul_f32 v238, v238, v66
    v_mul_f32 v239, v239, v67
    v_exp_f32 v224, v224
    v_exp_f32 v225, v225
    v_exp_f32 v226, v226
    v_exp_f32 v227, v227
    v_exp_f32 v228, v228
    v_exp_f32 v229, v229
    v_exp_f32 v230, v230
    v_exp_f32 v231, v231
    v_exp_f32 v232, v232
    v_exp_f32 v233, v233
    v_exp_f32 v234, v234
    v_exp_f32 v235, v235
    v_exp_f32 v236, v236
    v_exp_f32 v237, v237
    v_exp_f32 v238, v238
    v_exp_f32 v239, v239
    v_add_f32 v224, 1.0, v224
    v_add_f32 v225, 1.0, v225
    v_add_f32 v226, 1.0, v226
    v_add_f32 v227, 1.0, v227
    v_add_f32 v228, 1.0, v228
    v_add_f32 v229, 1.0, v229
    v_add_f32 v230, 1.0, v230
    v_add_f32 v231, 1.0, v231
    v_add_f32 v232, 1.0, v232
    v_add_f32 v233, 1.0, v233
    v_add_f32 v234, 1.0, v234
    v_add_f32 v235, 1.0, v235
    v_add_f32 v236, 1.0, v236
    v_add_f32 v237, 1.0, v237
    v_add_f32 v238, 1.0, v238
    v_add_f32 v239, 1.0, v239
    v_rcp_f32 v224, v224
    v_rcp_f32 v225, v225
    v_rcp_f32 v226, v226
    v_rcp_f32 v227, v227
    v_rcp_f32 v228, v228
    v_rcp_f32 v229, v229
    v_rcp_f32 v230, v230
    v_rcp_f32 v231, v231
    v_rcp_f32 v232, v232
    v_rcp_f32 v233, v233
    v_rcp_f32 v234, v234
    v_rcp_f32 v235, v235
    v_rcp_f32 v236, v236
    v_rcp_f32 v237, v237
    v_rcp_f32 v238, v238
    v_rcp_f32 v239, v239
    v_mul_f32 v16, v16, v224
    v_mul_f32 v17, v17, v225
    v_mul_f32 v18, v18, v226
    v_mul_f32 v19, v19, v227
    v_mul_f32 v32, v32, v228
    v_mul_f32 v33, v33, v229
    v_mul_f32 v34, v34, v230
    v_mul_f32 v35, v35, v231
    v_mul_f32 v48, v48, v232
    v_mul_f32 v49, v49, v233
    v_mul_f32 v50, v50, v234
    v_mul_f32 v51, v51, v235
    v_mul_f32 v64, v64, v236
    v_mul_f32 v65, v65, v237
    v_mul_f32 v66, v66, v238
    v_mul_f32 v67, v67, v239
    v_cvt_pk_bf16_f32 v80, v16, v17
    v_cvt_pk_bf16_f32 v81, v18, v19
    v_cvt_pk_bf16_f32 v82, v32, v33
    v_cvt_pk_bf16_f32 v83, v34, v35
    global_store_dwordx4 v5, v[80:83], s[6:7] offset:0 sc1
    v_cvt_pk_bf16_f32 v84, v48, v49
    v_cvt_pk_bf16_f32 v85, v50, v51
    v_cvt_pk_bf16_f32 v86, v64, v65
    v_cvt_pk_bf16_f32 v87, v66, v67
    global_store_dwordx4 v5, v[84:87], s[6:7] offset:1024 sc1
    v_add_u32 v5, 57344, v5
    v_add_f32 v20, v20, v208
    v_add_f32 v21, v21, v209
    v_add_f32 v22, v22, v210
    v_add_f32 v23, v23, v211
    v_add_f32 v36, v36, v212
    v_add_f32 v37, v37, v213
    v_add_f32 v38, v38, v214
    v_add_f32 v39, v39, v215
    v_add_f32 v52, v52, v216
    v_add_f32 v53, v53, v217
    v_add_f32 v54, v54, v218
    v_add_f32 v55, v55, v219
    v_add_f32 v68, v68, v220
    v_add_f32 v69, v69, v221
    v_add_f32 v70, v70, v222
    v_add_f32 v71, v71, v223
    v_mul_f32 v224, v20, v20
    v_mul_f32 v225, v21, v21
    v_mul_f32 v226, v22, v22
    v_mul_f32 v227, v23, v23
    v_mul_f32 v228, v36, v36
    v_mul_f32 v229, v37, v37
    v_mul_f32 v230, v38, v38
    v_mul_f32 v231, v39, v39
    v_mul_f32 v232, v52, v52
    v_mul_f32 v233, v53, v53
    v_mul_f32 v234, v54, v54
    v_mul_f32 v235, v55, v55
    v_mul_f32 v236, v68, v68
    v_mul_f32 v237, v69, v69
    v_mul_f32 v238, v70, v70
    v_mul_f32 v239, v71, v71
    v_fma_f32 v224, v224, v7, v6
    v_fma_f32 v225, v225, v7, v6
    v_fma_f32 v226, v226, v7, v6
    v_fma_f32 v227, v227, v7, v6
    v_fma_f32 v228, v228, v7, v6
    v_fma_f32 v229, v229, v7, v6
    v_fma_f32 v230, v230, v7, v6
    v_fma_f32 v231, v231, v7, v6
    v_fma_f32 v232, v232, v7, v6
    v_fma_f32 v233, v233, v7, v6
    v_fma_f32 v234, v234, v7, v6
    v_fma_f32 v235, v235, v7, v6
    v_fma_f32 v236, v236, v7, v6
    v_fma_f32 v237, v237, v7, v6
    v_fma_f32 v238, v238, v7, v6
    v_fma_f32 v239, v239, v7, v6
    v_mul_f32 v224, v224, v20
    v_mul_f32 v225, v225, v21
    v_mul_f32 v226, v226, v22
    v_mul_f32 v227, v227, v23
    v_mul_f32 v228, v228, v36
    v_mul_f32 v229, v229, v37
    v_mul_f32 v230, v230, v38
    v_mul_f32 v231, v231, v39
    v_mul_f32 v232, v232, v52
    v_mul_f32 v233, v233, v53
    v_mul_f32 v234, v234, v54
    v_mul_f32 v235, v235, v55
    v_mul_f32 v236, v236, v68
    v_mul_f32 v237, v237, v69
    v_mul_f32 v238, v238, v70
    v_mul_f32 v239, v239, v71
    v_exp_f32 v224, v224
    v_exp_f32 v225, v225
    v_exp_f32 v226, v226
    v_exp_f32 v227, v227
    v_exp_f32 v228, v228
    v_exp_f32 v229, v229
    v_exp_f32 v230, v230
    v_exp_f32 v231, v231
    v_exp_f32 v232, v232
    v_exp_f32 v233, v233
    v_exp_f32 v234, v234
    v_exp_f32 v235, v235
    v_exp_f32 v236, v236
    v_exp_f32 v237, v237
    v_exp_f32 v238, v238
    v_exp_f32 v239, v239
    v_add_f32 v224, 1.0, v224
    v_add_f32 v225, 1.0, v225
    v_add_f32 v226, 1.0, v226
    v_add_f32 v227, 1.0, v227
    v_add_f32 v228, 1.0, v228
    v_add_f32 v229, 1.0, v229
    v_add_f32 v230, 1.0, v230
    v_add_f32 v231, 1.0, v231
    v_add_f32 v232, 1.0, v232
    v_add_f32 v233, 1.0, v233
    v_add_f32 v234, 1.0, v234
    v_add_f32 v235, 1.0, v235
    v_add_f32 v236, 1.0, v236
    v_add_f32 v237, 1.0, v237
    v_add_f32 v238, 1.0, v238
    v_add_f32 v239, 1.0, v239
    v_rcp_f32 v224, v224
    v_rcp_f32 v225, v225
    v_rcp_f32 v226, v226
    v_rcp_f32 v227, v227
    v_rcp_f32 v228, v228
    v_rcp_f32 v229, v229
    v_rcp_f32 v230, v230
    v_rcp_f32 v231, v231
    v_rcp_f32 v232, v232
    v_rcp_f32 v233, v233
    v_rcp_f32 v234, v234
    v_rcp_f32 v235, v235
    v_rcp_f32 v236, v236
    v_rcp_f32 v237, v237
    v_rcp_f32 v238, v238
    v_rcp_f32 v239, v239
    v_mul_f32 v20, v20, v224
    v_mul_f32 v21, v21, v225
    v_mul_f32 v22, v22, v226
    v_mul_f32 v23, v23, v227
    v_mul_f32 v36, v36, v228
    v_mul_f32 v37, v37, v229
    v_mul_f32 v38, v38, v230
    v_mul_f32 v39, v39, v231
    v_mul_f32 v52, v52, v232
    v_mul_f32 v53, v53, v233
    v_mul_f32 v54, v54, v234
    v_mul_f32 v55, v55, v235
    v_mul_f32 v68, v68, v236
    v_mul_f32 v69, v69, v237
    v_mul_f32 v70, v70, v238
    v_mul_f32 v71, v71, v239
    v_cvt_pk_bf16_f32 v88, v20, v21
    v_cvt_pk_bf16_f32 v89, v22, v23
    v_cvt_pk_bf16_f32 v90, v36, v37
    v_cvt_pk_bf16_f32 v91, v38, v39
    global_store_dwordx4 v5, v[88:91], s[6:7] offset:0 sc1
    v_cvt_pk_bf16_f32 v92, v52, v53
    v_cvt_pk_bf16_f32 v93, v54, v55
    v_cvt_pk_bf16_f32 v94, v68, v69
    v_cvt_pk_bf16_f32 v95, v70, v71
    global_store_dwordx4 v5, v[92:95], s[6:7] offset:1024 sc1
    s_lshl_b32 s23, s9, 2
    s_add_u32 s23, s23, 0x8700
    s_waitcnt vmcnt(0)
    s_barrier
    s_cmp_lg_u32 s8, 0
    s_cbranch_scc1 .sg_73
    s_mov_b64 exec, 1
    v_mov_b32 v4, s23
    v_mov_b32 v5, 1
    global_atomic_add v4, v5, s[6:7]
    s_mov_b64 exec, -1
.sg_73:
    s_branch .wk_loop_41
.wk_46:
    s_mov_b32 s11, s9
    s_sub_u32 s9, s22, 11
    v_lshlrev_b32 v14, 4, v1
    s_mul_i32 s13, s9, 392
    s_mul_i32 s14, s8, 14
    s_add_u32 s13, s13, s14
    s_lshl_b32 s13, s13, 10
    s_add_u32 s13, s13, 0x1600000
    v_add_u32 v15, s13, v14
    global_load_dwordx4 a[0:3], v15, s[6:7] offset:0
    global_load_dwordx4 a[4:7], v15, s[6:7] offset:1024
    global_load_dwordx4 a[8:11], v15, s[6:7] offset:2048
    global_load_dwordx4 a[12:15], v15, s[6:7] offset:3072
    v_add_u32 v15, 4096, v15
    global_load_dwordx4 a[16:19], v15, s[6:7] offset:0
    global_load_dwordx4 a[20:23], v15, s[6:7] offset:1024
    global_load_dwordx4 a[24:27], v15, s[6:7] offset:2048
    global_load_dwordx4 a[28:31], v15, s[6:7] offset:3072
    v_add_u32 v15, 4096, v15
    global_load_dwordx4 a[32:35], v15, s[6:7] offset:0
    global_load_dwordx4 a[36:39], v15, s[6:7] offset:1024
    global_load_dwordx4 a[40:43], v15, s[6:7] offset:2048
    global_load_dwordx4 a[44:47], v15, s[6:7] offset:3072
    v_add_u32 v15, 4096, v15
    global_load_dwordx4 a[48:51], v15, s[6:7] offset:0
    global_load_dwordx4 a[52:55], v15, s[6:7] offset:1024
    s_add_u32 s13, s13, 57344
    v_add_u32 v15, s13, v14
    global_load_dwordx4 a[56:59], v15, s[6:7] offset:0
    global_load_dwordx4 a[60:63], v15, s[6:7] offset:1024
    global_load_dwordx4 a[64:67], v15, s[6:7] offset:2048
    global_load_dwordx4 a[68:71], v15, s[6:7] offset:3072
    v_add_u32 v15, 4096, v15
    global_load_dwordx4 a[72:75], v15, s[6:7] offset:0
    global_load_dwordx4 a[76:79], v15, s[6:7] offset:1024
    global_load_dwordx4 a[80:83], v15, s[6:7] offset:2048
    global_load_dwordx4 a[84:87], v15, s[6:7] offset:3072
    v_add_u32 v15, 4096, v15
    global_load_dwordx4 a[88:91], v15, s[6:7] offset:0
    global_load_dwordx4 a[92:95], v15, s[6:7] offset:1024
    global_load_dwordx4 a[96:99], v15, s[6:7] offset:2048
    global_load_dwordx4 a[100:103], v15, s[6:7] offset:3072
    v_add_u32 v15, 4096, v15
    global_load_dwordx4 a[104:107], v15, s[6:7] offset:0
    global_load_dwordx4 a[108:111], v15, s[6:7] offset:1024
    s_add_u32 s13, s13, 57344
    v_add_u32 v15, s13, v14
    global_load_dwordx4 a[112:115], v15, s[6:7] offset:0
    global_load_dwordx4 a[116:119], v15, s[6:7] offset:1024
    global_load_dwordx4 a[120:123], v15, s[6:7] offset:2048
    global_load_dwordx4 a[124:127], v15, s[6:7] offset:3072
    v_add_u32 v15, 4096, v15
    global_load_dwordx4 a[128:131], v15, s[6:7] offset:0
    global_load_dwordx4 a[132:135], v15, s[6:7] offset:1024
    global_load_dwordx4 a[136:139], v15, s[6:7] offset:2048
    global_load_dwordx4 a[140:143], v15, s[6:7] offset:3072
    v_add_u32 v15, 4096, v15
    global_load_dwordx4 a[144:147], v15, s[6:7] offset:0
    global_load_dwordx4 a[148:151], v15, s[6:7] offset:1024
    global_load_dwordx4 a[152:155], v15, s[6:7] offset:2048
    global_load_dwordx4 a[156:159], v15, s[6:7] offset:3072
    v_add_u32 v15, 4096, v15
    global_load_dwordx4 a[160:163], v15, s[6:7] offset:0
    global_load_dwordx4 a[164:167], v15, s[6:7] offset:1024
    s_add_u32 s13, s13, 57344
    v_add_u32 v15, s13, v14
    global_load_dwordx4 a[168:171], v15, s[6:7] offset:0
    global_load_dwordx4 a[172:175], v15, s[6:7] offset:1024
    global_load_dwordx4 a[176:179], v15, s[6:7] offset:2048
    global_load_dwordx4 a[180:183], v15, s[6:7] offset:3072
    v_add_u32 v15, 4096, v15
    global_load_dwordx4 a[184:187], v15, s[6:7] offset:0
    global_load_dwordx4 a[188:191], v15, s[6:7] offset:1024
    global_load_dwordx4 a[192:195], v15, s[6:7] offset:2048
    global_load_dwordx4 a[196:199], v15, s[6:7] offset:3072
    v_add_u32 v15, 4096, v15
    global_load_dwordx4 a[200:203], v15, s[6:7] offset:0
    global_load_dwordx4 a[204:207], v15, s[6:7] offset:1024
    global_load_dwordx4 a[208:211], v15, s[6:7] offset:2048
    global_load_dwordx4 a[212:215], v15, s[6:7] offset:3072
    v_add_u32 v15, 4096, v15
    global_load_dwordx4 a[216:219], v15, s[6:7] offset:0
    global_load_dwordx4 a[220:223], v15, s[6:7] offset:1024
    s_add_u32 s13, s13, 57344
    s_waitcnt vmcnt(42)
    v_add_u32 v15, s13, v14
    global_load_dwordx4 a[224:227], v15, s[6:7] offset:0
    global_load_dwordx4 a[228:231], v15, s[6:7] offset:1024
    global_load_dwordx4 a[232:235], v15, s[6:7] offset:2048
    global_load_dwordx4 a[236:239], v15, s[6:7] offset:3072
    v_add_u32 v15, 4096, v15
    global_load_dwordx4 a[240:243], v15, s[6:7] offset:0
    global_load_dwordx4 a[244:247], v15, s[6:7] offset:1024
    global_load_dwordx4 a[248:251], v15, s[6:7] offset:2048
    global_load_dwordx4 a[252:255], v15, s[6:7] offset:3072
    v_add_u32 v15, 4096, v15
    global_load_dwordx4 v[120:123], v15, s[6:7] offset:0
    global_load_dwordx4 v[124:127], v15, s[6:7] offset:1024
    global_load_dwordx4 v[128:131], v15, s[6:7] offset:2048
    global_load_dwordx4 v[132:135], v15, s[6:7] offset:3072
    v_add_u32 v15, 4096, v15
    global_load_dwordx4 v[136:139], v15, s[6:7] offset:0
    global_load_dwordx4 v[140:143], v15, s[6:7] offset:1024
    s_add_u32 s13, s13, 57344
    s_waitcnt vmcnt(42)
    v_add_u32 v15, s13, v14
    global_load_dwordx4 v[144:147], v15, s[6:7] offset:0
    global_load_dwordx4 v[148:151], v15, s[6:7] offset:1024
    global_load_dwordx4 v[152:155], v15, s[6:7] offset:2048
    global_load_dwordx4 v[156:159], v15, s[6:7] offset:3072
    v_add_u32 v15, 4096, v15
    global_load_dwordx4 v[160:163], v15, s[6:7] offset:0
    global_load_dwordx4 v[164:167], v15, s[6:7] offset:1024
    global_load_dwordx4 v[168:171], v15, s[6:7] offset:2048
    global_load_dwordx4 v[172:175], v15, s[6:7] offset:3072
    v_add_u32 v15, 4096, v15
    global_load_dwordx4 v[176:179], v15, s[6:7] offset:0
    global_load_dwordx4 v[180:183], v15, s[6:7] offset:1024
    global_load_dwordx4 v[184:187], v15, s[6:7] offset:2048
    global_load_dwordx4 v[188:191], v15, s[6:7] offset:3072
    v_add_u32 v15, 4096, v15
    global_load_dwordx4 v[192:195], v15, s[6:7] offset:0
    global_load_dwordx4 v[196:199], v15, s[6:7] offset:1024
    s_add_u32 s13, s13, 57344
    s_waitcnt vmcnt(42)
    v_add_u32 v15, s13, v14
    global_load_dwordx4 v[200:203], v15, s[6:7] offset:0
    global_load_dwordx4 v[204:207], v15, s[6:7] offset:1024
    global_load_dwordx4 v[208:211], v15, s[6:7] offset:2048
    global_load_dwordx4 v[212:215], v15, s[6:7] offset:3072
    v_add_u32 v15, 4096, v15
    global_load_dwordx4 v[216:219], v15, s[6:7] offset:0
    global_load_dwordx4 v[220:223], v15, s[6:7] offset:1024
    global_load_dwordx4 v[224:227], v15, s[6:7] offset:2048
    global_load_dwordx4 v[228:231], v15, s[6:7] offset:3072
    v_add_u32 v15, 4096, v15
    global_load_dwordx4 v[232:235], v15, s[6:7] offset:0
    global_load_dwordx4 v[236:239], v15, s[6:7] offset:1024
    global_load_dwordx4 v[240:243], v15, s[6:7] offset:2048
    global_load_dwordx4 v[244:247], v15, s[6:7] offset:3072
    v_add_u32 v15, 4096, v15
    global_load_dwordx4 v[248:251], v15, s[6:7] offset:0
    global_load_dwordx4 v[252:255], v15, s[6:7] offset:1024
    s_add_u32 s13, s13, 57344
    s_waitcnt vmcnt(42)
    s_lshl_b32 s23, s11, 2
    s_add_u32 s23, s23, 0x8700
    s_waitcnt vmcnt(0)
    s_cmp_lg_u32 s8, 0
    s_cbranch_scc1 .wf_74
    v_mov_b32 v4, s23
.wf_75:
    global_load_dword v8, v4, s[6:7] sc1
    s_sub_u32 s12, s12, 1
    s_cmp_eq_u32 s12, 0
    s_cbranch_scc1 .mg_end_12
    s_waitcnt vmcnt(0)
    v_readfirstlane_b32 s13, v8
    s_nop 3
    s_cmp_lt_u32 s13, 7
    s_cbranch_scc1 .wf_76
    s_branch .wf_77
.wf_76:
    s_sleep 8
    s_branch .wf_75
.wf_77:
.wf_74:
    s_barrier
    s_mul_i32 s13, s11, 112
    s_add_u32 s13, s13, s14
    s_lshl_b32 s13, s13, 10
    s_add_u32 s13, s13, 0x1e00000
    v_add_u32 v12, s13, v14
    s_add_u32 s13, s13, 57344
    v_add_u32 v13, s13, v14
    s_add_u32 s13, s13, 57344
    global_load_dwordx4 v[72:75], v12, s[6:7] offset:0 sc1
    global_load_dwordx4 v[76:79], v13, s[6:7] offset:0 sc1
    global_load_dwordx4 v[80:83], v12, s[6:7] offset:1024 sc1
    global_load_dwordx4 v[84:87], v13, s[6:7] offset:1024 sc1
    global_load_dwordx4 v[88:91], v12, s[6:7] offset:2048 sc1
    global_load_dwordx4 v[92:95], v13, s[6:7] offset:2048 sc1
    global_load_dwordx4 v[96:99], v12, s[6:7] offset:3072 sc1
    global_load_dwordx4 v[100:103], v13, s[6:7] offset:3072 sc1
    v_add_u32 v12, 4096, v12
    v_add_u32 v13, 4096, v13
    global_load_dwordx4 v[104:107], v12, s[6:7] offset:0 sc1
    global_load_dwordx4 v[108:111], v13, s[6:7] offset:0 sc1
    global_load_dwordx4 v[112:115], v12, s[6:7] offset:1024 sc1
    global_load_dwordx4 v[116:119], v13, s[6:7] offset:1024 sc1
    s_waitcnt vmcnt(10)
    v_mfma_f32_16x16x32_bf16 v[16:19], a[0:3], v[72:75], 0
    v_mfma_f32_16x16x32_bf16 v[20:23], a[0:3], v[76:79], 0
    v_mfma_f32_16x16x32_bf16 v[24:27], a[56:59], v[72:75], 0
    v_mfma_f32_16x16x32_bf16 v[28:31], a[56:59], v[76:79], 0
    v_mfma_f32_16x16x32_bf16 v[32:35], a[112:115], v[72:75], 0
    v_mfma_f32_16x16x32_bf16 v[36:39], a[112:115], v[76:79], 0
    v_mfma_f32_16x16x32_bf16 v[40:43], a[168:171], v[72:75], 0
    v_mfma_f32_16x16x32_bf16 v[44:47], a[168:171], v[76:79], 0
    v_mfma_f32_16x16x32_bf16 v[48:51], a[224:227], v[72:75], 0
    v_mfma_f32_16x16x32_bf16 v[52:55], a[224:227], v[76:79], 0
    v_mfma_f32_16x16x32_bf16 v[56:59], v[144:147], v[72:75], 0
    v_mfma_f32_16x16x32_bf16 v[60:63], v[144:147], v[76:79], 0
    v_mfma_f32_16x16x32_bf16 v[64:67], v[200:203], v[72:75], 0
    v_mfma_f32_16x16x32_bf16 v[68:71], v[200:203], v[76:79], 0
    global_load_dwordx4 v[72:75], v12, s[6:7] offset:2048 sc1
    global_load_dwordx4 v[76:79], v13, s[6:7] offset:2048 sc1
    s_waitcnt vmcnt(10)
    v_mfma_f32_16x16x32_bf16 v[16:19], a[4:7], v[80:83], v[16:19]
    v_mfma_f32_16x16x32_bf16 v[20:23], a[4:7], v[84:87], v[20:23]
    v_mfma_f32_16x16x32_bf16 v[24:27], a[60:63], v[80:83], v[24:27]
    v_mfma_f32_16x16x32_bf16 v[28:31], a[60:63], v[84:87], v[28:31]
    v_mfma_f32_16x16x32_bf16 v[32:35], a[116:119], v[80:83], v[32:35]
    v_mfma_f32_16x16x32_bf16 v[36:39], a[116:119], v[84:87], v[36:39]
    v_mfma_f32_16x16x32_bf16 v[40:43], a[172:175], v[80:83], v[40:43]
    v_mfma_f32_16x16x32_bf16 v[44:47], a[172:175], v[84:87], v[44:47]
    v_mfma_f32_16x16x32_bf16 v[48:51], a[228:231], v[80:83], v[48:51]
    v_mfma_f32_16x16x32_bf16 v[52:55], a[228:231], v[84:87], v[52:55]
    v_mfma_f32_16x16x32_bf16 v[56:59], v[148:151], v[80:83], v[56:59]
    v_mfma_f32_16x16x32_bf16 v[60:63], v[148:151], v[84:87], v[60:63]
    v_mfma_f32_16x16x32_bf16 v[64:67], v[204:207], v[80:83], v[64:67]
    v_mfma_f32_16x16x32_bf16 v[68:71], v[204:207], v[84:87], v[68:71]
    global_load_dwordx4 v[80:83], v12, s[6:7] offset:3072 sc1
    global_load_dwordx4 v[84:87], v13, s[6:7] offset:3072 sc1
    v_add_u32 v12, 4096, v12
    v_add_u32 v13, 4096, v13
    s_waitcnt vmcnt(10)
    v_mfma_f32_16x16x32_bf16 v[16:19], a[8:11], v[88:91], v[16:19]
    v_mfma_f32_16x16x32_bf16 v[20:23], a[8:11], v[92:95], v[20:23]
    v_mfma_f32_16x16x32_bf16 v[24:27], a[64:67], v[88:91], v[24:27]
    v_mfma_f32_16x16x32_bf16 v[28:31], a[64:67], v[92:95], v[28:31]
    v_mfma_f32_16x16x32_bf16 v[32:35], a[120:123], v[88:91], v[32:35]
    v_mfma_f32_16x16x32_bf16 v[36:39], a[120:123], v[92:95], v[36:39]
    v_mfma_f32_16x16x32_bf16 v[40:43], a[176:179], v[88:91], v[40:43]
    v_mfma_f32_16x16x32_bf16 v[44:47], a[176:179], v[92:95], v[44:47]
    v_mfma_f32_16x16x32_bf16 v[48:51], a[232:235], v[88:91], v[48:51]
    v_mfma_f32_16x16x32_bf16 v[52:55], a[232:235], v[92:95], v[52:55]
    v_mfma_f32_16x16x32_bf16 v[56:59], v[152:155], v[88:91], v[56:59]
    v_mfma_f32_16x16x32_bf16 v[60:63], v[152:155], v[92:95], v[60:63]
    v_mfma_f32_16x16x32_bf16 v[64:67], v[208:211], v[88:91], v[64:67]
    v_mfma_f32_16x16x32_bf16 v[68:71], v[208:211], v[92:95], v[68:71]
    global_load_dwordx4 v[88:91], v12, s[6:7] offset:0 sc1
    global_load_dwordx4 v[92:95], v13, s[6:7] offset:0 sc1
    s_waitcnt vmcnt(10)
    v_mfma_f32_16x16x32_bf16 v[16:19], a[12:15], v[96:99], v[16:19]
    v_mfma_f32_16x16x32_bf16 v[20:23], a[12:15], v[100:103], v[20:23]
    v_mfma_f32_16x16x32_bf16 v[24:27], a[68:71], v[96:99], v[24:27]
    v_mfma_f32_16x16x32_bf16 v[28:31], a[68:71], v[100:103], v[28:31]
    v_mfma_f32_16x16x32_bf16 v[32:35], a[124:127], v[96:99], v[32:35]
    v_mfma_f32_16x16x32_bf16 v[36:39], a[124:127], v[100:103], v[36:39]
    v_mfma_f32_16x16x32_bf16 v[40:43], a[180:183], v[96:99], v[40:43]
    v_mfma_f32_16x16x32_bf16 v[44:47], a[180:183], v[100:103], v[44:47]
    v_mfma_f32_16x16x32_bf16 v[48:51], a[236:239], v[96:99], v[48:51]
    v_mfma_f32_16x16x32_bf16 v[52:55], a[236:239], v[100:103], v[52:55]
    v_mfma_f32_16x16x32_bf16 v[56:59], v[156:159], v[96:99], v[56:59]
    v_mfma_f32_16x16x32_bf16 v[60:63], v[156:159], v[100:103], v[60:63]
    v_mfma_f32_16x16x32_bf16 v[64:67], v[212:215], v[96:99], v[64:67]
    v_mfma_f32_16x16x32_bf16 v[68:71], v[212:215], v[100:103], v[68:71]
    global_load_dwordx4 v[96:99], v12, s[6:7] offset:1024 sc1
    global_load_dwordx4 v[100:103], v13, s[6:7] offset:1024 sc1
    s_waitcnt vmcnt(10)
    v_mfma_f32_16x16x32_bf16 v[16:19], a[16:19], v[104:107], v[16:19]
    v_mfma_f32_16x16x32_bf16 v[20:23], a[16:19], v[108:111], v[20:23]
    v_mfma_f32_16x16x32_bf16 v[24:27], a[72:75], v[104:107], v[24:27]
    v_mfma_f32_16x16x32_bf16 v[28:31], a[72:75], v[108:111], v[28:31]
    v_mfma_f32_16x16x32_bf16 v[32:35], a[128:131], v[104:107], v[32:35]
    v_mfma_f32_16x16x32_bf16 v[36:39], a[128:131], v[108:111], v[36:39]
    v_mfma_f32_16x16x32_bf16 v[40:43], a[184:187], v[104:107], v[40:43]
    v_mfma_f32_16x16x32_bf16 v[44:47], a[184:187], v[108:111], v[44:47]
    v_mfma_f32_16x16x32_bf16 v[48:51], a[240:243], v[104:107], v[48:51]
    v_mfma_f32_16x16x32_bf16 v[52:55], a[240:243], v[108:111], v[52:55]
    v_mfma_f32_16x16x32_bf16 v[56:59], v[160:163], v[104:107], v[56:59]
    v_mfma_f32_16x16x32_bf16 v[60:63], v[160:163], v[108:111], v[60:63]
    v_mfma_f32_16x16x32_bf16 v[64:67], v[216:219], v[104:107], v[64:67]
    v_mfma_f32_16x16x32_bf16 v[68:71], v[216:219], v[108:111], v[68:71]
    global_load_dwordx4 v[104:107], v12, s[6:7] offset:2048 sc1
    global_load_dwordx4 v[108:111], v13, s[6:7] offset:2048 sc1
    s_waitcnt vmcnt(10)
    v_mfma_f32_16x16x32_bf16 v[16:19], a[20:23], v[112:115], v[16:19]
    v_mfma_f32_16x16x32_bf16 v[20:23], a[20:23], v[116:119], v[20:23]
    v_mfma_f32_16x16x32_bf16 v[24:27], a[76:79], v[112:115], v[24:27]
    v_mfma_f32_16x16x32_bf16 v[28:31], a[76:79], v[116:119], v[28:31]
    v_mfma_f32_16x16x32_bf16 v[32:35], a[132:135], v[112:115], v[32:35]
    v_mfma_f32_16x16x32_bf16 v[36:39], a[132:135], v[116:119], v[36:39]
    v_mfma_f32_16x16x32_bf16 v[40:43], a[188:191], v[112:115], v[40:43]
    v_mfma_f32_16x16x32_bf16 v[44:47], a[188:191], v[116:119], v[44:47]
    v_mfma_f32_16x16x32_bf16 v[48:51], a[244:247], v[112:115], v[48:51]
    v_mfma_f32_16x16x32_bf16 v[52:55], a[244:247], v[116:119], v[52:55]
    v_mfma_f32_16x16x32_bf16 v[56:59], v[164:167], v[112:115], v[56:59]
    v_mfma_f32_16x16x32_bf16 v[60:63], v[164:167], v[116:119], v[60:63]
    v_mfma_f32_16x16x32_bf16 v[64:67], v[220:223], v[112:115], v[64:67]
    v_mfma_f32_16x16x32_bf16 v[68:71], v[220:223], v[116:119], v[68:71]
    global_load_dwordx4 v[112:115], v12, s[6:7] offset:3072 sc1
    global_load_dwordx4 v[116:119], v13, s[6:7] offset:3072 sc1
    v_add_u32 v12, 4096, v12
    v_add_u32 v13, 4096, v13
    s_waitcnt vmcnt(10)
    v_mfma_f32_16x16x32_bf16 v[16:19], a[24:27], v[72:75], v[16:19]
    v_mfma_f32_16x16x32_bf16 v[20:23], a[24:27], v[76:79], v[20:23]
    v_mfma_f32_16x16x32_bf16 v[24:27], a[80:83], v[72:75], v[24:27]
    v_mfma_f32_16x16x32_bf16 v[28:31], a[80:83], v[76:79], v[28:31]
    v_mfma_f32_16x16x32_bf16 v[32:35], a[136:139], v[72:75], v[32:35]
    v_mfma_f32_16x16x32_bf16 v[36:39], a[136:139], v[76:79], v[36:39]
    v_mfma_f32_16x16x32_bf16 v[40:43], a[192:195], v[72:75], v[40:43]
    v_mfma_f32_16x16x32_bf16 v[44:47], a[192:195], v[76:79], v[44:47]
    v_mfma_f32_16x16x32_bf16 v[48:51], a[248:251], v[72:75], v[48:51]
    v_mfma_f32_16x16x32_bf16 v[52:55], a[248:251], v[76:79], v[52:55]
    v_mfma_f32_16x16x32_bf16 v[56:59], v[168:171], v[72:75], v[56:59]
    v_mfma_f32_16x16x32_bf16 v[60:63], v[168:171], v[76:79], v[60:63]
    v_mfma_f32_16x16x32_bf16 v[64:67], v[224:227], v[72:75], v[64:67]
    v_mfma_f32_16x16x32_bf16 v[68:71], v[224:227], v[76:79], v[68:71]
    global_load_dwordx4 v[72:75], v12, s[6:7] offset:0 sc1
    global_load_dwordx4 v[76:79], v13, s[6:7] offset:0 sc1
    s_waitcnt vmcnt(10)
    v_mfma_f32_16x16x32_bf16 v[16:19], a[28:31], v[80:83], v[16:19]
    v_mfma_f32_16x16x32_bf16 v[20:23], a[28:31], v[84:87], v[20:23]
    v_mfma_f32_16x16x32_bf16 v[24:27], a[84:87], v[80:83], v[24:27]
    v_mfma_f32_16x16x32_bf16 v[28:31], a[84:87], v[84:87], v[28:31]
    v_mfma_f32_16x16x32_bf16 v[32:35], a[140:143], v[80:83], v[32:35]
    v_mfma_f32_16x16x32_bf16 v[36:39], a[140:143], v[84:87], v[36:39]
    v_mfma_f32_16x16x32_bf16 v[40:43], a[196:199], v[80:83], v[40:43]
    v_mfma_f32_16x16x32_bf16 v[44:47], a[196:199], v[84:87], v[44:47]
    v_mfma_f32_16x16x32_bf16 v[48:51], a[252:255], v[80:83], v[48:51]
    v_mfma_f32_16x16x32_bf16 v[52:55], a[252:255], v[84:87], v[52:55]
    v_mfma_f32_16x16x32_bf16 v[56:59], v[172:175], v[80:83], v[56:59]
    v_mfma_f32_16x16x32_bf16 v[60:63], v[172:175], v[84:87], v[60:63]
    v_mfma_f32_16x16x32_bf16 v[64:67], v[228:231], v[80:83], v[64:67]
    v_mfma_f32_16x16x32_bf16 v[68:71], v[228:231], v[84:87], v[68:71]
    global_load_dwordx4 v[80:83], v12, s[6:7] offset:1024 sc1
    global_load_dwordx4 v[84:87], v13, s[6:7] offset:1024 sc1
    s_waitcnt vmcnt(10)
    v_mfma_f32_16x16x32_bf16 v[16:19], a[32:35], v[88:91], v[16:19]
    v_mfma_f32_16x16x32_bf16 v[20:23], a[32:35], v[92:95], v[20:23]
    v_mfma_f32_16x16x32_bf16 v[24:27], a[88:91], v[88:91], v[24:27]
    v_mfma_f32_16x16x32_bf16 v[28:31], a[88:91], v[92:95], v[28:31]
    v_mfma_f32_16x16x32_bf16 v[32:35], a[144:147], v[88:91], v[32:35]
    v_mfma_f32_16x16x32_bf16 v[36:39], a[144:147], v[92:95], v[36:39]
    v_mfma_f32_16x16x32_bf16 v[40:43], a[200:203], v[88:91], v[40:43]
    v_mfma_f32_16x16x32_bf16 v[44:47], a[200:203], v[92:95], v[44:47]
    v_mfma_f32_16x16x32_bf16 v[48:51], v[120:123], v[88:91], v[48:51]
    v_mfma_f32_16x16x32_bf16 v[52:55], v[120:123], v[92:95], v[52:55]
    v_mfma_f32_16x16x32_bf16 v[56:59], v[176:179], v[88:91], v[56:59]
    v_mfma_f32_16x16x32_bf16 v[60:63], v[176:179], v[92:95], v[60:63]
    v_mfma_f32_16x16x32_bf16 v[64:67], v[232:235], v[88:91], v[64:67]
    v_mfma_f32_16x16x32_bf16 v[68:71], v[232:235], v[92:95], v[68:71]
    s_waitcnt vmcnt(8)
    v_mfma_f32_16x16x32_bf16 v[16:19], a[36:39], v[96:99], v[16:19]
    v_mfma_f32_16x16x32_bf16 v[20:23], a[36:39], v[100:103], v[20:23]
    v_mfma_f32_16x16x32_bf16 v[24:27], a[92:95], v[96:99], v[24:27]
    v_mfma_f32_16x16x32_bf16 v[28:31], a[92:95], v[100:103], v[28:31]
    v_mfma_f32_16x16x32_bf16 v[32:35], a[148:151], v[96:99], v[32:35]
    v_mfma_f32_16x16x32_bf16 v[36:39], a[148:151], v[100:103], v[36:39]
    v_mfma_f32_16x16x32_bf16 v[40:43], a[204:207], v[96:99], v[40:43]
    v_mfma_f32_16x16x32_bf16 v[44:47], a[204:207], v[100:103], v[44:47]
    v_mfma_f32_16x16x32_bf16 v[48:51], v[124:127], v[96:99], v[48:51]
    v_mfma_f32_16x16x32_bf16 v[52:55], v[124:127], v[100:103], v[52:55]
    v_mfma_f32_16x16x32_bf16 v[56:59], v[180:183], v[96:99], v[56:59]
    v_mfma_f32_16x16x32_bf16 v[60:63], v[180:183], v[100:103], v[60:63]
    v_mfma_f32_16x16x32_bf16 v[64:67], v[236:239], v[96:99], v[64:67]
    v_mfma_f32_16x16x32_bf16 v[68:71], v[236:239], v[100:103], v[68:71]
    s_waitcnt vmcnt(6)
    v_mfma_f32_16x16x32_bf16 v[16:19], a[40:43], v[104:107], v[16:19]
    v_mfma_f32_16x16x32_bf16 v[20:23], a[40:43], v[108:111], v[20:23]
    v_mfma_f32_16x16x32_bf16 v[24:27], a[96:99], v[104:107], v[24:27]
    v_mfma_f32_16x16x32_bf16 v[28:31], a[96:99], v[108:111], v[28:31]
    v_mfma_f32_16x16x32_bf16 v[32:35], a[152:155], v[104:107], v[32:35]
    v_mfma_f32_16x16x32_bf16 v[36:39], a[152:155], v[108:111], v[36:39]
    v_mfma_f32_16x16x32_bf16 v[40:43], a[208:211], v[104:107], v[40:43]
    v_mfma_f32_16x16x32_bf16 v[44:47], a[208:211], v[108:111], v[44:47]
    v_mfma_f32_16x16x32_bf16 v[48:51], v[128:131], v[104:107], v[48:51]
    v_mfma_f32_16x16x32_bf16 v[52:55], v[128:131], v[108:111], v[52:55]
    v_mfma_f32_16x16x32_bf16 v[56:59], v[184:187], v[104:107], v[56:59]
    v_mfma_f32_16x16x32_bf16 v[60:63], v[184:187], v[108:111], v[60:63]
    v_mfma_f32_16x16x32_bf16 v[64:67], v[240:243], v[104:107], v[64:67]
    v_mfma_f32_16x16x32_bf16 v[68:71], v[240:243], v[108:111], v[68:71]
    s_waitcnt vmcnt(4)
    v_mfma_f32_16x16x32_bf16 v[16:19], a[44:47], v[112:115], v[16:19]
    v_mfma_f32_16x16x32_bf16 v[20:23], a[44:47], v[116:119], v[20:23]
    v_mfma_f32_16x16x32_bf16 v[24:27], a[100:103], v[112:115], v[24:27]
    v_mfma_f32_16x16x32_bf16 v[28:31], a[100:103], v[116:119], v[28:31]
    v_mfma_f32_16x16x32_bf16 v[32:35], a[156:159], v[112:115], v[32:35]
    v_mfma_f32_16x16x32_bf16 v[36:39], a[156:159], v[116:119], v[36:39]
    v_mfma_f32_16x16x32_bf16 v[40:43], a[212:215], v[112:115], v[40:43]
    v_mfma_f32_16x16x32_bf16 v[44:47], a[212:215], v[116:119], v[44:47]
    v_mfma_f32_16x16x32_bf16 v[48:51], v[132:135], v[112:115], v[48:51]
    v_mfma_f32_16x16x32_bf16 v[52:55], v[132:135], v[116:119], v[52:55]
    v_mfma_f32_16x16x32_bf16 v[56:59], v[188:191], v[112:115], v[56:59]
    v_mfma_f32_16x16x32_bf16 v[60:63], v[188:191], v[116:119], v[60:63]
    v_mfma_f32_16x16x32_bf16 v[64:67], v[244:247], v[112:115], v[64:67]
    v_mfma_f32_16x16x32_bf16 v[68:71], v[244:247], v[116:119], v[68:71]
    s_waitcnt vmcnt(2)
    v_mfma_f32_16x16x32_bf16 v[16:19], a[48:51], v[72:75], v[16:19]
    v_mfma_f32_16x16x32_bf16 v[20:23], a[48:51], v[76:79], v[20:23]
    v_mfma_f32_16x16x32_bf16 v[24:27], a[104:107], v[72:75], v[24:27]
    v_mfma_f32_16x16x32_bf16 v[28:31], a[104:107], v[76:79], v[28:31]
    v_mfma_f32_16x16x32_bf16 v[32:35], a[160:163], v[72:75], v[32:35]
    v_mfma_f32_16x16x32_bf16 v[36:39], a[160:163], v[76:79], v[36:39]
    v_mfma_f32_16x16x32_bf16 v[40:43], a[216:219], v[72:75], v[40:43]
    v_mfma_f32_16x16x32_bf16 v[44:47], a[216:219], v[76:79], v[44:47]
    v_mfma_f32_16x16x32_bf16 v[48:51], v[136:139], v[72:75], v[48:51]
    v_mfma_f32_16x16x32_bf16 v[52:55], v[136:139], v[76:79], v[52:55]
    v_mfma_f32_16x16x32_bf16 v[56:59], v[192:195], v[72:75], v[56:59]
    v_mfma_f32_16x16x32_bf16 v[60:63], v[192:195], v[76:79], v[60:63]
    v_mfma_f32_16x16x32_bf16 v[64:67], v[248:251], v[72:75], v[64:67]
    v_mfma_f32_16x16x32_bf16 v[68:71], v[248:251], v[76:79], v[68:71]
    s_waitcnt vmcnt(0)
    v_mfma_f32_16x16x32_bf16 v[16:19], a[52:55], v[80:83], v[16:19]
    v_mfma_f32_16x16x32_bf16 v[20:23], a[52:55], v[84:87], v[20:23]
    v_mfma_f32_16x16x32_bf16 v[24:27], a[108:111], v[80:83], v[24:27]
    v_mfma_f32_16x16x32_bf16 v[28:31], a[108:111], v[84:87], v[28:31]
    v_mfma_f32_16x16x32_bf16 v[32:35], a[164:167], v[80:83], v[32:35]
    v_mfma_f32_16x16x32_bf16 v[36:39], a[164:167], v[84:87], v[36:39]
    v_mfma_f32_16x16x32_bf16 v[40:43], a[220:223], v[80:83], v[40:43]
    v_mfma_f32_16x16x32_bf16 v[44:47], a[220:223], v[84:87], v[44:47]
    v_mfma_f32_16x16x32_bf16 v[48:51], v[140:143], v[80:83], v[48:51]
    v_mfma_f32_16x16x32_bf16 v[52:55], v[140:143], v[84:87], v[52:55]
    v_mfma_f32_16x16x32_bf16 v[56:59], v[196:199], v[80:83], v[56:59]
    v_mfma_f32_16x16x32_bf16 v[60:63], v[196:199], v[84:87], v[60:63]
    v_mfma_f32_16x16x32_bf16 v[64:67], v[252:255], v[80:83], v[64:67]
    v_mfma_f32_16x16x32_bf16 v[68:71], v[252:255], v[84:87], v[68:71]
    s_add_u32 s13, s8, 0
    s_min_u32 s13, s13, 13
    s_lshr_b32 s14, s13, 1
    s_and_b32 s15, s13, 1
    s_mul_i32 s16, s9, 7
    s_add_u32 s16, s16, s14
    s_lshl_b32 s16, s16, 4
    v_lshl_add_u32 v6, v3, 2, s16
    s_lshl_b32 s17, s11, 5
    s_lshl_b32 s15, s15, 4
    s_add_u32 s17, s17, s15
    v_add_u32 v7, s17, v2
    s_mov_b32 s18, 896
    v_mul_lo_u32 v7, v7, s18
    v_lshl_add_u32 v128, v6, 1, v7
    v_add_u32 v8, 0x1a00000, v128
    global_load_dwordx2 v[120:121], v8, s[6:7] sc1
    v_lshlrev_b32 v9, 1, v6
    global_load_dwordx2 v[122:123], v9, s[34:35]
    v_lshlrev_b32 v9, 2, v6
    v_add_u32 v9, 8960, v9
    global_load_dwordx4 v[124:127], v9, s[6:7]
    s_add_u32 s13, s8, 4
    s_min_u32 s13, s13, 13
    s_lshr_b32 s14, s13, 1
    s_and_b32 s15, s13, 1
    s_mul_i32 s16, s9, 7
    s_add_u32 s16, s16, s14
    s_lshl_b32 s16, s16, 4
    v_lshl_add_u32 v6, v3, 2, s16
    s_lshl_b32 s17, s11, 5
    s_lshl_b32 s15, s15, 4
    s_add_u32 s17, s17, s15
    v_add_u32 v7, s17, v2
    s_mov_b32 s18, 896
    v_mul_lo_u32 v7, v7, s18
    v_lshl_add_u32 v144, v6, 1, v7
    v_add_u32 v8, 0x1a00000, v144
    global_load_dwordx2 v[136:137], v8, s[6:7] sc1
    v_lshlrev_b32 v9, 1, v6
    global_load_dwordx2 v[138:139], v9, s[34:35]
    v_lshlrev_b32 v9, 2, v6
    v_add_u32 v9, 8960, v9
    global_load_dwordx4 v[140:143], v9, s[6:7]
    s_add_u32 s13, s8, 8
    s_min_u32 s13, s13, 13
    s_lshr_b32 s14, s13, 1
    s_and_b32 s15, s13, 1
    s_mul_i32 s16, s9, 7
    s_add_u32 s16, s16, s14
    s_lshl_b32 s16, s16, 4
    v_lshl_add_u32 v6, v3, 2, s16
    s_lshl_b32 s17, s11, 5
    s_lshl_b32 s15, s15, 4
    s_add_u32 s17, s17, s15
    v_add_u32 v7, s17, v2
    s_mov_b32 s18, 896
    v_mul_lo_u32 v7, v7, s18
    v_lshl_add_u32 v160, v6, 1, v7
    v_add_u32 v8, 0x1a00000, v160
    global_load_dwordx2 v[152:153], v8, s[6:7] sc1
    v_lshlrev_b32 v9, 1, v6
    global_load_dwordx2 v[154:155], v9, s[34:35]
    v_lshlrev_b32 v9, 2, v6
    v_add_u32 v9, 8960, v9
    global_load_dwordx4 v[156:159], v9, s[6:7]
    s_add_u32 s13, s8, 12
    s_min_u32 s13, s13, 13
    s_lshr_b32 s14, s13, 1
    s_and_b32 s15, s13, 1
    s_mul_i32 s16, s9, 7
    s_add_u32 s16, s16, s14
    s_lshl_b32 s16, s16, 4
    v_lshl_add_u32 v6, v3, 2, s16
    s_lshl_b32 s17, s11, 5
    s_lshl_b32 s15, s15, 4
    s_add_u32 s17, s17, s15
    v_add_u32 v7, s17, v2
    s_mov_b32 s18, 896
    v_mul_lo_u32 v7, v7, s18
    v_lshl_add_u32 v176, v6, 1, v7
    v_add_u32 v8, 0x1a00000, v176
    global_load_dwordx2 v[168:169], v8, s[6:7] sc1
    v_lshlrev_b32 v9, 1, v6
    global_load_dwordx2 v[170:171], v9, s[34:35]
    v_lshlrev_b32 v9, 2, v6
    v_add_u32 v9, 8960, v9
    global_load_dwordx4 v[172:175], v9, s[6:7]
    s_mul_i32 s13, s8, 14336
    v_add_u32 v5, s13, v14
    ds_write_b128 v5, v[16:19] offset:0
    ds_write_b128 v5, v[20:23] offset:1024
    ds_write_b128 v5, v[24:27] offset:2048
    ds_write_b128 v5, v[28:31] offset:3072
    ds_write_b128 v5, v[32:35] offset:4096
    ds_write_b128 v5, v[36:39] offset:5120
    ds_write_b128 v5, v[40:43] offset:6144
    ds_write_b128 v5, v[44:47] offset:7168
    ds_write_b128 v5, v[48:51] offset:8192
    ds_write_b128 v5, v[52:55] offset:9216
    ds_write_b128 v5, v[56:59] offset:10240
    ds_write_b128 v5, v[60:63] offset:11264
    ds_write_b128 v5, v[64:67] offset:12288
    ds_write_b128 v5, v[68:71] offset:13312
    s_waitcnt lgkmcnt(0)
    s_barrier
    s_add_u32 s13, s8, 0
    s_min_u32 s13, s13, 13
    s_lshl_b32 s14, s13, 10
    v_add_u32 v5, s14, v14
    ds_read_b128 v[16:19], v5 offset:0
    ds_read_b128 v[20:23], v5 offset:14336
    ds_read_b128 v[24:27], v5 offset:28672
    ds_read_b128 v[28:31], v5 offset:43008
    s_add_u32 s13, s8, 4
    s_min_u32 s13, s13, 13
    s_lshl_b32 s14, s13, 10
    v_add_u32 v5, s14, v14
    ds_read_b128 v[32:35], v5 offset:0
    ds_read_b128 v[36:39], v5 offset:14336
    ds_read_b128 v[40:43], v5 offset:28672
    ds_read_b128 v[44:47], v5 offset:43008
    s_add_u32 s13, s8, 8
    s_min_u32 s13, s13, 13
    s_lshl_b32 s14, s13, 10
    v_add_u32 v5, s14, v14
    ds_read_b128 v[48:51], v5 offset:0
    ds_read_b128 v[52:55], v5 offset:14336
    ds_read_b128 v[56:59], v5 offset:28672
    ds_read_b128 v[60:63], v5 offset:43008
    s_add_u32 s13, s8, 12
    s_min_u32 s13, s13, 13
    s_lshl_b32 s14, s13, 10
    v_add_u32 v5, s14, v14
    ds_read_b128 v[64:67], v5 offset:0
    ds_read_b128 v[68:71], v5 offset:14336
    ds_read_b128 v[72:75], v5 offset:28672
    ds_read_b128 v[76:79], v5 offset:43008
    s_waitcnt vmcnt(0) lgkmcnt(0)
    v_add_f32 v16, v16, v20
    v_add_f32 v24, v24, v28
    v_add_f32 v17, v17, v21
    v_add_f32 v25, v25, v29
    v_add_f32 v18, v18, v22
    v_add_f32 v26, v26, v30
    v_add_f32 v19, v19, v23
    v_add_f32 v27, v27, v31
    v_add_f32 v16, v16, v24
    v_add_f32 v17, v17, v25
    v_add_f32 v18, v18, v26
    v_add_f32 v19, v19, v27
    v_lshlrev_b32 v20, 16, v120
    v_and_b32 v21, 0xffff0000, v120
    v_lshlrev_b32 v24, 16, v122
    v_and_b32 v25, 0xffff0000, v122
    v_lshlrev_b32 v22, 16, v121
    v_and_b32 v23, 0xffff0000, v121
    v_lshlrev_b32 v26, 16, v123
    v_and_b32 v27, 0xffff0000, v123
    v_add_f32 v16, v16, v24
    v_fma_f32 v16, v16, v124, v20
    v_add_f32 v17, v17, v25
    v_fma_f32 v17, v17, v125, v21
    v_add_f32 v18, v18, v26
    v_fma_f32 v18, v18, v126, v22
    v_add_f32 v19, v19, v27
    v_fma_f32 v19, v19, v127, v23
    v_cvt_pk_bf16_f32 v28, v16, v17
    v_cvt_pk_bf16_f32 v29, v18, v19
    global_store_dwordx2 v128, v[28:29], s[36:37]
.m2s_78:
    v_add_f32 v32, v32, v36
    v_add_f32 v40, v40, v44
    v_add_f32 v33, v33, v37
    v_add_f32 v41, v41, v45
    v_add_f32 v34, v34, v38
    v_add_f32 v42, v42, v46
    v_add_f32 v35, v35, v39
    v_add_f32 v43, v43, v47
    v_add_f32 v32, v32, v40
    v_add_f32 v33, v33, v41
    v_add_f32 v34, v34, v42
    v_add_f32 v35, v35, v43
    v_lshlrev_b32 v36, 16, v136
    v_and_b32 v37, 0xffff0000, v136
    v_lshlrev_b32 v40, 16, v138
    v_and_b32 v41, 0xffff0000, v138
    v_lshlrev_b32 v38, 16, v137
    v_and_b32 v39, 0xffff0000, v137
    v_lshlrev_b32 v42, 16, v139
    v_and_b32 v43, 0xffff0000, v139
    v_add_f32 v32, v32, v40
    v_fma_f32 v32, v32, v140, v36
    v_add_f32 v33, v33, v41
    v_fma_f32 v33, v33, v141, v37
    v_add_f32 v34, v34, v42
    v_fma_f32 v34, v34, v142, v38
    v_add_f32 v35, v35, v43
    v_fma_f32 v35, v35, v143, v39
    v_cvt_pk_bf16_f32 v44, v32, v33
    v_cvt_pk_bf16_f32 v45, v34, v35
    global_store_dwordx2 v144, v[44:45], s[36:37]
.m2s_79:
    v_add_f32 v48, v48, v52
    v_add_f32 v56, v56, v60
    v_add_f32 v49, v49, v53
    v_add_f32 v57, v57, v61
    v_add_f32 v50, v50, v54
    v_add_f32 v58, v58, v62
    v_add_f32 v51, v51, v55
    v_add_f32 v59, v59, v63
    v_add_f32 v48, v48, v56
    v_add_f32 v49, v49, v57
    v_add_f32 v50, v50, v58
    v_add_f32 v51, v51, v59
    v_lshlrev_b32 v52, 16, v152
    v_and_b32 v53, 0xffff0000, v152
    v_lshlrev_b32 v56, 16, v154
    v_and_b32 v57, 0xffff0000, v154
    v_lshlrev_b32 v54, 16, v153
    v_and_b32 v55, 0xffff0000, v153
    v_lshlrev_b32 v58, 16, v155
    v_and_b32 v59, 0xffff0000, v155
    v_add_f32 v48, v48, v56
    v_fma_f32 v48, v48, v156, v52
    v_add_f32 v49, v49, v57
    v_fma_f32 v49, v49, v157, v53
    v_add_f32 v50, v50, v58
    v_fma_f32 v50, v50, v158, v54
    v_add_f32 v51, v51, v59
    v_fma_f32 v51, v51, v159, v55
    v_cvt_pk_bf16_f32 v60, v48, v49
    v_cvt_pk_bf16_f32 v61, v50, v51
    global_store_dwordx2 v160, v[60:61], s[36:37]
.m2s_80:
    s_cmp_ge_u32 s8, 2
    s_cbranch_scc1 .m2s_81
    v_add_f32 v64, v64, v68
    v_add_f32 v72, v72, v76
    v_add_f32 v65, v65, v69
    v_add_f32 v73, v73, v77
    v_add_f32 v66, v66, v70
    v_add_f32 v74, v74, v78
    v_add_f32 v67, v67, v71
    v_add_f32 v75, v75, v79
    v_add_f32 v64, v64, v72
    v_add_f32 v65, v65, v73
    v_add_f32 v66, v66, v74
    v_add_f32 v67, v67, v75
    v_lshlrev_b32 v68, 16, v168
    v_and_b32 v69, 0xffff0000, v168
    v_lshlrev_b32 v72, 16, v170
    v_and_b32 v73, 0xffff0000, v170
    v_lshlrev_b32 v70, 16, v169
    v_and_b32 v71, 0xffff0000, v169
    v_lshlrev_b32 v74, 16, v171
    v_and_b32 v75, 0xffff0000, v171
    v_add_f32 v64, v64, v72
    v_fma_f32 v64, v64, v172, v68
    v_add_f32 v65, v65, v73
    v_fma_f32 v65, v65, v173, v69
    v_add_f32 v66, v66, v74
    v_fma_f32 v66, v66, v174, v70
    v_add_f32 v67, v67, v75
    v_fma_f32 v67, v67, v175, v71
    v_cvt_pk_bf16_f32 v76, v64, v65
    v_cvt_pk_bf16_f32 v77, v66, v67
    global_store_dwordx2 v176, v[76:77], s[36:37]
.m2s_81:
    s_barrier
    s_branch .wk_loop_41
.mg_end_12:
.mg_end2_16:
    s_endpgm
.section .rodata,"a"
.p2align 6
.amdhsa_kernel prep_kernel
  .amdhsa_next_free_vgpr 240
  .amdhsa_next_free_sgpr 102
  .amdhsa_accum_offset 240
  .amdhsa_group_segment_fixed_size 0
  .amdhsa_kernarg_size 136
  .amdhsa_user_sgpr_count 2
  .amdhsa_user_sgpr_kernarg_segment_ptr 1
  .amdhsa_system_sgpr_workgroup_id_x 1
  .amdhsa_float_denorm_mode_32 3
.end_amdhsa_kernel
.p2align 6
.amdhsa_kernel pre2_kernel
  .amdhsa_next_free_vgpr 208
  .amdhsa_next_free_sgpr 102
  .amdhsa_accum_offset 208
  .amdhsa_group_segment_fixed_size 0
  .amdhsa_kernarg_size 136
  .amdhsa_user_sgpr_count 2
  .amdhsa_user_sgpr_kernarg_segment_ptr 1
  .amdhsa_system_sgpr_workgroup_id_x 1
  .amdhsa_float_denorm_mode_32 3
.end_amdhsa_kernel
.p2align 6
.amdhsa_kernel mega_kernel
  .amdhsa_next_free_vgpr 512
  .amdhsa_next_free_sgpr 102
  .amdhsa_accum_offset 256
  .amdhsa_group_segment_fixed_size 0
  .amdhsa_kernarg_size 136
  .amdhsa_user_sgpr_count 2
  .amdhsa_user_sgpr_kernarg_segment_ptr 1
  .amdhsa_system_sgpr_workgroup_id_x 1
  .amdhsa_float_denorm_mode_32 3
.end_amdhsa_kernel
```
